```python
import torch

def _softmax(x, axis=-1):
    return torch.softmax(x, dim=axis)

def _gelu(x):
    return torch.nn.functional.gelu(x, approximate='tanh')

def _silu(x):
    return torch.nn.functional.silu(x)

def _sigmoid(x):
    return torch.sigmoid(x)

def _layernorm(x, axis=-1, eps=1e-05):
    m = x.mean(dim=axis, keepdim=True)
    v = x.var(dim=axis, keepdim=True, unbiased=False)
    return (x - m) / torch.sqrt(v + eps)

def _scatter_add(tgt, idx, src, axis=0):
    return tgt.clone().index_add_(axis, idx, src)

def _segment_sum(src, seg, n):
    out = torch.zeros((n,) + src.shape[1:], dtype=src.dtype)
    return out.index_add_(0, seg, src)

def _pad(x, pw):
    flat = tuple((v for pair in reversed(pw) for v in pair))
    return torch.nn.functional.pad(x, flat)
kernel_name = 'sequential_preLN__ssm_conv_s4d__mixer_gmlp__prompt'

def setup_inputs():

    _w = lambda a: (lambda t: t.to(torch.bfloat16) if t.is_floating_point() else t)(torch.as_tensor(a))

    def _A_setup():
        Bsz, L, D, N = (1, 2048, 640, 128)
        return {'u': _w((lambda *s: torch.randn(*s, dtype=torch.bfloat16) * 0.05)(Bsz, L, D)), 'log_A_real': _w((lambda *s: torch.randn(*s, dtype=torch.bfloat16) * 6.4)(D, N) * 0.5), 'A_imag': _w((lambda *s: torch.randn(*s, dtype=torch.bfloat16) * 0.05)(D, N) * 3.14), 'C_real': _w((lambda *s: torch.randn(*s, dtype=torch.bfloat16) * 0.05)(D, N) / N ** 0.5), 'C_imag': _w((lambda *s: torch.randn(*s, dtype=torch.bfloat16) * 0.05)(D, N) / N ** 0.5), 'log_dt': _w((lambda *s: torch.randn(*s, dtype=torch.bfloat16) * 0.05)(D) * 0.5 - 4.0), 'D_skip': _w((lambda *s: torch.randn(*s, dtype=torch.bfloat16) * 0.05)(D))}
    _A_in = _A_setup()

    def _B_setup():
        B, S, D, F = (1, 2048, 640, 1728)
        Fh = F // 2
        return {'x': _w((lambda *s: torch.randn(*s, dtype=torch.bfloat16) * 0.05)(B, S, D)), 'w_in': _w((lambda *s: torch.randn(*s, dtype=torch.bfloat16) * 0.4)(D, 2 * Fh)), 'w_sp': _w(0.01 * (lambda *s: torch.randn(*s, dtype=torch.bfloat16) * 0.4)(S, S)), 'b_sp': _w(1.0 + 0.01 * (lambda *s: torch.randn(*s, dtype=torch.bfloat16) * 0.05)(S)), 'w_out': _w((lambda *s: torch.randn(*s, dtype=torch.bfloat16) * 0.05)(Fh, D))}
    _B_in = _B_setup()
    return {'A_u': _A_in['u'], 'A_log_A_real': _A_in['log_A_real'], 'A_A_imag': _A_in['A_imag'], 'A_C_real': _A_in['C_real'], 'A_C_imag': _A_in['C_imag'], 'A_log_dt': _A_in['log_dt'], 'A_D_skip': _A_in['D_skip'], 'B_x': _B_in['x'], 'B_w_in': _B_in['w_in'], 'B_w_sp': _B_in['w_sp'], 'B_b_sp': _B_in['b_sp'], 'B_w_out': _B_in['w_out']}

def reference(A_u, A_log_A_real, A_A_imag, A_C_real, A_C_imag, A_log_dt, A_D_skip, B_x, B_w_in, B_w_sp, B_b_sp, B_w_out):

    def _A_ref(u, log_A_real, A_imag, C_real, C_imag, log_dt, D_skip):
        L = u.shape[1]
        dt = torch.exp(log_dt)
        A = -torch.exp(log_A_real) + 1j * A_imag
        C = (C_real + 1j * C_imag) * dt[:, None]
        pos = (lambda x, dt: x.to(dt))(torch.arange(L), log_dt.dtype)
        P = torch.exp((A * dt[:, None])[:, :, None] * pos[None, None, :])
        K = 2.0 * torch.einsum('dn,dnl->dl', C, P).real
        L2 = 2 * L
        u_t = (lambda x, *d: x.permute(*d))(u, 0, 2, 1)
        Kf = (lambda x, *a, **k: torch.fft.rfft(x.float(), *a, **k))(K, L2)
        Uf = (lambda x, *a, **k: torch.fft.rfft(x.float(), *a, **k))(u_t, L2)
        y = (lambda x, *a, **k: torch.fft.irfft(x, *a, **k).to(torch.bfloat16))(Uf * Kf[None, :, :], L2)[:, :, :L]
        y = (lambda x, *d: x.permute(*d))(y, 0, 2, 1)
        return y + u * D_skip[None, None, :]

    def _B_ref(x, w_in, w_sp, b_sp, w_out):
        B, S, D = x.shape
        F = w_in.shape[-1]
        Fh = F // 2
        z = _gelu(torch.einsum('bsd,df->bsf', x, w_in))
        z1 = z[..., :Fh].clone()
        z2 = _layernorm(z[..., Fh:], axis=-1)
        g = torch.einsum('ts,bsf->btf', w_sp, z2) + b_sp[None, :, None]
        return torch.einsum('bsf,fd->bsd', z1 * g, w_out)
    x = A_u
    h = x + _A_ref(_layernorm(x, axis=-1), A_log_A_real, A_A_imag, A_C_real, A_C_imag, A_log_dt, A_D_skip)
    h2 = h + _B_ref(_layernorm(h, axis=-1), B_w_in, B_w_sp, B_b_sp, B_w_out)
    return h2
```

```asm
; @launch kernel=mega_kernel grid=(256,1,1) block=(512,1,1) lds=161856
.amdgcn_target "amdgcn-amd-amdhsa--gfx950"
.text
.globl mega_kernel
.p2align 8
.type mega_kernel,@function
mega_kernel:
    s_cmp_ge_u32 s2, 256
    s_cbranch_scc1 L_mega_kernel_end_1
    s_load_dwordx16 s[32:47], s[0:1], 0
    s_load_dwordx4 s[4:7], s[0:1], 104
    s_load_dwordx2 s[48:49], s[0:1], 64
    s_load_dwordx2 s[50:51], s[0:1], 88
    s_load_dwordx2 s[12:13], s[0:1], 96
    s_load_dwordx4 s[8:11], s[0:1], 72
    v_lshrrev_b32 v2, 6, v0
    v_and_b32 v1, 63, v0
    v_readfirstlane_b32 s16, v2
    s_bfe_u32 s14, s2, 0x20001
    s_lshl_b32 s14, s14, 3
    s_lshr_b32 s17, s2, 5
    s_add_u32 s14, s14, s17
    s_and_b32 s15, s2, 1
    s_lshl_b32 s15, s15, 2
    s_bfe_u32 s17, s2, 0x20003
    s_add_u32 s15, s15, s17
    s_and_b32 s18, s2, 7
    s_lshr_b32 s17, s2, 4
    s_lshl_b32 s17, s17, 3
    s_add_u32 s18, s18, s17
    s_bfe_u32 s52, s2, 0x10003
    s_mul_i32 s18, s18, 5
    s_mul_i32 s17, s52, 3
    s_add_u32 s53, s18, s17
    s_add_u32 s54, s53, 1
    s_add_u32 s55, s18, 2
    s_and_b32 s22, s16, 3
    v_and_b32 v5, 15, v0
    v_bfe_u32 v6, v0, 4, 2
    v_lshlrev_b32 v4, 4, v1
    v_mov_b32 v236, 0
    v_mov_b32 v154, 0
    v_mov_b32 v140, 0
    v_mov_b32 v141, 0
    v_mov_b32 v142, 0
    s_cmp_ge_u32 s16, 4
    s_cbranch_scc1 L_mega_kernel_mem_3
    v_mov_b32 v69, s53
    v_mov_b32 v71, 0
    s_mov_b32 exec_lo, 0
    v_mov_b32 v69, s54
    v_mov_b32 v71, 1
    s_mov_b64 exec, -1
    v_and_b32 v3, 31, v1
    s_lshl_b32 s17, s22, 5
    v_add_u32 v2, s17, v3
    v_lshlrev_b32 v68, 7, v69
    v_add_lshl_u32 v68, v68, v2, 1
    v_lshlrev_b32 v69, 1, v69
    s_waitcnt lgkmcnt(0)
    s_mov_b32 s60, s34
    s_mov_b32 s61, s35
    s_mov_b32 s62, 0x28000
    s_mov_b32 s63, 0x00020000
    buffer_load_ushort v64, v68, s[60:63], 0 offen
    s_mov_b32 s64, s36
    s_mov_b32 s65, s37
    s_mov_b32 s66, 0x28000
    s_mov_b32 s67, 0x00020000
    buffer_load_ushort v65, v68, s[64:67], 0 offen
    s_mov_b32 s68, s38
    s_mov_b32 s69, s39
    s_mov_b32 s70, 0x28000
    s_mov_b32 s71, 0x00020000
    buffer_load_ushort v66, v68, s[68:71], 0 offen
    s_mov_b32 s72, s40
    s_mov_b32 s73, s41
    s_mov_b32 s74, 0x28000
    s_mov_b32 s75, 0x00020000
    buffer_load_ushort v67, v68, s[72:75], 0 offen
    s_mov_b32 s76, s42
    s_mov_b32 s77, s43
    s_mov_b32 s78, 0x500
    s_mov_b32 s79, 0x00020000
    buffer_load_ushort v70, v69, s[76:79], 0 offen
    s_mov_b32 s76, s44
    s_mov_b32 s77, s45
    s_mov_b32 s78, 0x500
    s_mov_b32 s79, 0x00020000
    v_mov_b32 v2, 0
    s_lshl_b32 s17, s53, 1
    buffer_load_ushort v117, v2, s[76:79], s17 offen
    s_lshl_b32 s17, s54, 1
    buffer_load_ushort v118, v2, s[76:79], s17 offen
    s_cmp_lg_u32 s16, 3
    s_cbranch_scc1 L_mega_kernel_pf_4
    s_getpc_b64 s[60:61]
L_mega_kernel_pc_5:
    s_sub_u32 s60, s60, L_mega_kernel_pc_5-mega_kernel
    s_subb_u32 s61, s61, 0
    s_lshr_b32 s17, s2, 3
    s_lshl_b32 s17, s17, 11
    v_lshlrev_b32 v14, 5, v1
    v_add_u32 v14, s17, v14
    s_mov_b32 s17, L_code_end-mega_kernel
    v_cmp_gt_u32 vcc, s17, v14
    v_mov_b32 v13, s61
    s_and_saveexec_b64 s[62:63], vcc
    s_cbranch_execz L_mega_kernel_pe_6
    v_add_co_u32 v12, vcc, s60, v14
    s_nop 1
    v_addc_co_u32 v13, vcc, 0, v13, vcc
    global_load_dword v15, v[12:13], off
L_mega_kernel_pe_6:
    s_mov_b64 exec, -1
L_mega_kernel_pf_4:
    s_or_b32 s17, s2, s16
    s_cmp_lg_u32 s17, 0
    s_cbranch_scc1 L_mega_kernel_nn_7
    s_memrealtime s[20:21]
    s_mov_b32 s60, s4
    s_mov_b32 s61, s5
    s_mov_b32 s62, 0x100
    s_mov_b32 s63, 0x00020000
    v_mov_b32 v2, 0
    s_waitcnt lgkmcnt(0)
    s_or_b32 s21, s21, 0x80000000
    v_mov_b32 v12, s20
    v_mov_b32 v13, s21
    s_mov_b64 exec, 1
    buffer_store_dwordx2 v[12:13], v2, s[60:63], 0 offen sc0 sc1
    s_mov_b64 exec, -1
L_mega_kernel_nn_7:
    s_barrier
    v_and_b32 v3, 31, v1
    s_mul_i32 s17, s22, 1536
    s_add_u32 s17, s17, 76032
    v_lshlrev_b32 v72, 5, v71
    v_add_lshl_u32 v72, v72, v3, 4
    v_add_u32 v72, s17, v72
    s_add_u32 s17, s17, 0
    v_lshlrev_b32 v10, 6, v6
    v_add_u32 v10, s17, v10
    v_lshrrev_b32 v73, 4, v3
    s_lshl_b32 s17, s22, 1
    v_add_u32 v73, s17, v73
    v_lshl_add_u32 v73, v71, 3, v73
    v_lshlrev_b32 v73, 2, v73
    v_add_u32 v73, 82432, v73
    v_cvt_f32_u32 v8, v5
    s_mul_i32 s17, s22, 2624
    s_add_u32 s17, s17, 119424
    v_lshlrev_b32 v11, 6, v5
    v_lshl_add_u32 v11, v6, 4, v11
    v_add_u32 v11, s17, v11
    v_and_b32 v116, 255, v0
    v_lshlrev_b32 v2, 3, v116
    v_sub_u32 v2, 2047, v2
    s_mov_b32 s18, -24264
    v_cvt_f32_i32 v3, v2
    v_cmp_gt_i32 vcc, 128, v2
    v_cvt_pk_bf16_f32 v3, v3, 0
    v_add_u32 v100, 17024, v2
    v_add_u32 v2, -1, v2
    v_cndmask_b32 v3, v3, v100, vcc
    v_subrev_u32 v3, s18, v3
    v_lshlrev_b32 v100, 1, v3
    v_cvt_f32_i32 v3, v2
    v_cmp_gt_i32 vcc, 128, v2
    v_cvt_pk_bf16_f32 v3, v3, 0
    v_add_u32 v101, 17024, v2
    v_add_u32 v2, -1, v2
    v_cndmask_b32 v3, v3, v101, vcc
    v_subrev_u32 v3, s18, v3
    v_lshlrev_b32 v101, 1, v3
    v_cvt_f32_i32 v3, v2
    v_cmp_gt_i32 vcc, 128, v2
    v_cvt_pk_bf16_f32 v3, v3, 0
    v_add_u32 v102, 17024, v2
    v_add_u32 v2, -1, v2
    v_cndmask_b32 v3, v3, v102, vcc
    v_subrev_u32 v3, s18, v3
    v_lshlrev_b32 v102, 1, v3
    v_cvt_f32_i32 v3, v2
    v_cmp_gt_i32 vcc, 128, v2
    v_cvt_pk_bf16_f32 v3, v3, 0
    v_add_u32 v103, 17024, v2
    v_add_u32 v2, -1, v2
    v_cndmask_b32 v3, v3, v103, vcc
    v_subrev_u32 v3, s18, v3
    v_lshlrev_b32 v103, 1, v3
    v_cvt_f32_i32 v3, v2
    v_cmp_gt_i32 vcc, 128, v2
    v_cvt_pk_bf16_f32 v3, v3, 0
    v_add_u32 v104, 17024, v2
    v_add_u32 v2, -1, v2
    v_cndmask_b32 v3, v3, v104, vcc
    v_subrev_u32 v3, s18, v3
    v_lshlrev_b32 v104, 1, v3
    v_cvt_f32_i32 v3, v2
    v_cmp_gt_i32 vcc, 128, v2
    v_cvt_pk_bf16_f32 v3, v3, 0
    v_add_u32 v105, 17024, v2
    v_add_u32 v2, -1, v2
    v_cndmask_b32 v3, v3, v105, vcc
    v_subrev_u32 v3, s18, v3
    v_lshlrev_b32 v105, 1, v3
    v_cvt_f32_i32 v3, v2
    v_cmp_gt_i32 vcc, 128, v2
    v_cvt_pk_bf16_f32 v3, v3, 0
    v_add_u32 v106, 17024, v2
    v_add_u32 v2, -1, v2
    v_cndmask_b32 v3, v3, v106, vcc
    v_subrev_u32 v3, s18, v3
    v_lshlrev_b32 v106, 1, v3
    v_cvt_f32_i32 v3, v2
    v_cmp_gt_i32 vcc, 128, v2
    v_cvt_pk_bf16_f32 v3, v3, 0
    v_add_u32 v107, 17024, v2
    v_add_u32 v2, -1, v2
    v_cndmask_b32 v3, v3, v107, vcc
    v_subrev_u32 v3, s18, v3
    v_lshlrev_b32 v107, 1, v3
    v_cvt_f32_i32 v3, v2
    v_cmp_gt_i32 vcc, 128, v2
    v_cvt_pk_bf16_f32 v3, v3, 0
    v_add_u32 v108, 17024, v2
    v_add_u32 v2, -1, v2
    v_cndmask_b32 v3, v3, v108, vcc
    v_subrev_u32 v3, s18, v3
    v_lshlrev_b32 v108, 1, v3
    v_cvt_f32_i32 v3, v2
    v_cmp_gt_i32 vcc, 128, v2
    v_cvt_pk_bf16_f32 v3, v3, 0
    v_add_u32 v109, 17024, v2
    v_add_u32 v2, -1, v2
    v_cndmask_b32 v3, v3, v109, vcc
    v_subrev_u32 v3, s18, v3
    v_lshlrev_b32 v109, 1, v3
    v_cvt_f32_i32 v3, v2
    v_cmp_gt_i32 vcc, 128, v2
    v_cvt_pk_bf16_f32 v3, v3, 0
    v_add_u32 v110, 17024, v2
    v_cndmask_b32 v3, v3, v110, vcc
    v_subrev_u32 v3, s18, v3
    v_lshlrev_b32 v110, 1, v3
    v_lshlrev_b32 v111, 4, v116
    v_add_u32 v115, 0, v111
    v_add_u32 v111, 119424, v111
    v_lshlrev_b32 v113, 3, v116
    v_add_u32 v113, 82576, v113
    v_mov_b32 v16, 0
    v_mov_b32 v17, 0
    v_mov_b32 v18, 0
    v_mov_b32 v19, 0
    s_min_u32 s17, s16, 2
    s_mul_i32 s18, s17, 25344
    s_add_u32 s18, s18, 16640
    v_add_u32 v20, s18, v4
    v_bfe_u32 v2, v1, 1, 2
    v_mul_u32_u24 v2, 25344, v2
    v_and_b32 v3, 1, v1
    v_lshl_add_u32 v2, v3, 4, v2
    s_mul_i32 s18, s16, 4160
    s_add_u32 s18, s18, 4096
    v_add_u32 v2, s18, v2
    v_cmp_gt_u32 vcc, 32, v1
    s_mul_i32 s17, s17, 1344
    s_add_u32 s17, s17, 82560
    v_cndmask_b32 v20, v2, v20, vcc
    v_mov_b32 v2, s17
    v_cmp_eq_u32 vcc, 38, v1
    s_nop 1
    v_cndmask_b32 v20, v20, v2, vcc
    s_mov_b32 exec_hi, 0x7f
    ds_write_b128 v20, v[16:19]
    s_mov_b64 exec, -1
    s_lshr_b32 s36, s16, 1
    s_add_u32 s37, s53, s36
    v_and_b32 v2, 3, v1
    v_mul_u32_u24 v237, 4160, v2
    v_lshl_add_u32 v237, v6, 4, v237
    v_bfe_u32 v2, v1, 2, 2
    v_lshlrev_b32 v2, 3, v2
    v_sub_u32 v237, v237, v2
    v_add_u32 v237, 472, v237
    v_lshlrev_b32 v238, 5, v5
    v_lshl_add_u32 v241, v6, 3, v238
    v_lshl_add_u32 v238, v6, 4, v238
    v_add_u32 v238, 17120, v238
    s_mul_i32 s17, s36, 25344
    s_and_b32 s18, s16, 1
    s_lshl_b32 s18, s18, 8
    s_sub_u32 s17, s17, s18
    v_add_u32 v239, s17, v237
    v_add_u32 v240, s17, v238
    s_and_b32 s17, s16, 1
    s_lshl_b32 s17, s17, 11
    s_sub_u32 s17, 2048, s17
    s_mul_i32 s18, s36, 25344
    s_add_u32 s18, s18, s17
    s_add_u32 s18, s18, 21248
    v_add_u32 v242, s18, v241
    s_sub_u32 s41, s55, 2
    s_mul_i32 s41, s41, 52429
    s_lshr_b32 s41, s41, 18
    s_lshl_b32 s40, s41, 2
    s_lshl_b32 s37, s52, 1
    s_add_u32 s40, s40, s37
    s_add_u32 s40, s40, s36
    s_lshl_b32 s40, s40, 7
    s_mul_i32 s17, s17, 640
    s_add_u32 s40, s40, s17
    s_cmp_eq_u32 s52, 0
    s_mov_b32 s17, 359
    s_cselect_b32 s17, s17, 9029
    s_lshl_b32 s18, s16, 2
    s_lshr_b32 s17, s17, s18
    s_and_b32 s17, s17, 15
    s_lshl_b32 s17, s17, 9
    s_add_u32 s41, s41, 512
    s_lshl_b32 s41, s41, 7
    s_mul_i32 s18, s17, 640
    s_add_u32 s41, s41, s18
    s_add_u32 s17, s17, 71936
    v_add_u32 v243, s17, v241
    s_mul_i32 s17, s36, 21248
    s_sub_u32 s17, 65408, s17
    v_add_u32 v244, s17, v242
    v_add_u32 v245, 22912, v243
    s_lshl_b32 s17, s16, 12
    s_add_u32 s17, s17, 119424
    v_add_u32 v246, s17, v4
    v_add_u32 v248, 4294946816, v246
    s_xor_b32 s17, s16, 1
    s_lshl_b32 s17, s17, 12
    s_add_u32 s17, s17, 119424
    v_add_u32 v247, s17, v4
    s_lshl_b32 s17, s16, 10
    s_add_u32 s17, s17, 98944
    v_add_u32 v249, s17, v4
    s_lshl_b32 s17, s16, 7
    s_sub_u32 s17, 50688, s17
    v_add_u32 v250, s17, v237
    v_add_u32 v251, s17, v238
    v_lshrrev_b32 v236, 2, v5
    v_mul_u32_u24 v236, 81792, v236
    v_add_u32 v236, v236, v241
    s_add_u32 s80, s40, 327680
    s_add_u32 s81, s40, 655360
    s_add_u32 s82, s40, 983040
    s_add_u32 s64, s6, 0xa80000
    s_addc_u32 s65, s7, 0
    s_mov_b32 s66, 0x280000
    s_mov_b32 s67, 0x00020000
    s_waitcnt vmcnt(0)
    s_setprio 1
    v_cmp_eq_u32 vcc, 0, v116
    v_lshlrev_b32 v117, 16, v117
    s_nop 0
    v_cndmask_b32 v117, 0, v117, vcc
    v_lshlrev_b32 v118, 16, v118
    v_cndmask_b32 v118, 0, v118, vcc
    v_lshlrev_b32 v64, 16, v64
    v_lshlrev_b32 v65, 16, v65
    v_lshlrev_b32 v66, 16, v66
    v_lshlrev_b32 v67, 16, v67
    v_lshlrev_b32 v70, 16, v70
    v_mul_f32 v70, 0x3fb8aa3b, v70
    v_mul_f32 v64, 0x3fb8aa3b, v64
    v_exp_f32 v70, v70
    v_exp_f32 v64, v64
    v_cvt_pk_bf16_f32 v70, v70, v70
    v_lshlrev_b32 v70, 16, v70
    v_cvt_pk_bf16_f32 v64, v64, v64
    v_lshlrev_b32 v64, 16, v64
    v_mul_f32 v64, v64, v70
    v_mul_f32 v64, 0xbfb8aa3b, v64
    v_mul_f32 v65, v65, v70
    v_mul_f32 v65, 0x3e22f983, v65
    v_add_f32 v70, v70, v70
    v_mul_f32 v66, v66, v70
    v_mul_f32 v67, v67, v70
    ds_write_b128 v72, v[64:67]
    ds_read_b128 v[12:15], v10 offset:0
    ds_read_b128 v[16:19], v10 offset:16
    ds_read_b128 v[20:23], v10 offset:32
    ds_read_b128 v[24:27], v10 offset:48
    v_add_u32 v10, 256, v10
    v_mul_f32 v74, 0x45000000, v64
    v_mul_f32 v75, 0x45000000, v65
    v_exp_f32 v74, v74
    v_fract_f32 v75, v75
    v_sin_f32 v76, v75
    v_cos_f32 v75, v75
    v_mul_f32 v76, v76, v67
    v_fma_f32 v75, v75, v66, -v76
    v_mul_f32 v75, v75, v74
    s_nop 1
    v_add_f32_dpp v75, v75, v75 row_ror:8 row_mask:0xf bank_mask:0xf
    s_nop 1
    v_add_f32_dpp v75, v75, v75 row_ror:4 row_mask:0xf bank_mask:0xf
    s_nop 1
    v_add_f32_dpp v75, v75, v75 row_ror:2 row_mask:0xf bank_mask:0xf
    s_nop 1
    v_add_f32_dpp v75, v75, v75 row_ror:1 row_mask:0xf bank_mask:0xf
    ds_write_b32 v73, v75
    s_mov_b32 s38, 0
    s_mov_b32 s56, 0
L_mega_kernel_outer_8:
    v_mov_b32 v60, 0
    v_mov_b32 v61, 0
    v_mov_b32 v62, 0
    v_mov_b32 v63, 0
    v_mov_b32 v64, 0
    v_mov_b32 v65, 0
    v_mov_b32 v66, 0
    v_mov_b32 v67, 0
    v_mov_b32 v68, 0
    v_mov_b32 v69, 0
    v_mov_b32 v70, 0
    v_mov_b32 v71, 0
    v_mov_b32 v72, 0
    v_mov_b32 v73, 0
    v_mov_b32 v74, 0
    v_mov_b32 v75, 0
    s_mov_b32 s39, 0
L_mega_kernel_unit_2:
    s_waitcnt lgkmcnt(0)
    v_pk_mul_f32 v[78:79], v[12:13], v[8:9] op_sel_hi:[1,0]
    v_pk_mul_f32 v[84:85], v[16:17], v[8:9] op_sel_hi:[1,0]
    v_pk_mul_f32 v[90:91], v[20:21], v[8:9] op_sel_hi:[1,0]
    v_pk_mul_f32 v[96:97], v[24:25], v[8:9] op_sel_hi:[1,0]
    ds_read_b64 v[12:13], v10 offset:0
    ds_read_b64 v[16:17], v10 offset:16
    ds_read_b64 v[20:21], v10 offset:32
    ds_read_b64 v[24:25], v10 offset:48
    v_exp_f32 v80, v78
    v_exp_f32 v86, v84
    v_exp_f32 v92, v90
    v_exp_f32 v98, v96
    v_cos_f32 v76, v79
    v_cos_f32 v82, v85
    v_cos_f32 v88, v91
    v_cos_f32 v94, v97
    v_sin_f32 v77, v79
    v_sin_f32 v83, v85
    v_sin_f32 v89, v91
    v_sin_f32 v95, v97
    v_pk_mul_f32 v[76:77], v[76:77], v[80:81] op_sel_hi:[1,0]
    v_pk_mul_f32 v[82:83], v[82:83], v[86:87] op_sel_hi:[1,0]
    v_pk_mul_f32 v[88:89], v[88:89], v[92:93] op_sel_hi:[1,0]
    v_pk_mul_f32 v[94:95], v[94:95], v[98:99] op_sel_hi:[1,0]
    v_cvt_pk_bf16_f32 v28, v76, v77
    v_cvt_pk_bf16_f32 v29, v82, v83
    v_cvt_pk_bf16_f32 v30, v88, v89
    v_cvt_pk_bf16_f32 v31, v94, v95
    v_pk_mul_f32 v[78:79], v[76:77], v[76:77] op_sel_hi:[1,0]
    v_pk_mul_f32 v[84:85], v[82:83], v[82:83] op_sel_hi:[1,0]
    v_pk_mul_f32 v[90:91], v[88:89], v[88:89] op_sel_hi:[1,0]
    v_pk_mul_f32 v[96:97], v[94:95], v[94:95] op_sel_hi:[1,0]
    v_pk_fma_f32 v[76:77], v[76:77], v[76:77], v[78:79] op_sel:[1,1,0] op_sel_hi:[0,1,1] neg_lo:[1,0,0]
    v_pk_fma_f32 v[82:83], v[82:83], v[82:83], v[84:85] op_sel:[1,1,0] op_sel_hi:[0,1,1] neg_lo:[1,0,0]
    v_pk_fma_f32 v[88:89], v[88:89], v[88:89], v[90:91] op_sel:[1,1,0] op_sel_hi:[0,1,1] neg_lo:[1,0,0]
    v_pk_fma_f32 v[94:95], v[94:95], v[94:95], v[96:97] op_sel:[1,1,0] op_sel_hi:[0,1,1] neg_lo:[1,0,0]
    v_cvt_pk_bf16_f32 v32, v76, v77
    v_cvt_pk_bf16_f32 v33, v82, v83
    v_cvt_pk_bf16_f32 v34, v88, v89
    v_cvt_pk_bf16_f32 v35, v94, v95
    v_pk_mul_f32 v[78:79], v[76:77], v[76:77] op_sel_hi:[1,0]
    v_pk_mul_f32 v[84:85], v[82:83], v[82:83] op_sel_hi:[1,0]
    v_pk_mul_f32 v[90:91], v[88:89], v[88:89] op_sel_hi:[1,0]
    v_pk_mul_f32 v[96:97], v[94:95], v[94:95] op_sel_hi:[1,0]
    v_pk_fma_f32 v[76:77], v[76:77], v[76:77], v[78:79] op_sel:[1,1,0] op_sel_hi:[0,1,1] neg_lo:[1,0,0]
    v_pk_fma_f32 v[82:83], v[82:83], v[82:83], v[84:85] op_sel:[1,1,0] op_sel_hi:[0,1,1] neg_lo:[1,0,0]
    v_pk_fma_f32 v[88:89], v[88:89], v[88:89], v[90:91] op_sel:[1,1,0] op_sel_hi:[0,1,1] neg_lo:[1,0,0]
    v_pk_fma_f32 v[94:95], v[94:95], v[94:95], v[96:97] op_sel:[1,1,0] op_sel_hi:[0,1,1] neg_lo:[1,0,0]
    v_cvt_pk_bf16_f32 v36, v76, v77
    v_cvt_pk_bf16_f32 v37, v82, v83
    v_cvt_pk_bf16_f32 v38, v88, v89
    v_cvt_pk_bf16_f32 v39, v94, v95
    v_pk_mul_f32 v[78:79], v[76:77], v[76:77] op_sel_hi:[1,0]
    v_pk_mul_f32 v[84:85], v[82:83], v[82:83] op_sel_hi:[1,0]
    v_pk_mul_f32 v[90:91], v[88:89], v[88:89] op_sel_hi:[1,0]
    v_pk_mul_f32 v[96:97], v[94:95], v[94:95] op_sel_hi:[1,0]
    v_pk_fma_f32 v[76:77], v[76:77], v[76:77], v[78:79] op_sel:[1,1,0] op_sel_hi:[0,1,1] neg_lo:[1,0,0]
    v_pk_fma_f32 v[82:83], v[82:83], v[82:83], v[84:85] op_sel:[1,1,0] op_sel_hi:[0,1,1] neg_lo:[1,0,0]
    v_pk_fma_f32 v[88:89], v[88:89], v[88:89], v[90:91] op_sel:[1,1,0] op_sel_hi:[0,1,1] neg_lo:[1,0,0]
    v_pk_fma_f32 v[94:95], v[94:95], v[94:95], v[96:97] op_sel:[1,1,0] op_sel_hi:[0,1,1] neg_lo:[1,0,0]
    v_cvt_pk_bf16_f32 v40, v76, v77
    v_cvt_pk_bf16_f32 v41, v82, v83
    v_cvt_pk_bf16_f32 v42, v88, v89
    v_cvt_pk_bf16_f32 v43, v94, v95
    v_pk_mul_f32 v[78:79], v[76:77], v[76:77] op_sel_hi:[1,0]
    v_pk_mul_f32 v[84:85], v[82:83], v[82:83] op_sel_hi:[1,0]
    v_pk_mul_f32 v[90:91], v[88:89], v[88:89] op_sel_hi:[1,0]
    v_pk_mul_f32 v[96:97], v[94:95], v[94:95] op_sel_hi:[1,0]
    v_pk_fma_f32 v[76:77], v[76:77], v[76:77], v[78:79] op_sel:[1,1,0] op_sel_hi:[0,1,1] neg_lo:[1,0,0]
    v_pk_fma_f32 v[82:83], v[82:83], v[82:83], v[84:85] op_sel:[1,1,0] op_sel_hi:[0,1,1] neg_lo:[1,0,0]
    v_pk_fma_f32 v[88:89], v[88:89], v[88:89], v[90:91] op_sel:[1,1,0] op_sel_hi:[0,1,1] neg_lo:[1,0,0]
    v_pk_fma_f32 v[94:95], v[94:95], v[94:95], v[96:97] op_sel:[1,1,0] op_sel_hi:[0,1,1] neg_lo:[1,0,0]
    v_pk_mul_f32 v[80:81], v[76:77], v[14:15] op_sel_hi:[1,0] neg_hi:[1,0]
    v_pk_mul_f32 v[86:87], v[82:83], v[18:19] op_sel_hi:[1,0] neg_hi:[1,0]
    v_pk_mul_f32 v[92:93], v[88:89], v[22:23] op_sel_hi:[1,0] neg_hi:[1,0]
    v_pk_mul_f32 v[98:99], v[94:95], v[26:27] op_sel_hi:[1,0] neg_hi:[1,0]
    v_pk_fma_f32 v[80:81], v[76:77], v[14:15], v[80:81] op_sel:[1,1,0] op_sel_hi:[0,1,1] neg_lo:[1,0,0] neg_hi:[1,0,0]
    v_pk_fma_f32 v[86:87], v[82:83], v[18:19], v[86:87] op_sel:[1,1,0] op_sel_hi:[0,1,1] neg_lo:[1,0,0] neg_hi:[1,0,0]
    v_pk_fma_f32 v[92:93], v[88:89], v[22:23], v[92:93] op_sel:[1,1,0] op_sel_hi:[0,1,1] neg_lo:[1,0,0] neg_hi:[1,0,0]
    v_pk_fma_f32 v[98:99], v[94:95], v[26:27], v[98:99] op_sel:[1,1,0] op_sel_hi:[0,1,1] neg_lo:[1,0,0] neg_hi:[1,0,0]
    v_cvt_pk_bf16_f32 v44, v80, v81
    v_cvt_pk_bf16_f32 v45, v86, v87
    v_cvt_pk_bf16_f32 v46, v92, v93
    v_cvt_pk_bf16_f32 v47, v98, v99
    v_pk_mul_f32 v[78:79], v[76:77], v[76:77] op_sel_hi:[1,0]
    v_pk_mul_f32 v[84:85], v[82:83], v[82:83] op_sel_hi:[1,0]
    v_pk_mul_f32 v[90:91], v[88:89], v[88:89] op_sel_hi:[1,0]
    v_pk_mul_f32 v[96:97], v[94:95], v[94:95] op_sel_hi:[1,0]
    v_pk_fma_f32 v[76:77], v[76:77], v[76:77], v[78:79] op_sel:[1,1,0] op_sel_hi:[0,1,1] neg_lo:[1,0,0]
    v_pk_fma_f32 v[82:83], v[82:83], v[82:83], v[84:85] op_sel:[1,1,0] op_sel_hi:[0,1,1] neg_lo:[1,0,0]
    v_pk_fma_f32 v[88:89], v[88:89], v[88:89], v[90:91] op_sel:[1,1,0] op_sel_hi:[0,1,1] neg_lo:[1,0,0]
    v_pk_fma_f32 v[94:95], v[94:95], v[94:95], v[96:97] op_sel:[1,1,0] op_sel_hi:[0,1,1] neg_lo:[1,0,0]
    v_pk_mul_f32 v[80:81], v[76:77], v[14:15] op_sel_hi:[1,0] neg_hi:[1,0]
    v_pk_mul_f32 v[86:87], v[82:83], v[18:19] op_sel_hi:[1,0] neg_hi:[1,0]
    v_pk_mul_f32 v[92:93], v[88:89], v[22:23] op_sel_hi:[1,0] neg_hi:[1,0]
    v_pk_mul_f32 v[98:99], v[94:95], v[26:27] op_sel_hi:[1,0] neg_hi:[1,0]
    v_pk_fma_f32 v[80:81], v[76:77], v[14:15], v[80:81] op_sel:[1,1,0] op_sel_hi:[0,1,1] neg_lo:[1,0,0] neg_hi:[1,0,0]
    v_pk_fma_f32 v[86:87], v[82:83], v[18:19], v[86:87] op_sel:[1,1,0] op_sel_hi:[0,1,1] neg_lo:[1,0,0] neg_hi:[1,0,0]
    v_pk_fma_f32 v[92:93], v[88:89], v[22:23], v[92:93] op_sel:[1,1,0] op_sel_hi:[0,1,1] neg_lo:[1,0,0] neg_hi:[1,0,0]
    v_pk_fma_f32 v[98:99], v[94:95], v[26:27], v[98:99] op_sel:[1,1,0] op_sel_hi:[0,1,1] neg_lo:[1,0,0] neg_hi:[1,0,0]
    v_cvt_pk_bf16_f32 v48, v80, v81
    v_cvt_pk_bf16_f32 v49, v86, v87
    v_cvt_pk_bf16_f32 v50, v92, v93
    v_cvt_pk_bf16_f32 v51, v98, v99
    v_pk_mul_f32 v[78:79], v[76:77], v[76:77] op_sel_hi:[1,0]
    v_pk_mul_f32 v[84:85], v[82:83], v[82:83] op_sel_hi:[1,0]
    v_pk_mul_f32 v[90:91], v[88:89], v[88:89] op_sel_hi:[1,0]
    v_pk_mul_f32 v[96:97], v[94:95], v[94:95] op_sel_hi:[1,0]
    v_pk_fma_f32 v[76:77], v[76:77], v[76:77], v[78:79] op_sel:[1,1,0] op_sel_hi:[0,1,1] neg_lo:[1,0,0]
    v_pk_fma_f32 v[82:83], v[82:83], v[82:83], v[84:85] op_sel:[1,1,0] op_sel_hi:[0,1,1] neg_lo:[1,0,0]
    v_pk_fma_f32 v[88:89], v[88:89], v[88:89], v[90:91] op_sel:[1,1,0] op_sel_hi:[0,1,1] neg_lo:[1,0,0]
    v_pk_fma_f32 v[94:95], v[94:95], v[94:95], v[96:97] op_sel:[1,1,0] op_sel_hi:[0,1,1] neg_lo:[1,0,0]
    v_pk_mul_f32 v[80:81], v[76:77], v[14:15] op_sel_hi:[1,0] neg_hi:[1,0]
    v_pk_mul_f32 v[86:87], v[82:83], v[18:19] op_sel_hi:[1,0] neg_hi:[1,0]
    v_pk_mul_f32 v[92:93], v[88:89], v[22:23] op_sel_hi:[1,0] neg_hi:[1,0]
    v_pk_mul_f32 v[98:99], v[94:95], v[26:27] op_sel_hi:[1,0] neg_hi:[1,0]
    v_pk_fma_f32 v[80:81], v[76:77], v[14:15], v[80:81] op_sel:[1,1,0] op_sel_hi:[0,1,1] neg_lo:[1,0,0] neg_hi:[1,0,0]
    v_pk_fma_f32 v[86:87], v[82:83], v[18:19], v[86:87] op_sel:[1,1,0] op_sel_hi:[0,1,1] neg_lo:[1,0,0] neg_hi:[1,0,0]
    v_pk_fma_f32 v[92:93], v[88:89], v[22:23], v[92:93] op_sel:[1,1,0] op_sel_hi:[0,1,1] neg_lo:[1,0,0] neg_hi:[1,0,0]
    v_pk_fma_f32 v[98:99], v[94:95], v[26:27], v[98:99] op_sel:[1,1,0] op_sel_hi:[0,1,1] neg_lo:[1,0,0] neg_hi:[1,0,0]
    v_cvt_pk_bf16_f32 v52, v80, v81
    v_cvt_pk_bf16_f32 v53, v86, v87
    v_cvt_pk_bf16_f32 v54, v92, v93
    v_cvt_pk_bf16_f32 v55, v98, v99
    v_pk_mul_f32 v[78:79], v[76:77], v[76:77] op_sel_hi:[1,0]
    v_pk_mul_f32 v[84:85], v[82:83], v[82:83] op_sel_hi:[1,0]
    v_pk_mul_f32 v[90:91], v[88:89], v[88:89] op_sel_hi:[1,0]
    v_pk_mul_f32 v[96:97], v[94:95], v[94:95] op_sel_hi:[1,0]
    v_pk_fma_f32 v[76:77], v[76:77], v[76:77], v[78:79] op_sel:[1,1,0] op_sel_hi:[0,1,1] neg_lo:[1,0,0]
    v_pk_fma_f32 v[82:83], v[82:83], v[82:83], v[84:85] op_sel:[1,1,0] op_sel_hi:[0,1,1] neg_lo:[1,0,0]
    v_pk_fma_f32 v[88:89], v[88:89], v[88:89], v[90:91] op_sel:[1,1,0] op_sel_hi:[0,1,1] neg_lo:[1,0,0]
    v_pk_fma_f32 v[94:95], v[94:95], v[94:95], v[96:97] op_sel:[1,1,0] op_sel_hi:[0,1,1] neg_lo:[1,0,0]
    v_pk_mul_f32 v[80:81], v[76:77], v[14:15] op_sel_hi:[1,0] neg_hi:[1,0]
    v_pk_mul_f32 v[86:87], v[82:83], v[18:19] op_sel_hi:[1,0] neg_hi:[1,0]
    v_pk_mul_f32 v[92:93], v[88:89], v[22:23] op_sel_hi:[1,0] neg_hi:[1,0]
    v_pk_mul_f32 v[98:99], v[94:95], v[26:27] op_sel_hi:[1,0] neg_hi:[1,0]
    v_pk_fma_f32 v[80:81], v[76:77], v[14:15], v[80:81] op_sel:[1,1,0] op_sel_hi:[0,1,1] neg_lo:[1,0,0] neg_hi:[1,0,0]
    v_pk_fma_f32 v[86:87], v[82:83], v[18:19], v[86:87] op_sel:[1,1,0] op_sel_hi:[0,1,1] neg_lo:[1,0,0] neg_hi:[1,0,0]
    v_pk_fma_f32 v[92:93], v[88:89], v[22:23], v[92:93] op_sel:[1,1,0] op_sel_hi:[0,1,1] neg_lo:[1,0,0] neg_hi:[1,0,0]
    v_pk_fma_f32 v[98:99], v[94:95], v[26:27], v[98:99] op_sel:[1,1,0] op_sel_hi:[0,1,1] neg_lo:[1,0,0] neg_hi:[1,0,0]
    ds_read_b64 v[14:15], v10 offset:8
    ds_read_b64 v[18:19], v10 offset:24
    ds_read_b64 v[22:23], v10 offset:40
    ds_read_b64 v[26:27], v10 offset:56
    v_add_u32 v10, 256, v10
    v_cvt_pk_bf16_f32 v56, v80, v81
    v_cvt_pk_bf16_f32 v57, v86, v87
    v_cvt_pk_bf16_f32 v58, v92, v93
    v_cvt_pk_bf16_f32 v59, v98, v99
    v_mfma_f32_16x16x32_bf16 v[60:63], v[28:31], v[44:47], v[60:63]
    v_mfma_f32_16x16x32_bf16 v[64:67], v[32:35], v[48:51], v[64:67]
    v_mfma_f32_16x16x32_bf16 v[68:71], v[36:39], v[52:55], v[68:71]
    v_mfma_f32_16x16x32_bf16 v[72:75], v[40:43], v[56:59], v[72:75]
    s_cmp_eq_u32 s56, 1
    s_cbranch_scc1 L_mega_kernel_uret1
    s_cmp_eq_u32 s56, 2
    s_nop 0
    s_cbranch_scc1 L_mega_kernel_uret2
    s_add_u32 s39, s39, 1
    s_cmp_lt_u32 s39, 2
    s_cbranch_scc1 L_mega_kernel_unit_2
    ds_write_b128 v11, v[60:63]
    s_mov_b32 exec_lo, 0xff00ff00
    s_mov_b32 exec_hi, 0xff00ff00
    ds_write_b128 v11, v[64:67] offset:512
    ds_write_b128 v11, v[68:71] offset:1024
    ds_write_b128 v11, v[72:75] offset:1536
    s_mov_b64 exec, -1
    v_add_u32 v11, 10496, v11
    s_add_u32 s38, s38, 1
    s_cmp_lt_u32 s38, 2
    s_cbranch_scc1 L_mega_kernel_outer_8
    v_mov_b32 v2, 161808
    v_mov_b32 v3, 1
    s_waitcnt lgkmcnt(0)
    s_mov_b64 exec, 1
    ds_add_u32 v2, v3
    s_mov_b64 exec, -1
    v_mov_b32 v2, 161808
    s_mov_b32 s17, 0
L_mega_kernel_ls_9:
    ds_read_b32 v3, v2
    s_waitcnt lgkmcnt(0)
    v_cmp_gt_u32 vcc, 4, v3
    s_cbranch_vccz L_mega_kernel_lo_10
    s_add_u32 s17, s17, 1
    s_sleep 1
    s_cmp_lt_u32 s17, 0x400000
    s_cbranch_scc1 L_mega_kernel_ls_9
L_mega_kernel_lo_10:
    v_mov_b32 v2, 161824
    ds_read_b64 v[96:97], v2
    s_add_u32 s60, s6, 0x940000
    s_addc_u32 s61, s7, 0
    s_mov_b32 s62, 0x30000
    s_mov_b32 s63, 0x00020000
    v_lshlrev_b32 v154, 9, v1
    s_waitcnt lgkmcnt(0)
    v_readfirstlane_b32 s20, v96
    v_readfirstlane_b32 s21, v97
    s_cmp_lg_u32 s16, 0
    s_cbranch_scc1 L_mega_kernel_q_11
    buffer_load_dwordx2 v[156:157], v154, s[60:63], 0 offen offset:0 sc1
    buffer_load_dwordx2 v[158:159], v154, s[60:63], 0 offen offset:128 sc1
    buffer_load_dwordx2 v[160:161], v154, s[60:63], 0 offen offset:256 sc1
    buffer_load_dwordx2 v[162:163], v154, s[60:63], 0 offen offset:384 sc1
L_mega_kernel_q_11:
    v_cmp_gt_u32 vcc, 160, v116
    v_min_u32 v2, 1, v1
    v_lshlrev_b32 v3, 5, v2
    v_add_u32 v3, 82432, v3
    ds_read_b128 v[44:47], v3
    ds_read_b128 v[48:51], v3 offset:16
    v_mul_u32_u24 v2, 1344, v2
    v_add_u32 v2, 83856, v2
    s_and_saveexec_b64 s[34:35], vcc
    s_cbranch_execz L_mega_kernel_vr_12
    ds_read_b128 v[12:15], v111 offset:0
    ds_read_b128 v[16:19], v111 offset:2624
    ds_read_b128 v[20:23], v111 offset:5248
    ds_read_b128 v[24:27], v111 offset:7872
    ds_read_b128 v[28:31], v111 offset:10496
    ds_read_b128 v[32:35], v111 offset:13120
    ds_read_b128 v[36:39], v111 offset:15744
    ds_read_b128 v[40:43], v111 offset:18368
    s_waitcnt lgkmcnt(4)
    v_pk_add_f32 v[12:13], v[12:13], v[16:17]
    v_pk_add_f32 v[20:21], v[20:21], v[24:25]
    v_pk_add_f32 v[14:15], v[14:15], v[18:19]
    v_pk_add_f32 v[22:23], v[22:23], v[26:27]
    v_pk_add_f32 v[12:13], v[12:13], v[20:21]
    v_pk_add_f32 v[14:15], v[14:15], v[22:23]
    v_add_f32 v12, v12, v117
    v_cvt_pk_bf16_f32 v16, v12, v13
    v_cvt_pk_bf16_f32 v17, v14, v15
    ds_write_b64 v113, v[16:17] offset:0
    s_waitcnt lgkmcnt(1)
    v_pk_add_f32 v[28:29], v[28:29], v[32:33]
    v_pk_add_f32 v[36:37], v[36:37], v[40:41]
    v_pk_add_f32 v[30:31], v[30:31], v[34:35]
    v_pk_add_f32 v[38:39], v[38:39], v[42:43]
    v_pk_add_f32 v[28:29], v[28:29], v[36:37]
    v_pk_add_f32 v[30:31], v[30:31], v[38:39]
    v_add_f32 v28, v28, v118
    v_cvt_pk_bf16_f32 v32, v28, v29
    v_cvt_pk_bf16_f32 v33, v30, v31
    ds_write_b64 v113, v[32:33] offset:1344
L_mega_kernel_vr_12:
    s_mov_b64 exec, s[34:35]
    s_waitcnt lgkmcnt(0)
    v_pk_add_f32 v[44:45], v[44:45], v[48:49]
    v_pk_add_f32 v[46:47], v[46:47], v[50:51]
    v_pk_add_f32 v[44:45], v[44:45], v[46:47]
    v_add_f32 v44, v44, v45
    v_cvt_pk_bf16_f32 v44, v44, v44
    ds_write_b16 v2, v44
    v_mov_b32 v2, 161808
    v_mov_b32 v3, 1
    s_waitcnt lgkmcnt(0)
    s_mov_b64 exec, 1
    ds_add_u32 v2, v3
    s_mov_b64 exec, -1
    v_lshrrev_b32 v148, 2, v116
    v_mul_u32_u24 v148, 40960, v148
    v_and_b32 v2, 3, v1
    v_lshl_add_u32 v148, v2, 4, v148
    v_lshlrev_b32 v149, 5, v116
    v_lshlrev_b32 v119, 4, v116
    v_add_u32 v119, 17152, v119
    s_add_u32 s72, s6, 0x280000
    s_addc_u32 s73, s7, 0
    s_mov_b32 s74, 0x280000
    s_mov_b32 s75, 0x00020000
    s_add_u32 s76, s6, 0x900000
    s_addc_u32 s77, s7, 0
    s_mov_b32 s78, 0x4000
    s_mov_b32 s79, 0x00020000
    s_cmp_lg_u32 s16, 0
    s_cbranch_scc1 L_mega_kernel_sp_13
    s_mov_b32 s38, 0
L_mega_kernel_poll_15:
    s_waitcnt vmcnt(0)
    s_cmp_eq_u32 s21, 0
    s_cbranch_scc1 L_mega_kernel_rn_17
    v_cmp_ne_u64 vcc, s[20:21], v[156:157]
    v_cmp_ne_u64 s[84:85], s[20:21], v[158:159]
    s_nop 0
    s_or_b64 vcc, vcc, s[84:85]
    v_cmp_ne_u64 s[84:85], s[20:21], v[160:161]
    s_nop 0
    s_or_b64 vcc, vcc, s[84:85]
    v_cmp_ne_u64 s[84:85], s[20:21], v[162:163]
    s_nop 0
    s_or_b64 vcc, vcc, s[84:85]
    s_cbranch_vccz L_mega_kernel_ok_16
L_mega_kernel_rn_17:
    v_mov_b32 v2, 161824
    ds_read_b64 v[96:97], v2
    buffer_load_dwordx2 v[156:157], v154, s[60:63], 0 offen offset:0 sc1
    buffer_load_dwordx2 v[158:159], v154, s[60:63], 0 offen offset:128 sc1
    buffer_load_dwordx2 v[160:161], v154, s[60:63], 0 offen offset:256 sc1
    buffer_load_dwordx2 v[162:163], v154, s[60:63], 0 offen offset:384 sc1
    s_waitcnt lgkmcnt(0)
    v_readfirstlane_b32 s20, v96
    v_readfirstlane_b32 s21, v97
    s_add_u32 s38, s38, 1
    s_cmp_lt_u32 s38, 0x100000
    s_cbranch_scc1 L_mega_kernel_poll_15
L_mega_kernel_ok_16:
    v_mov_b32 v2, 161800
    v_mov_b32 v3, 1
    s_waitcnt lgkmcnt(0)
    s_mov_b64 exec, 1
    ds_add_u32 v2, v3
    s_mov_b64 exec, -1
    s_branch L_mega_kernel_go_14
L_mega_kernel_sp_13:
    v_mov_b32 v2, 161800
    s_mov_b32 s17, 0
L_mega_kernel_ls_18:
    ds_read_b32 v3, v2
    s_waitcnt lgkmcnt(0)
    v_cmp_gt_u32 vcc, 1, v3
    s_cbranch_vccz L_mega_kernel_lo_19
    s_add_u32 s17, s17, 1
    s_sleep 1
    s_cmp_lt_u32 s17, 0x400000
    s_cbranch_scc1 L_mega_kernel_ls_18
L_mega_kernel_lo_19:
L_mega_kernel_go_14:
    s_lshl_b32 s17, s53, 6
    buffer_load_dwordx4 v[120:123], v148, s[72:75], s17 offen sc1
    s_mov_b32 s17, 8192
    buffer_load_dwordx4 v[132:135], v149, s[76:79], 0 offen offset:0 sc1
    buffer_load_dwordx4 v[140:143], v149, s[76:79], s17 offen offset:0 sc1
    buffer_load_dwordx4 v[136:139], v149, s[76:79], 0 offen offset:16 sc1
    buffer_load_dwordx4 v[144:147], v149, s[76:79], s17 offen offset:16 sc1
    s_lshl_b32 s17, s54, 6
    buffer_load_dwordx4 v[124:127], v148, s[72:75], s17 offen sc1
    s_lshl_b32 s17, s55, 6
    buffer_load_dwordx4 v[128:131], v148, s[72:75], s17 offen sc1
    v_mov_b32 v2, 161808
    s_mov_b32 s17, 0
L_mega_kernel_ls_20:
    ds_read_b32 v3, v2
    s_waitcnt lgkmcnt(0)
    v_cmp_gt_u32 vcc, 8, v3
    s_cbranch_vccz L_mega_kernel_lo_21
    s_add_u32 s17, s17, 1
    s_sleep 1
    s_cmp_lt_u32 s17, 0x400000
    s_cbranch_scc1 L_mega_kernel_ls_20
L_mega_kernel_lo_21:
    ds_read_u16 v60, v100 offset:0
    ds_read_u16 v61, v101 offset:0
    ds_read_u16 v62, v102 offset:0
    ds_read_u16 v63, v103 offset:0
    ds_read_u16 v64, v104 offset:0
    ds_read_u16 v65, v105 offset:0
    ds_read_u16 v66, v106 offset:0
    ds_read_u16 v67, v107 offset:0
    ds_read_u16 v68, v108 offset:0
    ds_read_u16 v69, v109 offset:0
    ds_read_u16 v70, v110 offset:0
    ds_read_u16 v71, v100 offset:1344
    ds_read_u16 v72, v101 offset:1344
    ds_read_u16 v73, v102 offset:1344
    ds_read_u16 v74, v103 offset:1344
    ds_read_u16 v75, v104 offset:1344
    ds_read_u16 v76, v105 offset:1344
    ds_read_u16 v77, v106 offset:1344
    ds_read_u16 v78, v107 offset:1344
    ds_read_u16 v79, v108 offset:1344
    ds_read_u16 v80, v109 offset:1344
    ds_read_u16 v81, v110 offset:1344
    s_waitcnt lgkmcnt(15)
    v_lshl_or_b32 v24, v61, 16, v60
    v_lshl_or_b32 v25, v63, 16, v62
    v_lshl_or_b32 v26, v65, 16, v64
    s_waitcnt lgkmcnt(14)
    v_lshl_or_b32 v27, v67, 16, v66
    ds_write_b128 v115, v[24:27] offset:12480
    v_lshl_or_b32 v20, v62, 16, v61
    v_lshl_or_b32 v21, v64, 16, v63
    v_lshl_or_b32 v22, v66, 16, v65
    s_waitcnt lgkmcnt(14)
    v_lshl_or_b32 v23, v68, 16, v67
    ds_write_b128 v115, v[20:23] offset:8320
    v_lshl_or_b32 v16, v63, 16, v62
    v_lshl_or_b32 v17, v65, 16, v64
    v_lshl_or_b32 v18, v67, 16, v66
    s_waitcnt lgkmcnt(14)
    v_lshl_or_b32 v19, v69, 16, v68
    ds_write_b128 v115, v[16:19] offset:4160
    v_lshl_or_b32 v12, v64, 16, v63
    v_lshl_or_b32 v13, v66, 16, v65
    v_lshl_or_b32 v14, v68, 16, v67
    s_waitcnt lgkmcnt(14)
    v_lshl_or_b32 v15, v70, 16, v69
    ds_write_b128 v115, v[12:15] offset:0
    s_waitcnt lgkmcnt(13)
    v_lshl_or_b32 v40, v72, 16, v71
    s_waitcnt lgkmcnt(11)
    v_lshl_or_b32 v41, v74, 16, v73
    s_waitcnt lgkmcnt(9)
    v_lshl_or_b32 v42, v76, 16, v75
    s_waitcnt lgkmcnt(7)
    v_lshl_or_b32 v43, v78, 16, v77
    ds_write_b128 v115, v[40:43] offset:37824
    v_lshl_or_b32 v36, v73, 16, v72
    v_lshl_or_b32 v37, v75, 16, v74
    v_lshl_or_b32 v38, v77, 16, v76
    s_waitcnt lgkmcnt(7)
    v_lshl_or_b32 v39, v79, 16, v78
    ds_write_b128 v115, v[36:39] offset:33664
    v_lshl_or_b32 v32, v74, 16, v73
    v_lshl_or_b32 v33, v76, 16, v75
    v_lshl_or_b32 v34, v78, 16, v77
    s_waitcnt lgkmcnt(7)
    v_lshl_or_b32 v35, v80, 16, v79
    ds_write_b128 v115, v[32:35] offset:29504
    v_lshl_or_b32 v28, v75, 16, v74
    v_lshl_or_b32 v29, v77, 16, v76
    v_lshl_or_b32 v30, v79, 16, v78
    s_waitcnt lgkmcnt(7)
    v_lshl_or_b32 v31, v81, 16, v80
    ds_write_b128 v115, v[28:31] offset:25344
    v_mov_b32 v8, 0
    v_mov_b32 v9, 0
    v_mov_b32 v10, 0
    v_mov_b32 v11, 0
    v_mov_b32 v12, 0
    v_mov_b32 v13, 0
    v_mov_b32 v14, 0
    v_mov_b32 v15, 0
    v_mov_b32 v16, 0
    v_mov_b32 v17, 0
    v_mov_b32 v18, 0
    v_mov_b32 v19, 0
    v_mov_b32 v20, 0
    v_mov_b32 v21, 0
    v_mov_b32 v22, 0
    v_mov_b32 v23, 0
    v_mov_b32 v24, 0
    v_mov_b32 v25, 0
    v_mov_b32 v26, 0
    v_mov_b32 v27, 0
    v_mov_b32 v28, 0
    v_mov_b32 v29, 0
    v_mov_b32 v30, 0
    v_mov_b32 v31, 0
    v_mov_b32 v32, 0
    v_mov_b32 v33, 0
    v_mov_b32 v34, 0
    v_mov_b32 v35, 0
    v_mov_b32 v36, 0
    v_mov_b32 v37, 0
    v_mov_b32 v38, 0
    v_mov_b32 v39, 0
    v_mov_b32 v40, 0
    v_mov_b32 v41, 0
    v_mov_b32 v42, 0
    v_mov_b32 v43, 0
    v_mov_b32 v44, 0
    v_mov_b32 v45, 0
    v_mov_b32 v46, 0
    v_mov_b32 v47, 0
    v_mov_b32 v48, 0
    v_mov_b32 v49, 0
    v_mov_b32 v50, 0
    v_mov_b32 v51, 0
    v_mov_b32 v52, 0
    v_mov_b32 v53, 0
    v_mov_b32 v54, 0
    v_mov_b32 v55, 0
    s_waitcnt vmcnt(2)
    ds_write_b128 v119, v[120:123] offset:4096
    v_lshlrev_b32 v96, 16, v120
    v_lshlrev_b32 v98, 16, v121
    v_and_b32 v97, 0xffff0000, v120
    v_and_b32 v99, 0xffff0000, v121
    v_pk_add_f32 v[96:97], v[96:97], v[132:133] neg_lo:[0,1] neg_hi:[0,1]
    v_pk_add_f32 v[98:99], v[98:99], v[134:135] neg_lo:[0,1] neg_hi:[0,1]
    v_pk_mul_f32 v[96:97], v[96:97], v[140:141]
    v_pk_mul_f32 v[98:99], v[98:99], v[142:143]
    v_cvt_pk_bf16_f32 v120, v96, v97
    v_cvt_pk_bf16_f32 v121, v98, v99
    v_lshlrev_b32 v96, 16, v122
    v_lshlrev_b32 v98, 16, v123
    v_and_b32 v97, 0xffff0000, v122
    v_and_b32 v99, 0xffff0000, v123
    v_pk_add_f32 v[96:97], v[96:97], v[136:137] neg_lo:[0,1] neg_hi:[0,1]
    v_pk_add_f32 v[98:99], v[98:99], v[138:139] neg_lo:[0,1] neg_hi:[0,1]
    v_pk_mul_f32 v[96:97], v[96:97], v[144:145]
    v_pk_mul_f32 v[98:99], v[98:99], v[146:147]
    v_cvt_pk_bf16_f32 v122, v96, v97
    v_cvt_pk_bf16_f32 v123, v98, v99
    ds_write_b128 v119, v[120:123] offset:0
    s_waitcnt vmcnt(1)
    ds_write_b128 v119, v[124:127] offset:29440
    v_lshlrev_b32 v96, 16, v124
    v_lshlrev_b32 v98, 16, v125
    v_and_b32 v97, 0xffff0000, v124
    v_and_b32 v99, 0xffff0000, v125
    v_pk_add_f32 v[96:97], v[96:97], v[132:133] neg_lo:[0,1] neg_hi:[0,1]
    v_pk_add_f32 v[98:99], v[98:99], v[134:135] neg_lo:[0,1] neg_hi:[0,1]
    v_pk_mul_f32 v[96:97], v[96:97], v[140:141]
    v_pk_mul_f32 v[98:99], v[98:99], v[142:143]
    v_cvt_pk_bf16_f32 v124, v96, v97
    v_cvt_pk_bf16_f32 v125, v98, v99
    v_lshlrev_b32 v96, 16, v126
    v_lshlrev_b32 v98, 16, v127
    v_and_b32 v97, 0xffff0000, v126
    v_and_b32 v99, 0xffff0000, v127
    v_pk_add_f32 v[96:97], v[96:97], v[136:137] neg_lo:[0,1] neg_hi:[0,1]
    v_pk_add_f32 v[98:99], v[98:99], v[138:139] neg_lo:[0,1] neg_hi:[0,1]
    v_pk_mul_f32 v[96:97], v[96:97], v[144:145]
    v_pk_mul_f32 v[98:99], v[98:99], v[146:147]
    v_cvt_pk_bf16_f32 v126, v96, v97
    v_cvt_pk_bf16_f32 v127, v98, v99
    ds_write_b128 v119, v[124:127] offset:25344
    s_waitcnt vmcnt(0)
    ds_write_b128 v119, v[128:131] offset:54784
    v_lshlrev_b32 v96, 16, v128
    v_lshlrev_b32 v98, 16, v129
    v_and_b32 v97, 0xffff0000, v128
    v_and_b32 v99, 0xffff0000, v129
    v_pk_add_f32 v[96:97], v[96:97], v[132:133] neg_lo:[0,1] neg_hi:[0,1]
    v_pk_add_f32 v[98:99], v[98:99], v[134:135] neg_lo:[0,1] neg_hi:[0,1]
    v_pk_mul_f32 v[96:97], v[96:97], v[140:141]
    v_pk_mul_f32 v[98:99], v[98:99], v[142:143]
    v_cvt_pk_bf16_f32 v128, v96, v97
    v_cvt_pk_bf16_f32 v129, v98, v99
    v_lshlrev_b32 v96, 16, v130
    v_lshlrev_b32 v98, 16, v131
    v_and_b32 v97, 0xffff0000, v130
    v_and_b32 v99, 0xffff0000, v131
    v_pk_add_f32 v[96:97], v[96:97], v[136:137] neg_lo:[0,1] neg_hi:[0,1]
    v_pk_add_f32 v[98:99], v[98:99], v[138:139] neg_lo:[0,1] neg_hi:[0,1]
    v_pk_mul_f32 v[96:97], v[96:97], v[144:145]
    v_pk_mul_f32 v[98:99], v[98:99], v[146:147]
    v_cvt_pk_bf16_f32 v130, v96, v97
    v_cvt_pk_bf16_f32 v131, v98, v99
    ds_write_b128 v119, v[128:131] offset:50688
    v_mov_b32 v2, 161808
    v_mov_b32 v3, 1
    s_waitcnt lgkmcnt(0)
    s_mov_b64 exec, 1
    ds_add_u32 v2, v3
    s_mov_b64 exec, -1
    v_mov_b32 v2, 161808
    s_mov_b32 s17, 0
L_mega_kernel_ls_22:
    ds_read_b32 v3, v2
    s_waitcnt lgkmcnt(0)
    v_cmp_gt_u32 vcc, 12, v3
    s_cbranch_vccz L_mega_kernel_lo_23
    s_add_u32 s17, s17, 1
    s_sleep 1
    s_cmp_lt_u32 s17, 0x400000
    s_cbranch_scc1 L_mega_kernel_ls_22
L_mega_kernel_lo_23:
    s_setprio 0
    ds_read_b128 v[120:123], v240 offset:0
    ds_read_b64 v[56:57], v239 offset:3584
    ds_read_b64 v[58:59], v239 offset:3592
    ds_read_b128 v[124:127], v240 offset:512
    ds_read_b64 v[60:61], v239 offset:3072
    ds_read_b64 v[62:63], v239 offset:3080
    ds_read_b128 v[128:131], v240 offset:1024
    ds_read_b64 v[64:65], v239 offset:2560
    ds_read_b64 v[66:67], v239 offset:2568
    ds_read_b128 v[132:135], v240 offset:1536
    ds_read_b64 v[68:69], v239 offset:2048
    ds_read_b64 v[70:71], v239 offset:2056
    ds_read_b128 v[136:139], v240 offset:2048
    ds_read_b64 v[72:73], v239 offset:1536
    ds_read_b64 v[74:75], v239 offset:1544
    ds_read_b128 v[140:143], v240 offset:2560
    ds_read_b64 v[76:77], v239 offset:1024
    ds_read_b64 v[78:79], v239 offset:1032
    ds_read_b128 v[144:147], v240 offset:3072
    ds_read_b64 v[80:81], v239 offset:512
    ds_read_b64 v[82:83], v239 offset:520
    ds_read_b128 v[148:151], v240 offset:3584
    ds_read_b64 v[84:85], v239 offset:0
    ds_read_b64 v[86:87], v239 offset:8
    v_subrev_u32 v239, 64, v239
    v_subrev_u32 v240, 64, v240
    s_waitcnt lgkmcnt(15)
    v_mfma_f32_16x16x32_bf16 v[36:39], v[56:59], v[120:123], v[36:39]
    ds_read_b128 v[152:155], v240 offset:0
    v_mfma_f32_16x16x32_bf16 v[28:31], v[60:63], v[124:127], v[28:31]
    ds_read_b64 v[88:89], v239 offset:3584
    v_mfma_f32_16x16x32_bf16 v[32:35], v[56:59], v[124:127], v[32:35]
    ds_read_b64 v[90:91], v239 offset:3592
    v_mfma_f32_16x16x32_bf16 v[32:35], v[60:63], v[120:123], v[32:35]
    v_mfma_f32_16x16x32_bf16 v[20:23], v[64:67], v[128:131], v[20:23]
    ds_read_b128 v[156:159], v240 offset:512
    v_mfma_f32_16x16x32_bf16 v[24:27], v[60:63], v[128:131], v[24:27]
    ds_read_b64 v[92:93], v239 offset:3072
    v_mfma_f32_16x16x32_bf16 v[24:27], v[64:67], v[124:127], v[24:27]
    v_mfma_f32_16x16x32_bf16 v[28:31], v[56:59], v[128:131], v[28:31]
    ds_read_b64 v[94:95], v239 offset:3080
    v_mfma_f32_16x16x32_bf16 v[28:31], v[64:67], v[120:123], v[28:31]
    ds_read_b128 v[160:163], v240 offset:1024
    s_waitcnt lgkmcnt(15)
    v_mfma_f32_16x16x32_bf16 v[12:15], v[68:71], v[132:135], v[12:15]
    v_mfma_f32_16x16x32_bf16 v[16:19], v[64:67], v[132:135], v[16:19]
    ds_read_b64 v[96:97], v239 offset:2560
    v_mfma_f32_16x16x32_bf16 v[16:19], v[68:71], v[128:131], v[16:19]
    ds_read_b64 v[98:99], v239 offset:2568
    v_mfma_f32_16x16x32_bf16 v[20:23], v[60:63], v[132:135], v[20:23]
    v_mfma_f32_16x16x32_bf16 v[20:23], v[68:71], v[124:127], v[20:23]
    ds_read_b128 v[164:167], v240 offset:1536
    v_mfma_f32_16x16x32_bf16 v[24:27], v[56:59], v[132:135], v[24:27]
    ds_read_b64 v[100:101], v239 offset:2048
    v_mfma_f32_16x16x32_bf16 v[24:27], v[68:71], v[120:123], v[24:27]
    v_mfma_f32_16x16x32_bf16 v[8:11], v[68:71], v[136:139], v[8:11]
    ds_read_b64 v[102:103], v239 offset:2056
    v_mfma_f32_16x16x32_bf16 v[8:11], v[72:75], v[132:135], v[8:11]
    ds_read_b128 v[168:171], v240 offset:2048
    v_mfma_f32_16x16x32_bf16 v[12:15], v[64:67], v[136:139], v[12:15]
    ds_read_b64 v[104:105], v239 offset:1536
    v_mfma_f32_16x16x32_bf16 v[12:15], v[72:75], v[128:131], v[12:15]
    v_mfma_f32_16x16x32_bf16 v[16:19], v[60:63], v[136:139], v[16:19]
    ds_read_b64 v[106:107], v239 offset:1544
    v_mfma_f32_16x16x32_bf16 v[16:19], v[72:75], v[124:127], v[16:19]
    ds_read_b128 v[172:175], v240 offset:2560
    v_mfma_f32_16x16x32_bf16 v[20:23], v[56:59], v[136:139], v[20:23]
    v_mfma_f32_16x16x32_bf16 v[20:23], v[72:75], v[120:123], v[20:23]
    ds_read_b64 v[108:109], v239 offset:1024
    v_mfma_f32_16x16x32_bf16 v[8:11], v[64:67], v[140:143], v[8:11]
    ds_read_b64 v[110:111], v239 offset:1032
    s_waitcnt lgkmcnt(15)
    v_mfma_f32_16x16x32_bf16 v[8:11], v[76:79], v[128:131], v[8:11]
    v_mfma_f32_16x16x32_bf16 v[12:15], v[60:63], v[140:143], v[12:15]
    ds_read_b128 v[176:179], v240 offset:3072
    v_mfma_f32_16x16x32_bf16 v[12:15], v[76:79], v[124:127], v[12:15]
    ds_read_b64 v[112:113], v239 offset:512
    v_mfma_f32_16x16x32_bf16 v[16:19], v[56:59], v[140:143], v[16:19]
    v_mfma_f32_16x16x32_bf16 v[16:19], v[76:79], v[120:123], v[16:19]
    ds_read_b64 v[114:115], v239 offset:520
    v_mfma_f32_16x16x32_bf16 v[8:11], v[60:63], v[144:147], v[8:11]
    ds_read_b128 v[180:183], v240 offset:3584
    v_mfma_f32_16x16x32_bf16 v[8:11], v[80:83], v[124:127], v[8:11]
    v_mfma_f32_16x16x32_bf16 v[12:15], v[56:59], v[144:147], v[12:15]
    ds_read_b64 v[116:117], v239 offset:0
    v_mfma_f32_16x16x32_bf16 v[12:15], v[80:83], v[120:123], v[12:15]
    ds_read_b64 v[118:119], v239 offset:8
    v_mfma_f32_16x16x32_bf16 v[8:11], v[56:59], v[148:151], v[8:11]
    v_mfma_f32_16x16x32_bf16 v[8:11], v[84:87], v[120:123], v[8:11]
    v_subrev_u32 v239, 64, v239
    v_subrev_u32 v240, 64, v240
    v_mfma_f32_16x16x32_bf16 v[36:39], v[88:91], v[152:155], v[36:39]
    ds_read_b128 v[120:123], v240 offset:0
    s_waitcnt lgkmcnt(15)
    v_mfma_f32_16x16x32_bf16 v[28:31], v[92:95], v[156:159], v[28:31]
    ds_read_b64 v[56:57], v239 offset:3584
    v_mfma_f32_16x16x32_bf16 v[32:35], v[88:91], v[156:159], v[32:35]
    ds_read_b64 v[58:59], v239 offset:3592
    v_mfma_f32_16x16x32_bf16 v[32:35], v[92:95], v[152:155], v[32:35]
    v_mfma_f32_16x16x32_bf16 v[20:23], v[96:99], v[160:163], v[20:23]
    ds_read_b128 v[124:127], v240 offset:512
    v_mfma_f32_16x16x32_bf16 v[24:27], v[92:95], v[160:163], v[24:27]
    ds_read_b64 v[60:61], v239 offset:3072
    v_mfma_f32_16x16x32_bf16 v[24:27], v[96:99], v[156:159], v[24:27]
    v_mfma_f32_16x16x32_bf16 v[28:31], v[88:91], v[160:163], v[28:31]
    ds_read_b64 v[62:63], v239 offset:3080
    v_mfma_f32_16x16x32_bf16 v[28:31], v[96:99], v[152:155], v[28:31]
    ds_read_b128 v[128:131], v240 offset:1024
    s_waitcnt lgkmcnt(15)
    v_mfma_f32_16x16x32_bf16 v[12:15], v[100:103], v[164:167], v[12:15]
    v_mfma_f32_16x16x32_bf16 v[16:19], v[96:99], v[164:167], v[16:19]
    ds_read_b64 v[64:65], v239 offset:2560
    v_mfma_f32_16x16x32_bf16 v[16:19], v[100:103], v[160:163], v[16:19]
    ds_read_b64 v[66:67], v239 offset:2568
    v_mfma_f32_16x16x32_bf16 v[20:23], v[92:95], v[164:167], v[20:23]
    v_mfma_f32_16x16x32_bf16 v[20:23], v[100:103], v[156:159], v[20:23]
    ds_read_b128 v[132:135], v240 offset:1536
    v_mfma_f32_16x16x32_bf16 v[24:27], v[88:91], v[164:167], v[24:27]
    ds_read_b64 v[68:69], v239 offset:2048
    v_mfma_f32_16x16x32_bf16 v[24:27], v[100:103], v[152:155], v[24:27]
    v_mfma_f32_16x16x32_bf16 v[8:11], v[100:103], v[168:171], v[8:11]
    ds_read_b64 v[70:71], v239 offset:2056
    v_mfma_f32_16x16x32_bf16 v[8:11], v[104:107], v[164:167], v[8:11]
    ds_read_b128 v[136:139], v240 offset:2048
    v_mfma_f32_16x16x32_bf16 v[12:15], v[96:99], v[168:171], v[12:15]
    ds_read_b64 v[72:73], v239 offset:1536
    v_mfma_f32_16x16x32_bf16 v[12:15], v[104:107], v[160:163], v[12:15]
    v_mfma_f32_16x16x32_bf16 v[16:19], v[92:95], v[168:171], v[16:19]
    ds_read_b64 v[74:75], v239 offset:1544
    v_mfma_f32_16x16x32_bf16 v[16:19], v[104:107], v[156:159], v[16:19]
    ds_read_b128 v[140:143], v240 offset:2560
    v_mfma_f32_16x16x32_bf16 v[20:23], v[88:91], v[168:171], v[20:23]
    v_mfma_f32_16x16x32_bf16 v[20:23], v[104:107], v[152:155], v[20:23]
    ds_read_b64 v[76:77], v239 offset:1024
    v_mfma_f32_16x16x32_bf16 v[8:11], v[96:99], v[172:175], v[8:11]
    ds_read_b64 v[78:79], v239 offset:1032
    s_waitcnt lgkmcnt(15)
    v_mfma_f32_16x16x32_bf16 v[8:11], v[108:111], v[160:163], v[8:11]
    v_mfma_f32_16x16x32_bf16 v[12:15], v[92:95], v[172:175], v[12:15]
    ds_read_b128 v[144:147], v240 offset:3072
    v_mfma_f32_16x16x32_bf16 v[12:15], v[108:111], v[156:159], v[12:15]
    ds_read_b64 v[80:81], v239 offset:512
    v_mfma_f32_16x16x32_bf16 v[16:19], v[88:91], v[172:175], v[16:19]
    v_mfma_f32_16x16x32_bf16 v[16:19], v[108:111], v[152:155], v[16:19]
    ds_read_b64 v[82:83], v239 offset:520
    v_mfma_f32_16x16x32_bf16 v[8:11], v[92:95], v[176:179], v[8:11]
    ds_read_b128 v[148:151], v240 offset:3584
    v_mfma_f32_16x16x32_bf16 v[8:11], v[112:115], v[156:159], v[8:11]
    v_mfma_f32_16x16x32_bf16 v[12:15], v[88:91], v[176:179], v[12:15]
    ds_read_b64 v[84:85], v239 offset:0
    v_mfma_f32_16x16x32_bf16 v[12:15], v[112:115], v[152:155], v[12:15]
    ds_read_b64 v[86:87], v239 offset:8
    v_mfma_f32_16x16x32_bf16 v[8:11], v[88:91], v[180:183], v[8:11]
    v_mfma_f32_16x16x32_bf16 v[8:11], v[116:119], v[152:155], v[8:11]
    v_subrev_u32 v239, 64, v239
    v_subrev_u32 v240, 64, v240
    v_mfma_f32_16x16x32_bf16 v[36:39], v[56:59], v[120:123], v[36:39]
    ds_read_b128 v[152:155], v240 offset:0
    s_waitcnt lgkmcnt(15)
    v_mfma_f32_16x16x32_bf16 v[28:31], v[60:63], v[124:127], v[28:31]
    ds_read_b64 v[88:89], v239 offset:3584
    v_mfma_f32_16x16x32_bf16 v[32:35], v[56:59], v[124:127], v[32:35]
    ds_read_b64 v[90:91], v239 offset:3592
    v_mfma_f32_16x16x32_bf16 v[32:35], v[60:63], v[120:123], v[32:35]
    v_mfma_f32_16x16x32_bf16 v[20:23], v[64:67], v[128:131], v[20:23]
    ds_read_b128 v[156:159], v240 offset:512
    v_mfma_f32_16x16x32_bf16 v[24:27], v[60:63], v[128:131], v[24:27]
    ds_read_b64 v[92:93], v239 offset:3072
    v_mfma_f32_16x16x32_bf16 v[24:27], v[64:67], v[124:127], v[24:27]
    v_mfma_f32_16x16x32_bf16 v[28:31], v[56:59], v[128:131], v[28:31]
    ds_read_b64 v[94:95], v239 offset:3080
    v_mfma_f32_16x16x32_bf16 v[28:31], v[64:67], v[120:123], v[28:31]
    ds_read_b128 v[160:163], v240 offset:1024
    s_waitcnt lgkmcnt(15)
    v_mfma_f32_16x16x32_bf16 v[12:15], v[68:71], v[132:135], v[12:15]
    v_mfma_f32_16x16x32_bf16 v[16:19], v[64:67], v[132:135], v[16:19]
    ds_read_b64 v[96:97], v239 offset:2560
    v_mfma_f32_16x16x32_bf16 v[16:19], v[68:71], v[128:131], v[16:19]
    ds_read_b64 v[98:99], v239 offset:2568
    v_mfma_f32_16x16x32_bf16 v[20:23], v[60:63], v[132:135], v[20:23]
    v_mfma_f32_16x16x32_bf16 v[20:23], v[68:71], v[124:127], v[20:23]
    ds_read_b128 v[164:167], v240 offset:1536
    v_mfma_f32_16x16x32_bf16 v[24:27], v[56:59], v[132:135], v[24:27]
    ds_read_b64 v[100:101], v239 offset:2048
    v_mfma_f32_16x16x32_bf16 v[24:27], v[68:71], v[120:123], v[24:27]
    v_mfma_f32_16x16x32_bf16 v[8:11], v[68:71], v[136:139], v[8:11]
    ds_read_b64 v[102:103], v239 offset:2056
    v_mfma_f32_16x16x32_bf16 v[8:11], v[72:75], v[132:135], v[8:11]
    ds_read_b128 v[168:171], v240 offset:2048
    v_mfma_f32_16x16x32_bf16 v[12:15], v[64:67], v[136:139], v[12:15]
    ds_read_b64 v[104:105], v239 offset:1536
    v_mfma_f32_16x16x32_bf16 v[12:15], v[72:75], v[128:131], v[12:15]
    v_mfma_f32_16x16x32_bf16 v[16:19], v[60:63], v[136:139], v[16:19]
    ds_read_b64 v[106:107], v239 offset:1544
    v_mfma_f32_16x16x32_bf16 v[16:19], v[72:75], v[124:127], v[16:19]
    ds_read_b128 v[172:175], v240 offset:2560
    v_mfma_f32_16x16x32_bf16 v[20:23], v[56:59], v[136:139], v[20:23]
    v_mfma_f32_16x16x32_bf16 v[20:23], v[72:75], v[120:123], v[20:23]
    ds_read_b64 v[108:109], v239 offset:1024
    v_mfma_f32_16x16x32_bf16 v[8:11], v[64:67], v[140:143], v[8:11]
    ds_read_b64 v[110:111], v239 offset:1032
    s_waitcnt lgkmcnt(15)
    v_mfma_f32_16x16x32_bf16 v[8:11], v[76:79], v[128:131], v[8:11]
    v_mfma_f32_16x16x32_bf16 v[12:15], v[60:63], v[140:143], v[12:15]
    ds_read_b128 v[176:179], v240 offset:3072
    v_mfma_f32_16x16x32_bf16 v[12:15], v[76:79], v[124:127], v[12:15]
    ds_read_b64 v[112:113], v239 offset:512
    v_mfma_f32_16x16x32_bf16 v[16:19], v[56:59], v[140:143], v[16:19]
    v_mfma_f32_16x16x32_bf16 v[16:19], v[76:79], v[120:123], v[16:19]
    ds_read_b64 v[114:115], v239 offset:520
    v_mfma_f32_16x16x32_bf16 v[8:11], v[60:63], v[144:147], v[8:11]
    ds_read_b128 v[180:183], v240 offset:3584
    v_mfma_f32_16x16x32_bf16 v[8:11], v[80:83], v[124:127], v[8:11]
    v_mfma_f32_16x16x32_bf16 v[12:15], v[56:59], v[144:147], v[12:15]
    ds_read_b64 v[116:117], v239 offset:0
    v_mfma_f32_16x16x32_bf16 v[12:15], v[80:83], v[120:123], v[12:15]
    ds_read_b64 v[118:119], v239 offset:8
    v_mfma_f32_16x16x32_bf16 v[8:11], v[56:59], v[148:151], v[8:11]
    v_mfma_f32_16x16x32_bf16 v[8:11], v[84:87], v[120:123], v[8:11]
    ds_read_b64 v[184:185], v242 offset:1536
    ds_read_b64 v[188:189], v242 offset:1024
    ds_read_b64 v[192:193], v242 offset:512
    ds_read_b64 v[196:197], v242 offset:0
    ds_read_b64 v[200:201], v243 offset:0
    v_mov_b32 v2, 161824
    ds_read_b64 v[230:231], v2
    v_mov_b32 v2, 161820
    s_mov_b32 s17, 0
L_mega_kernel_ls_24:
    ds_read_b32 v3, v2
    s_waitcnt lgkmcnt(0)
    v_cmp_gt_u32 vcc, 4, v3
    s_cbranch_vccz L_mega_kernel_lo_25
    s_add_u32 s17, s17, 1
    s_sleep 1
    s_cmp_lt_u32 s17, 0x400000
    s_cbranch_scc1 L_mega_kernel_ls_24
L_mega_kernel_lo_25:
    v_readfirstlane_b32 s20, v230
    v_readfirstlane_b32 s21, v231
    v_mfma_f32_16x16x32_bf16 v[36:39], v[88:91], v[152:155], v[36:39]
    ds_read_b128 v[120:123], v251 offset:0
    v_lshlrev_b32 v186, 16, v185
    v_mfma_f32_16x16x32_bf16 v[28:31], v[92:95], v[156:159], v[28:31]
    ds_read_b64 v[56:57], v250 offset:3584
    v_mfma_f32_16x16x32_bf16 v[32:35], v[88:91], v[156:159], v[32:35]
    v_and_b32 v187, 0xffff0000, v185
    v_mfma_f32_16x16x32_bf16 v[32:35], v[92:95], v[152:155], v[32:35]
    ds_read_b64 v[58:59], v250 offset:3592
    v_and_b32 v185, 0xffff0000, v184
    v_mfma_f32_16x16x32_bf16 v[20:23], v[96:99], v[160:163], v[20:23]
    ds_read_b128 v[124:127], v251 offset:512
    v_mfma_f32_16x16x32_bf16 v[24:27], v[92:95], v[160:163], v[24:27]
    v_lshlrev_b32 v184, 16, v184
    v_mfma_f32_16x16x32_bf16 v[24:27], v[96:99], v[156:159], v[24:27]
    ds_read_b64 v[60:61], v250 offset:3072
    v_mfma_f32_16x16x32_bf16 v[28:31], v[88:91], v[160:163], v[28:31]
    v_lshlrev_b32 v190, 16, v189
    ds_read_b64 v[62:63], v250 offset:3080
    v_mfma_f32_16x16x32_bf16 v[28:31], v[96:99], v[152:155], v[28:31]
    v_and_b32 v191, 0xffff0000, v189
    v_mfma_f32_16x16x32_bf16 v[12:15], v[100:103], v[164:167], v[12:15]
    ds_read_b128 v[128:131], v251 offset:1024
    v_mfma_f32_16x16x32_bf16 v[16:19], v[96:99], v[164:167], v[16:19]
    v_and_b32 v189, 0xffff0000, v188
    v_mfma_f32_16x16x32_bf16 v[16:19], v[100:103], v[160:163], v[16:19]
    ds_read_b64 v[64:65], v250 offset:2560
    v_lshlrev_b32 v188, 16, v188
    v_mfma_f32_16x16x32_bf16 v[20:23], v[92:95], v[164:167], v[20:23]
    ds_read_b64 v[66:67], v250 offset:2568
    v_mfma_f32_16x16x32_bf16 v[20:23], v[100:103], v[156:159], v[20:23]
    v_lshlrev_b32 v194, 16, v193
    v_mfma_f32_16x16x32_bf16 v[24:27], v[88:91], v[164:167], v[24:27]
    ds_read_b128 v[132:135], v251 offset:1536
    v_mfma_f32_16x16x32_bf16 v[24:27], v[100:103], v[152:155], v[24:27]
    v_and_b32 v195, 0xffff0000, v193
    ds_read_b64 v[68:69], v250 offset:2048
    v_mfma_f32_16x16x32_bf16 v[8:11], v[100:103], v[168:171], v[8:11]
    v_and_b32 v193, 0xffff0000, v192
    v_mfma_f32_16x16x32_bf16 v[8:11], v[104:107], v[164:167], v[8:11]
    ds_read_b64 v[70:71], v250 offset:2056
    v_mfma_f32_16x16x32_bf16 v[12:15], v[96:99], v[168:171], v[12:15]
    v_lshlrev_b32 v192, 16, v192
    v_mfma_f32_16x16x32_bf16 v[12:15], v[104:107], v[160:163], v[12:15]
    ds_read_b128 v[136:139], v251 offset:2048
    v_lshlrev_b32 v198, 16, v197
    v_mfma_f32_16x16x32_bf16 v[16:19], v[92:95], v[168:171], v[16:19]
    ds_read_b64 v[72:73], v250 offset:1536
    v_mfma_f32_16x16x32_bf16 v[16:19], v[104:107], v[156:159], v[16:19]
    v_and_b32 v199, 0xffff0000, v197
    v_mfma_f32_16x16x32_bf16 v[20:23], v[88:91], v[168:171], v[20:23]
    ds_read_b64 v[74:75], v250 offset:1544
    v_mfma_f32_16x16x32_bf16 v[20:23], v[104:107], v[152:155], v[20:23]
    v_and_b32 v197, 0xffff0000, v196
    ds_read_b128 v[140:143], v251 offset:2560
    v_mfma_f32_16x16x32_bf16 v[8:11], v[96:99], v[172:175], v[8:11]
    v_lshlrev_b32 v196, 16, v196
    v_mfma_f32_16x16x32_bf16 v[8:11], v[108:111], v[160:163], v[8:11]
    ds_read_b64 v[76:77], v250 offset:1024
    v_mfma_f32_16x16x32_bf16 v[12:15], v[92:95], v[172:175], v[12:15]
    v_lshlrev_b32 v202, 16, v201
    v_mfma_f32_16x16x32_bf16 v[12:15], v[108:111], v[156:159], v[12:15]
    ds_read_b64 v[78:79], v250 offset:1032
    v_and_b32 v203, 0xffff0000, v201
    v_mfma_f32_16x16x32_bf16 v[16:19], v[88:91], v[172:175], v[16:19]
    ds_read_b128 v[144:147], v251 offset:3072
    v_mfma_f32_16x16x32_bf16 v[16:19], v[108:111], v[152:155], v[16:19]
    v_and_b32 v201, 0xffff0000, v200
    v_mfma_f32_16x16x32_bf16 v[8:11], v[92:95], v[176:179], v[8:11]
    ds_read_b64 v[80:81], v250 offset:512
    v_mfma_f32_16x16x32_bf16 v[8:11], v[112:115], v[156:159], v[8:11]
    v_lshlrev_b32 v200, 16, v200
    ds_read_b64 v[82:83], v250 offset:520
    v_mfma_f32_16x16x32_bf16 v[12:15], v[88:91], v[176:179], v[12:15]
    ds_read_b128 v[148:151], v251 offset:3584
    v_mfma_f32_16x16x32_bf16 v[12:15], v[112:115], v[152:155], v[12:15]
    ds_read_b64 v[84:85], v250 offset:0
    v_mfma_f32_16x16x32_bf16 v[8:11], v[88:91], v[180:183], v[8:11]
    ds_read_b64 v[86:87], v250 offset:8
    v_mfma_f32_16x16x32_bf16 v[8:11], v[116:119], v[152:155], v[8:11]
    v_subrev_u32 v250, 64, v250
    v_subrev_u32 v251, 64, v251
    s_bitcmp1_b32 s16, 0
    s_nop 3
    s_cbranch_scc1 L_mega_kernel_odd_26
    ds_write_b128 v246, v[24:27] offset:0
    ds_write_b128 v246, v[28:31] offset:1024
    ds_write_b128 v246, v[32:35] offset:2048
    ds_write_b128 v246, v[36:39] offset:3072
    s_branch L_mega_kernel_j_27
L_mega_kernel_odd_26:
    ds_write_b128 v246, v[8:11] offset:0
    ds_write_b128 v246, v[12:15] offset:1024
    ds_write_b128 v246, v[16:19] offset:2048
    ds_write_b128 v246, v[20:23] offset:3072
    v_mov_b32 v8, v24
    v_mov_b32 v9, v25
    v_mov_b32 v10, v26
    v_mov_b32 v11, v27
    v_mov_b32 v12, v28
    v_mov_b32 v13, v29
    v_mov_b32 v14, v30
    v_mov_b32 v15, v31
    v_mov_b32 v16, v32
    v_mov_b32 v17, v33
    v_mov_b32 v18, v34
    v_mov_b32 v19, v35
    v_mov_b32 v20, v36
    v_mov_b32 v21, v37
    v_mov_b32 v22, v38
    v_mov_b32 v23, v39
L_mega_kernel_j_27:
    v_mov_b32 v2, 161816
    v_mov_b32 v3, 1
    s_waitcnt lgkmcnt(0)
    s_mov_b64 exec, 1
    ds_add_u32 v2, v3
    s_mov_b64 exec, -1
    v_pk_add_f32 v[8:9], v[8:9], v[184:185]
    v_pk_add_f32 v[10:11], v[10:11], v[186:187]
    v_pk_add_f32 v[12:13], v[12:13], v[188:189]
    v_pk_add_f32 v[14:15], v[14:15], v[190:191]
    v_pk_add_f32 v[16:17], v[16:17], v[192:193]
    v_pk_add_f32 v[18:19], v[18:19], v[194:195]
    v_pk_add_f32 v[20:21], v[20:21], v[196:197]
    v_pk_add_f32 v[22:23], v[22:23], v[198:199]
    s_add_u32 s60, s6, 0x940000
    s_addc_u32 s61, s7, 0
    s_mov_b32 s62, 0x30000
    s_mov_b32 s63, 0x00020000
    v_mov_b32 v2, 161816
    s_mov_b32 s17, 0
L_mega_kernel_ls_28:
    ds_read_b32 v3, v2
    s_waitcnt lgkmcnt(0)
    v_cmp_gt_u32 vcc, 4, v3
    s_cbranch_vccz L_mega_kernel_lo_29
    s_add_u32 s17, s17, 1
    s_sleep 1
    s_cmp_lt_u32 s17, 0x400000
    s_cbranch_scc1 L_mega_kernel_ls_28
L_mega_kernel_lo_29:
    ds_read_b128 v[204:207], v247 offset:0
    ds_read_b128 v[208:211], v247 offset:1024
    ds_read_b128 v[212:215], v247 offset:2048
    ds_read_b128 v[216:219], v247 offset:3072
    s_waitcnt lgkmcnt(3)
    v_pk_add_f32 v[8:9], v[8:9], v[204:205]
    v_pk_add_f32 v[10:11], v[10:11], v[206:207]
    v_cvt_pk_bf16_f32 v220, v8, v9
    v_cvt_pk_bf16_f32 v221, v10, v11
    buffer_store_dwordx2 v[220:221], v236, s[64:67], s82 offen sc0 sc1
    s_waitcnt lgkmcnt(2)
    v_pk_add_f32 v[12:13], v[12:13], v[208:209]
    v_pk_add_f32 v[14:15], v[14:15], v[210:211]
    v_cvt_pk_bf16_f32 v222, v12, v13
    v_cvt_pk_bf16_f32 v223, v14, v15
    buffer_store_dwordx2 v[222:223], v236, s[64:67], s81 offen sc0 sc1
    s_waitcnt lgkmcnt(1)
    v_pk_add_f32 v[16:17], v[16:17], v[212:213]
    v_pk_add_f32 v[18:19], v[18:19], v[214:215]
    v_cvt_pk_bf16_f32 v224, v16, v17
    v_cvt_pk_bf16_f32 v225, v18, v19
    buffer_store_dwordx2 v[224:225], v236, s[64:67], s80 offen sc0 sc1
    s_waitcnt lgkmcnt(0)
    v_pk_add_f32 v[20:21], v[20:21], v[216:217]
    v_pk_add_f32 v[22:23], v[22:23], v[218:219]
    v_cvt_pk_bf16_f32 v226, v20, v21
    v_cvt_pk_bf16_f32 v227, v22, v23
    buffer_store_dwordx2 v[226:227], v236, s[64:67], s40 offen sc0 sc1
    s_cmp_eq_u32 s52, 1
    s_cbranch_scc1 L_mega_kernel_xb_30
    v_mfma_f32_16x16x32_bf16 v[52:55], v[56:59], v[120:123], v[52:55]
    ds_read_b128 v[152:155], v251 offset:0
    ds_read_b64 v[88:89], v250 offset:3584
    v_mfma_f32_16x16x32_bf16 v[48:51], v[56:59], v[124:127], v[48:51]
    ds_read_b64 v[90:91], v250 offset:3592
    v_mfma_f32_16x16x32_bf16 v[48:51], v[60:63], v[120:123], v[48:51]
    ds_read_b128 v[156:159], v251 offset:512
    ds_read_b64 v[92:93], v250 offset:3072
    v_mfma_f32_16x16x32_bf16 v[44:47], v[68:71], v[132:135], v[44:47]
    ds_read_b64 v[94:95], v250 offset:3080
    v_mfma_f32_16x16x32_bf16 v[40:43], v[68:71], v[136:139], v[40:43]
    ds_read_b128 v[164:167], v251 offset:1536
    ds_read_b64 v[100:101], v250 offset:2048
    v_mfma_f32_16x16x32_bf16 v[40:43], v[72:75], v[132:135], v[40:43]
    ds_read_b64 v[102:103], v250 offset:2056
    v_mfma_f32_16x16x32_bf16 v[44:47], v[64:67], v[136:139], v[44:47]
    ds_read_b128 v[168:171], v251 offset:2048
    v_mfma_f32_16x16x32_bf16 v[44:47], v[72:75], v[128:131], v[44:47]
    ds_read_b64 v[104:105], v250 offset:1536
    ds_read_b64 v[106:107], v250 offset:1544
    v_mfma_f32_16x16x32_bf16 v[40:43], v[64:67], v[140:143], v[40:43]
    ds_read_b64 v[96:97], v250 offset:2560
    v_mfma_f32_16x16x32_bf16 v[40:43], v[76:79], v[128:131], v[40:43]
    ds_read_b64 v[98:99], v250 offset:2568
    ds_read_b128 v[160:163], v251 offset:1024
    v_mfma_f32_16x16x32_bf16 v[44:47], v[60:63], v[140:143], v[44:47]
    ds_read_b128 v[172:175], v251 offset:2560
    v_mfma_f32_16x16x32_bf16 v[44:47], v[76:79], v[124:127], v[44:47]
    ds_read_b64 v[108:109], v250 offset:1024
    v_mfma_f32_16x16x32_bf16 v[40:43], v[60:63], v[144:147], v[40:43]
    ds_read_b64 v[110:111], v250 offset:1032
    ds_read_b128 v[176:179], v251 offset:3072
    v_mfma_f32_16x16x32_bf16 v[40:43], v[80:83], v[124:127], v[40:43]
    ds_read_b64 v[112:113], v250 offset:512
    v_mfma_f32_16x16x32_bf16 v[44:47], v[56:59], v[144:147], v[44:47]
    ds_read_b64 v[114:115], v250 offset:520
    ds_read_b128 v[180:183], v251 offset:3584
    v_mfma_f32_16x16x32_bf16 v[44:47], v[80:83], v[120:123], v[44:47]
    ds_read_b64 v[116:117], v250 offset:0
    v_mfma_f32_16x16x32_bf16 v[40:43], v[56:59], v[148:151], v[40:43]
    ds_read_b64 v[118:119], v250 offset:8
    v_mfma_f32_16x16x32_bf16 v[40:43], v[84:87], v[120:123], v[40:43]
    s_waitcnt lgkmcnt(15)
    v_mfma_f32_16x16x32_bf16 v[52:55], v[88:91], v[152:155], v[52:55]
    v_mfma_f32_16x16x32_bf16 v[48:51], v[88:91], v[156:159], v[48:51]
    v_mfma_f32_16x16x32_bf16 v[48:51], v[92:95], v[152:155], v[48:51]
    v_mfma_f32_16x16x32_bf16 v[44:47], v[100:103], v[164:167], v[44:47]
    s_waitcnt lgkmcnt(14)
    v_mfma_f32_16x16x32_bf16 v[40:43], v[100:103], v[168:171], v[40:43]
    s_waitcnt lgkmcnt(12)
    v_mfma_f32_16x16x32_bf16 v[40:43], v[104:107], v[164:167], v[40:43]
    s_waitcnt lgkmcnt(10)
    v_mfma_f32_16x16x32_bf16 v[44:47], v[96:99], v[168:171], v[44:47]
    s_waitcnt lgkmcnt(9)
    v_mfma_f32_16x16x32_bf16 v[44:47], v[104:107], v[160:163], v[44:47]
    s_waitcnt lgkmcnt(8)
    v_mfma_f32_16x16x32_bf16 v[40:43], v[96:99], v[172:175], v[40:43]
    s_waitcnt lgkmcnt(6)
    v_mfma_f32_16x16x32_bf16 v[40:43], v[108:111], v[160:163], v[40:43]
    v_mfma_f32_16x16x32_bf16 v[44:47], v[92:95], v[172:175], v[44:47]
    v_mfma_f32_16x16x32_bf16 v[44:47], v[108:111], v[156:159], v[44:47]
    s_waitcnt lgkmcnt(5)
    v_mfma_f32_16x16x32_bf16 v[40:43], v[92:95], v[176:179], v[40:43]
    s_waitcnt lgkmcnt(3)
    v_mfma_f32_16x16x32_bf16 v[40:43], v[112:115], v[156:159], v[40:43]
    v_mfma_f32_16x16x32_bf16 v[44:47], v[88:91], v[176:179], v[44:47]
    v_mfma_f32_16x16x32_bf16 v[44:47], v[112:115], v[152:155], v[44:47]
    s_waitcnt lgkmcnt(2)
    v_mfma_f32_16x16x32_bf16 v[40:43], v[88:91], v[180:183], v[40:43]
    s_waitcnt lgkmcnt(0)
    v_mfma_f32_16x16x32_bf16 v[40:43], v[116:119], v[152:155], v[40:43]
    s_branch L_mega_kernel_xp_31
L_mega_kernel_xb_30:
    v_mfma_f32_16x16x32_bf16 v[52:55], v[60:63], v[124:127], v[52:55]
    ds_read_b128 v[156:159], v251 offset:512
    ds_read_b64 v[92:93], v250 offset:3072
    v_mfma_f32_16x16x32_bf16 v[44:47], v[64:67], v[128:131], v[44:47]
    ds_read_b64 v[94:95], v250 offset:3080
    v_mfma_f32_16x16x32_bf16 v[48:51], v[60:63], v[128:131], v[48:51]
    ds_read_b128 v[160:163], v251 offset:1024
    v_mfma_f32_16x16x32_bf16 v[48:51], v[64:67], v[124:127], v[48:51]
    ds_read_b64 v[96:97], v250 offset:2560
    v_mfma_f32_16x16x32_bf16 v[52:55], v[56:59], v[128:131], v[52:55]
    ds_read_b64 v[98:99], v250 offset:2568
    v_mfma_f32_16x16x32_bf16 v[52:55], v[64:67], v[120:123], v[52:55]
    ds_read_b64 v[88:89], v250 offset:3584
    v_mfma_f32_16x16x32_bf16 v[40:43], v[64:67], v[132:135], v[40:43]
    ds_read_b64 v[90:91], v250 offset:3592
    v_mfma_f32_16x16x32_bf16 v[40:43], v[68:71], v[128:131], v[40:43]
    ds_read_b128 v[152:155], v251 offset:0
    v_mfma_f32_16x16x32_bf16 v[44:47], v[60:63], v[132:135], v[44:47]
    ds_read_b128 v[164:167], v251 offset:1536
    v_mfma_f32_16x16x32_bf16 v[44:47], v[68:71], v[124:127], v[44:47]
    ds_read_b64 v[100:101], v250 offset:2048
    v_mfma_f32_16x16x32_bf16 v[48:51], v[56:59], v[132:135], v[48:51]
    ds_read_b64 v[102:103], v250 offset:2056
    v_mfma_f32_16x16x32_bf16 v[48:51], v[68:71], v[120:123], v[48:51]
    ds_read_b128 v[168:171], v251 offset:2048
    v_mfma_f32_16x16x32_bf16 v[40:43], v[60:63], v[136:139], v[40:43]
    ds_read_b64 v[104:105], v250 offset:1536
    v_mfma_f32_16x16x32_bf16 v[40:43], v[72:75], v[124:127], v[40:43]
    ds_read_b64 v[106:107], v250 offset:1544
    v_mfma_f32_16x16x32_bf16 v[44:47], v[56:59], v[136:139], v[44:47]
    ds_read_b128 v[172:175], v251 offset:2560
    v_mfma_f32_16x16x32_bf16 v[44:47], v[72:75], v[120:123], v[44:47]
    ds_read_b64 v[108:109], v250 offset:1024
    v_mfma_f32_16x16x32_bf16 v[40:43], v[56:59], v[140:143], v[40:43]
    ds_read_b64 v[110:111], v250 offset:1032
    v_mfma_f32_16x16x32_bf16 v[40:43], v[76:79], v[120:123], v[40:43]
    s_waitcnt lgkmcnt(15)
    v_mfma_f32_16x16x32_bf16 v[52:55], v[92:95], v[156:159], v[52:55]
    s_waitcnt lgkmcnt(12)
    v_mfma_f32_16x16x32_bf16 v[44:47], v[96:99], v[160:163], v[44:47]
    v_mfma_f32_16x16x32_bf16 v[48:51], v[92:95], v[160:163], v[48:51]
    v_mfma_f32_16x16x32_bf16 v[48:51], v[96:99], v[156:159], v[48:51]
    s_waitcnt lgkmcnt(10)
    v_mfma_f32_16x16x32_bf16 v[52:55], v[88:91], v[160:163], v[52:55]
    s_waitcnt lgkmcnt(9)
    v_mfma_f32_16x16x32_bf16 v[52:55], v[96:99], v[152:155], v[52:55]
    s_waitcnt lgkmcnt(8)
    v_mfma_f32_16x16x32_bf16 v[40:43], v[96:99], v[164:167], v[40:43]
    s_waitcnt lgkmcnt(6)
    v_mfma_f32_16x16x32_bf16 v[40:43], v[100:103], v[160:163], v[40:43]
    v_mfma_f32_16x16x32_bf16 v[44:47], v[92:95], v[164:167], v[44:47]
    v_mfma_f32_16x16x32_bf16 v[44:47], v[100:103], v[156:159], v[44:47]
    v_mfma_f32_16x16x32_bf16 v[48:51], v[88:91], v[164:167], v[48:51]
    v_mfma_f32_16x16x32_bf16 v[48:51], v[100:103], v[152:155], v[48:51]
    s_waitcnt lgkmcnt(5)
    v_mfma_f32_16x16x32_bf16 v[40:43], v[92:95], v[168:171], v[40:43]
    s_waitcnt lgkmcnt(3)
    v_mfma_f32_16x16x32_bf16 v[40:43], v[104:107], v[156:159], v[40:43]
    v_mfma_f32_16x16x32_bf16 v[44:47], v[88:91], v[168:171], v[44:47]
    v_mfma_f32_16x16x32_bf16 v[44:47], v[104:107], v[152:155], v[44:47]
    s_waitcnt lgkmcnt(2)
    v_mfma_f32_16x16x32_bf16 v[40:43], v[88:91], v[172:175], v[40:43]
    s_waitcnt lgkmcnt(0)
    v_mfma_f32_16x16x32_bf16 v[40:43], v[108:111], v[152:155], v[40:43]
L_mega_kernel_xp_31:
    s_waitcnt vmcnt(0)
    v_mov_b32 v2, 161832
    v_mov_b32 v3, 1
    s_mov_b64 exec, 1
    ds_add_rtn_u32 v3, v2, v3
    s_waitcnt lgkmcnt(0)
    v_cmp_eq_u32 vcc, 3, v3
    s_mov_b64 exec, -1
    s_cbranch_vccz L_mega_kernel_np_32
    s_lshl_b32 s17, s2, 7
    v_mov_b32 v2, 32768
    v_mov_b32 v232, s20
    v_mov_b32 v233, s21
    s_mov_b64 exec, 1
    buffer_store_dwordx2 v[232:233], v2, s[60:63], s17 offen sc0 sc1
    s_mov_b64 exec, -1
L_mega_kernel_np_32:
    ds_write_b128 v249, v[40:43] offset:0
    ds_write_b128 v249, v[44:47] offset:4096
    ds_write_b128 v249, v[48:51] offset:8192
    ds_write_b128 v249, v[52:55] offset:12288
    v_mov_b32 v2, 161844
    v_mov_b32 v3, 1
    s_waitcnt lgkmcnt(0)
    s_mov_b64 exec, 1
    ds_add_u32 v2, v3
    s_mov_b64 exec, -1
    v_lshrrev_b32 v7, 5, v1
    v_mul_u32_u24 v7, 1536, v7
    v_lshl_add_u32 v7, v1, 4, v7
    s_add_u32 s28, s6, 0x500000
    s_addc_u32 s29, s7, 0
    s_mov_b32 s30, 0x280000
    s_mov_b32 s31, 0x00020000
    s_mul_i32 s24, s15, 163840
    s_lshl_b32 s17, s22, 9
    s_add_u32 s24, s24, s17
    s_lshr_b32 s17, s16, 2
    s_mul_i32 s17, s17, 8192
    s_add_u32 s24, s24, s17
    s_and_b32 s17, s16, 1
    s_mul_i32 s17, s17, 4096
    s_sub_u32 s25, s24, s17
    s_add_u32 s25, s25, 4096
    s_add_u32 s24, s24, s17
    v_mov_b32 v2, 161844
    s_mov_b32 s17, 0
L_mega_kernel_ls_33:
    ds_read_b32 v3, v2
    s_waitcnt lgkmcnt(0)
    v_cmp_gt_u32 vcc, 4, v3
    s_cbranch_vccz L_mega_kernel_lo_34
    s_add_u32 s17, s17, 1
    s_sleep 1
    s_cmp_lt_u32 s17, 0x400000
    s_cbranch_scc1 L_mega_kernel_ls_33
L_mega_kernel_lo_34:
    ds_read_b128 v[204:207], v248 offset:0
    ds_read_b128 v[208:211], v248 offset:1024
    ds_read_b128 v[212:215], v248 offset:2048
    ds_read_b128 v[216:219], v248 offset:3072
    s_waitcnt lgkmcnt(0)
    v_pk_add_f32 v[204:205], v[204:205], v[208:209]
    v_pk_add_f32 v[212:213], v[212:213], v[216:217]
    v_pk_add_f32 v[206:207], v[206:207], v[210:211]
    v_pk_add_f32 v[214:215], v[214:215], v[218:219]
    v_pk_add_f32 v[204:205], v[204:205], v[200:201]
    v_pk_add_f32 v[206:207], v[206:207], v[202:203]
    v_pk_add_f32 v[204:205], v[204:205], v[212:213]
    v_pk_add_f32 v[206:207], v[206:207], v[214:215]
    v_cvt_pk_bf16_f32 v228, v204, v205
    v_cvt_pk_bf16_f32 v229, v206, v207
    buffer_store_dwordx2 v[228:229], v236, s[64:67], s41 offen sc0 sc1
    s_setprio 0
    s_add_u32 s17, s24, 0
    buffer_load_dwordx4 v[92:95], v7, s[28:31], s17 offen sc1
    s_add_u32 s17, s25, 0
    buffer_load_dwordx4 v[96:99], v7, s[28:31], s17 offen sc1
    s_add_u32 s17, s24, 16384
    buffer_load_dwordx4 v[100:103], v7, s[28:31], s17 offen sc1
    s_add_u32 s17, s25, 16384
    buffer_load_dwordx4 v[104:107], v7, s[28:31], s17 offen sc1
    s_add_u32 s17, s24, 32768
    buffer_load_dwordx4 v[108:111], v7, s[28:31], s17 offen sc1
    s_add_u32 s17, s25, 32768
    buffer_load_dwordx4 v[112:115], v7, s[28:31], s17 offen sc1
    s_waitcnt vmcnt(6)
    v_mov_b32 v2, 161848
    v_mov_b32 v3, 1
    s_mov_b64 exec, 1
    ds_add_rtn_u32 v3, v2, v3
    s_waitcnt lgkmcnt(0)
    v_cmp_eq_u32 vcc, 3, v3
    s_mov_b64 exec, -1
    s_cbranch_vccz L_mega_kernel_np_35
    s_lshl_b32 s17, s2, 7
    v_mov_b32 v2, 163840
    v_mov_b32 v232, s20
    v_mov_b32 v233, s21
    s_mov_b64 exec, 1
    buffer_store_dwordx2 v[232:233], v2, s[60:63], s17 offen sc0 sc1
    s_mov_b64 exec, -1
L_mega_kernel_np_35:
    s_add_u32 s17, s24, 49152
    buffer_load_dwordx4 v[116:119], v7, s[28:31], s17 offen sc1
    s_add_u32 s17, s25, 49152
    buffer_load_dwordx4 v[120:123], v7, s[28:31], s17 offen sc1
    s_add_u32 s17, s24, 65536
    buffer_load_dwordx4 v[124:127], v7, s[28:31], s17 offen sc1
    s_add_u32 s17, s25, 65536
    buffer_load_dwordx4 v[128:131], v7, s[28:31], s17 offen sc1
    s_add_u32 s17, s24, 81920
    buffer_load_dwordx4 v[132:135], v7, s[28:31], s17 offen sc1
    s_add_u32 s17, s25, 81920
    buffer_load_dwordx4 v[136:139], v7, s[28:31], s17 offen sc1
    s_add_u32 s17, s24, 98304
    buffer_load_dwordx4 v[140:143], v7, s[28:31], s17 offen sc1
    s_add_u32 s17, s25, 98304
    buffer_load_dwordx4 v[144:147], v7, s[28:31], s17 offen sc1
    s_add_u32 s17, s24, 114688
    buffer_load_dwordx4 v[148:151], v7, s[28:31], s17 offen sc1
    s_add_u32 s17, s25, 114688
    buffer_load_dwordx4 v[152:155], v7, s[28:31], s17 offen sc1
    s_add_u32 s17, s24, 131072
    buffer_load_dwordx4 v[156:159], v7, s[28:31], s17 offen sc1
    s_add_u32 s17, s25, 131072
    buffer_load_dwordx4 v[160:163], v7, s[28:31], s17 offen sc1
    s_add_u32 s17, s24, 147456
    buffer_load_dwordx4 v[164:167], v7, s[28:31], s17 offen sc1
    s_add_u32 s17, s25, 147456
    buffer_load_dwordx4 v[168:171], v7, s[28:31], s17 offen sc1
    s_branch L_mega_kernel_sym_36
L_mega_kernel_mem_3:
    s_setprio 2
    s_and_b32 s17, s2, 7
    s_lshl_b32 s17, s17, 3
    s_lshr_b32 s80, s2, 5
    s_add_u32 s80, s80, s17
    s_bfe_u32 s81, s2, 0x20003
    s_mul_i32 s82, s22, 8192
    s_add_u32 s82, s82, 86656
    v_mul_u32_u24 v3, 13108, v1
    v_lshrrev_b32 v3, 16, v3
    v_mul_u32_u24 v78, 1200, v3
    v_add_u32 v78, v78, v4
    s_mul_i32 s85, s80, 40960
    s_lshl_b32 s17, s81, 2
    s_add_u32 s17, s17, s22
    s_mul_i32 s18, s17, 80
    s_add_u32 s85, s85, s18
    s_lshl_b32 s18, s80, 4
    s_add_u32 s17, s17, s18
    s_mul_i32 s80, s17, 2560
    s_lshl_b32 s17, s17, 1
    v_and_b32 v80, 1, v6
    v_add_u32 v80, s17, v80
    v_mul_u32_u24 v79, 1280, v80
    v_lshl_add_u32 v79, v5, 4, v79
    v_lshlrev_b32 v2, 2, v5
    v_add_u32 v2, 161792, v2
    v_mov_b32 v3, 0
    ds_write_b32 v2, v3
    s_waitcnt lgkmcnt(0)
    s_mov_b32 s88, s32
    s_mov_b32 s89, s33
    s_mov_b32 s90, 0x280000
    s_mov_b32 s91, 0x00020000
    s_mov_b32 exec_hi, 0x0fffffff
    s_add_u32 m0, s82, 0
    s_nop 0
    buffer_load_dwordx4 v78, s[88:91], s85 offen lds
    s_add_u32 s85, s85, 15360
    s_add_u32 m0, s82, 960
    s_nop 0
    buffer_load_dwordx4 v78, s[88:91], s85 offen lds
    s_add_u32 s85, s85, 15360
    s_add_u32 m0, s82, 1920
    s_mov_b32 exec_hi, 0xff
    buffer_load_dwordx4 v78, s[88:91], s85 offen lds
    s_mov_b64 exec, -1
    buffer_load_dwordx4 v[12:15], v79, s[88:91], 0 offen offset:0
    buffer_load_dwordx4 v[16:19], v79, s[88:91], 0 offen offset:256
    buffer_load_dwordx4 v[20:23], v79, s[88:91], 0 offen offset:512
    buffer_load_dwordx4 v[24:27], v79, s[88:91], 0 offen offset:768
    buffer_load_dwordx4 v[28:31], v79, s[88:91], 0 offen offset:1024
    s_barrier
    v_mov_b32 v69, s55
    v_mov_b32 v71, 2
    v_and_b32 v3, 31, v1
    s_lshl_b32 s17, s22, 5
    v_add_u32 v2, s17, v3
    v_lshlrev_b32 v68, 7, v69
    v_add_lshl_u32 v68, v68, v2, 1
    v_lshlrev_b32 v69, 1, v69
    s_mov_b32 s60, s34
    s_mov_b32 s61, s35
    s_mov_b32 s62, 0x28000
    s_mov_b32 s63, 0x00020000
    buffer_load_ushort v64, v68, s[60:63], 0 offen
    s_mov_b32 s64, s36
    s_mov_b32 s65, s37
    s_mov_b32 s66, 0x28000
    s_mov_b32 s67, 0x00020000
    buffer_load_ushort v65, v68, s[64:67], 0 offen
    s_mov_b32 s68, s38
    s_mov_b32 s69, s39
    s_mov_b32 s70, 0x28000
    s_mov_b32 s71, 0x00020000
    buffer_load_ushort v66, v68, s[68:71], 0 offen
    s_mov_b32 s72, s40
    s_mov_b32 s73, s41
    s_mov_b32 s74, 0x28000
    s_mov_b32 s75, 0x00020000
    buffer_load_ushort v67, v68, s[72:75], 0 offen
    s_mov_b32 s76, s42
    s_mov_b32 s77, s43
    s_mov_b32 s78, 0x500
    s_mov_b32 s79, 0x00020000
    buffer_load_ushort v70, v69, s[76:79], 0 offen
    s_mov_b32 s76, s44
    s_mov_b32 s77, s45
    s_mov_b32 s78, 0x500
    s_mov_b32 s79, 0x00020000
    v_mov_b32 v2, 0
    s_lshl_b32 s17, s55, 1
    buffer_load_ushort v117, v2, s[76:79], s17 offen
    s_lshl_b32 s83, s2, 2
    s_add_u32 s83, s83, s22
    s_mov_b32 s84, 0x3f803f80
    v_and_b32 v84, 3, v1
    v_lshlrev_b32 v84, 3, v84
    v_add_u32 v84, s82, v84
    v_bfe_u32 v85, v1, 2, 2
    v_lshl_add_u32 v2, v6, 3, v85
    v_mul_u32_u24 v81, 80, v2
    v_add_u32 v81, v81, v84
    v_lshlrev_b32 v82, 6, v5
    v_lshl_add_u32 v82, v6, 4, v82
    v_add_u32 v82, s82, v82
    v_add_u32 v83, s82, v4
    v_mov_b32 v86, 0
    v_mov_b32 v87, 0
    s_add_u32 s92, s6, 0x280000
    s_addc_u32 s93, s7, 0
    s_mov_b32 s94, 0x280000
    s_mov_b32 s95, 0x00020000
    v_lshlrev_b32 v90, 2, v80
    s_mov_b32 exec_lo, 0
    v_add_u32 v90, 8192, v90
    s_mov_b64 exec, -1
    v_lshl_add_u32 v141, v6, 5, v84
    v_mov_b32 v142, 0
    s_cmp_ge_u32 s83, 640
    s_cbranch_scc1 L_mega_kernel_wo_37
    s_mul_i32 s17, s83, 1639
    s_lshr_b32 s17, s17, 16
    s_mul_i32 s18, s17, 40
    s_sub_u32 s18, s83, s18
    s_mul_i32 s38, s18, 69120
    s_sub_u32 s36, s18, 32
    s_mul_i32 s36, s36, 276480
    s_add_u32 s36, s36, 6912
    s_cmp_lt_u32 s18, 32
    s_cselect_b32 s38, s38, s36
    s_mov_b32 s35, 17280
    s_cselect_b32 s35, s35, 69120
    s_cselect_b32 s36, 0, 1
    s_mul_i32 s18, s17, 224
    s_add_u32 s38, s38, s18
    s_cmp_lt_u32 s17, 8
    s_mov_b32 s18, 1728
    s_cselect_b32 s18, s18, 4294965504
    s_add_u32 s38, s38, s18
    s_mov_b32 s72, s48
    s_mov_b32 s73, s49
    s_mov_b32 s74, 0x21c000
    s_mov_b32 s75, 0x00020000
    v_mul_u32_u24 v3, 4682, v1
    v_lshrrev_b32 v3, 16, v3
    v_mul_u32_u24 v143, 3232, v3
    v_add_u32 v143, v143, v4
    v_lshrrev_b32 v2, 1, v3
    v_lshlrev_b32 v3, 2, v3
    s_cmp_eq_u32 s36, 0
    s_cselect_b64 vcc, -1, 0
    v_cndmask_b32 v2, v3, v2, vcc
    v_mul_u32_u24 v2, 3456, v2
    v_add_u32 v143, v143, v2
    s_mov_b32 s36, 4
    s_mov_b32 s34, 896
    s_mov_b32 s37, 0x00ffffff
    v_mul_u32_u24 v140, 224, v85
    v_add_u32 v140, v140, v141
    s_add_u32 s76, s6, 0x500000
    s_addc_u32 s77, s7, 0
    s_mov_b32 s78, 0x280000
    s_mov_b32 s79, 0x00020000
    s_lshl_b32 s39, s83, 12
    s_mov_b32 s40, 0
    s_branch L_mega_kernel_j1_39
L_mega_kernel_wo_37:
    s_cmp_ge_u32 s83, 856
    s_cbranch_scc1 L_mega_kernel_cs_38
    s_sub_u32 s40, s83, 640
    s_mul_i32 s17, s40, 2428
    s_lshr_b32 s17, s17, 16
    s_mul_i32 s18, s17, 27
    s_sub_u32 s18, s40, s18
    s_mul_i32 s38, s18, 40960
    s_mul_i32 s18, s17, 160
    s_add_u32 s38, s38, s18
    s_mov_b32 s72, s50
    s_mov_b32 s73, s51
    s_mov_b32 s74, 0x10e000
    s_mov_b32 s75, 0x00020000
    v_mul_u32_u24 v3, 6554, v1
    v_lshrrev_b32 v3, 16, v3
    v_mul_u32_u24 v143, 1120, v3
    v_add_u32 v143, v143, v4
    s_mov_b32 s36, 8
    s_mov_b32 s34, 640
    s_mov_b32 s35, 5120
    s_mov_b32 s37, 0xff
    v_mul_u32_u24 v2, 160, v85
    v_add_u32 v140, v2, v141
    v_add_u32 v141, v2, v84
    v_lshrrev_b32 v2, 1, v6
    v_mul_u32_u24 v2, 1280, v2
    v_mul_u32_u24 v3, 640, v6
    v_add3_u32 v141, v141, v2, v3
    v_mul_u32_u24 v142, 1280, v6
    v_lshl_add_u32 v142, v5, 4, v142
    s_add_u32 s76, s6, 0x780000
    s_addc_u32 s77, s7, 0
    s_mov_b32 s78, 0x10e000
    s_mov_b32 s79, 0x00020000
    s_mul_i32 s39, s40, 5120
    s_mov_b32 s40, 1
    s_branch L_mega_kernel_j1_39
L_mega_kernel_cs_38:
    v_mov_b32 v143, 0
    v_mov_b32 v140, 0
    s_mov_b32 s36, 0
    s_mov_b32 s34, 0
    s_mov_b32 s35, 0
    s_mov_b32 s37, 0
    s_mov_b32 s38, 0
    s_mov_b32 s39, 0
    s_mov_b32 s40, 2
    s_mov_b32 s72, s48
    s_mov_b32 s73, s49
    s_mov_b32 s74, 0x0
    s_mov_b32 s75, 0x00020000
    s_mov_b32 s76, s48
    s_mov_b32 s77, s49
    s_mov_b32 s78, 0x0
    s_mov_b32 s79, 0x00020000
L_mega_kernel_j1_39:
    s_mov_b32 s68, s4
    s_mov_b32 s69, s5
    s_mov_b32 s70, 0x100
    s_mov_b32 s71, 0x00020000
    v_mov_b32 v2, 0
    buffer_load_dwordx2 v[96:97], v2, s[68:71], 0 offen sc1
    s_waitcnt vmcnt(12)
    ds_read_b64_tr_b16 v[32:33], v81 offset:0
    ds_read_b64_tr_b16 v[34:35], v81 offset:320
    ds_read_b64_tr_b16 v[36:37], v81 offset:32
    ds_read_b64_tr_b16 v[38:39], v81 offset:352
    ds_read_b64_tr_b16 v[40:41], v81 offset:64
    ds_read_b64_tr_b16 v[42:43], v81 offset:384
    s_waitcnt lgkmcnt(0)
    ds_write_b128 v82, v[32:35] offset:0
    ds_write_b128 v82, v[36:39] offset:1024
    ds_write_b128 v82, v[40:43] offset:2048
    ds_read_b128 v[32:35], v83 offset:0
    ds_read_b128 v[36:39], v83 offset:1024
    ds_read_b128 v[40:43], v83 offset:2048
    s_add_u32 s88, s6, 0x900000
    s_addc_u32 s89, s7, 0
    s_mov_b32 s90, 0x4000
    s_mov_b32 s91, 0x00020000
    s_waitcnt lgkmcnt(0)
    buffer_store_dwordx4 v[32:35], v4, s[92:95], s80 offen offset:0 sc0 sc1
    buffer_store_dwordx4 v[36:39], v4, s[92:95], s80 offen offset:1024 sc0 sc1
    s_mov_b32 exec_hi, 0
    buffer_store_dwordx4 v[40:43], v4, s[92:95], s80 offen offset:2048 sc0 sc1
    s_mov_b64 exec, -1
    s_waitcnt vmcnt(10)
    v_dot2_f32_bf16 v86, v12, s84, v86
    v_dot2_f32_bf16 v87, v12, v12, v87
    v_dot2_f32_bf16 v86, v13, s84, v86
    v_dot2_f32_bf16 v87, v13, v13, v87
    v_dot2_f32_bf16 v86, v14, s84, v86
    v_dot2_f32_bf16 v87, v14, v14, v87
    v_dot2_f32_bf16 v86, v15, s84, v86
    v_dot2_f32_bf16 v87, v15, v15, v87
    v_dot2_f32_bf16 v86, v16, s84, v86
    v_dot2_f32_bf16 v87, v16, v16, v87
    v_dot2_f32_bf16 v86, v17, s84, v86
    v_dot2_f32_bf16 v87, v17, v17, v87
    v_dot2_f32_bf16 v86, v18, s84, v86
    v_dot2_f32_bf16 v87, v18, v18, v87
    v_dot2_f32_bf16 v86, v19, s84, v86
    v_dot2_f32_bf16 v87, v19, v19, v87
    v_dot2_f32_bf16 v86, v20, s84, v86
    v_dot2_f32_bf16 v87, v20, v20, v87
    v_dot2_f32_bf16 v86, v21, s84, v86
    v_dot2_f32_bf16 v87, v21, v21, v87
    v_dot2_f32_bf16 v86, v22, s84, v86
    v_dot2_f32_bf16 v87, v22, v22, v87
    v_dot2_f32_bf16 v86, v23, s84, v86
    v_dot2_f32_bf16 v87, v23, v23, v87
    v_dot2_f32_bf16 v86, v24, s84, v86
    v_dot2_f32_bf16 v87, v24, v24, v87
    v_dot2_f32_bf16 v86, v25, s84, v86
    v_dot2_f32_bf16 v87, v25, v25, v87
    v_dot2_f32_bf16 v86, v26, s84, v86
    v_dot2_f32_bf16 v87, v26, v26, v87
    v_dot2_f32_bf16 v86, v27, s84, v86
    v_dot2_f32_bf16 v87, v27, v27, v87
    v_dot2_f32_bf16 v86, v28, s84, v86
    v_dot2_f32_bf16 v87, v28, v28, v87
    v_dot2_f32_bf16 v86, v29, s84, v86
    v_dot2_f32_bf16 v87, v29, v29, v87
    v_dot2_f32_bf16 v86, v30, s84, v86
    v_dot2_f32_bf16 v87, v30, v30, v87
    v_dot2_f32_bf16 v86, v31, s84, v86
    v_dot2_f32_bf16 v87, v31, v31, v87
    s_nop 1
    v_add_f32_dpp v86, v86, v86 row_ror:8 row_mask:0xf bank_mask:0xf
    v_add_f32_dpp v87, v87, v87 row_ror:8 row_mask:0xf bank_mask:0xf
    s_nop 0
    v_add_f32_dpp v86, v86, v86 row_ror:4 row_mask:0xf bank_mask:0xf
    v_add_f32_dpp v87, v87, v87 row_ror:4 row_mask:0xf bank_mask:0xf
    s_nop 0
    v_add_f32_dpp v86, v86, v86 row_ror:2 row_mask:0xf bank_mask:0xf
    v_add_f32_dpp v87, v87, v87 row_ror:2 row_mask:0xf bank_mask:0xf
    s_nop 0
    v_add_f32_dpp v86, v86, v86 row_ror:1 row_mask:0xf bank_mask:0xf
    v_add_f32_dpp v87, v87, v87 row_ror:1 row_mask:0xf bank_mask:0xf
    v_mul_f32 v86, 0x3acccccd, v86
    v_mul_f32 v87, 0x3acccccd, v87
    v_fma_f32 v87, -v86, v86, v87
    v_max_f32 v87, 0, v87
    v_cvt_pk_bf16_f32 v88, v86, v86
    v_lshlrev_b32 v88, 16, v88
    v_cvt_pk_bf16_f32 v87, v87, v87
    v_lshlrev_b32 v87, 16, v87
    v_add_f32 v87, 0x3727c5ac, v87
    v_cvt_pk_bf16_f32 v87, v87, v87
    v_lshlrev_b32 v87, 16, v87
    v_sqrt_f32 v87, v87
    s_nop 0
    v_cvt_pk_bf16_f32 v87, v87, v87
    v_lshlrev_b32 v87, 16, v87
    v_rcp_f32 v89, v87
    s_mov_b32 exec_lo, 0
    v_mov_b32 v88, v89
    s_mov_b32 exec_lo, 0x00010001
    s_mov_b32 exec_hi, 0x00010001
    buffer_store_dword v88, v90, s[88:91], 0 offen sc0 sc1
    s_mov_b64 exec, -1
    s_cmp_eq_u32 s36, 0
    s_cbranch_scc1 L_mega_kernel_nl_40
    s_add_u32 m0, s82, 3072
    s_mov_b32 exec_hi, s37
L_mega_kernel_jl_41:
    buffer_load_dwordx4 v143, s[72:75], s38 offen lds
    s_add_u32 m0, m0, s34
    s_add_u32 s38, s38, s35
    s_sub_u32 s36, s36, 1
    s_cmp_lg_u32 s36, 0
    s_cbranch_scc1 L_mega_kernel_jl_41
    s_mov_b64 exec, -1
L_mega_kernel_nl_40:
    s_cmp_eq_u32 s40, 1
    s_cbranch_scc1 L_mega_kernel_w8_42
    s_cmp_eq_u32 s40, 0
    s_cbranch_scc1 L_mega_kernel_w4_43
    s_waitcnt vmcnt(0)
    s_branch L_mega_kernel_wd_44
L_mega_kernel_w8_42:
    s_waitcnt vmcnt(8)
    s_branch L_mega_kernel_wd_44
L_mega_kernel_w4_43:
    s_waitcnt vmcnt(4)
L_mega_kernel_wd_44:
    s_mov_b32 s86, 0
L_mega_kernel_gn_45:
    v_readfirstlane_b32 s20, v96
    v_readfirstlane_b32 s21, v97
    s_nop 0
    s_cmp_lg_u32 s21, 0
    s_cbranch_scc1 L_mega_kernel_gn2_46
    v_mov_b32 v2, 0
    buffer_load_dwordx2 v[96:97], v2, s[68:71], 0 offen sc1
    s_add_u32 s86, s86, 1
    s_waitcnt vmcnt(0)
    s_cmp_lt_u32 s86, 0x100000
    s_cbranch_scc1 L_mega_kernel_gn_45
L_mega_kernel_gn2_46:
    s_add_u32 s68, s6, 0x940000
    s_addc_u32 s69, s7, 0
    s_mov_b32 s70, 0x30000
    s_mov_b32 s71, 0x00020000
    v_mov_b32 v2, 161792
    v_mov_b32 v3, 1
    s_mov_b64 exec, 1
    ds_add_rtn_u32 v3, v2, v3
    s_waitcnt lgkmcnt(0)
    v_cmp_eq_u32 vcc, 3, v3
    s_mov_b64 exec, -1
    s_cbranch_vccz L_mega_kernel_np_47
    s_lshl_b32 s17, s2, 7
    v_mov_b32 v2, 0
    v_mov_b32 v40, s20
    v_mov_b32 v41, s21
    s_mov_b64 exec, 1
    buffer_store_dwordx2 v[40:41], v2, s[68:71], s17 offen sc0 sc1
    s_mov_b64 exec, -1
L_mega_kernel_np_47:
    s_setprio 0
    v_mov_b32 v2, 161824
    ds_write_b64 v2, v[96:97]
    s_add_u32 s64, s6, 0xf90000
    s_addc_u32 s65, s7, 0
    s_mov_b32 s66, 0x20000
    s_mov_b32 s67, 0x00020000
    v_mov_b32 v32, -1
    v_mov_b32 v33, -1
    v_mov_b32 v34, -1
    v_mov_b32 v35, -1
    s_lshl_b32 s17, s83, 7
    s_mov_b64 exec, 0xff
    buffer_store_dwordx4 v[32:35], v4, s[64:67], s17 offen sc0 sc1
    s_mov_b64 exec, -1
    v_lshlrev_b32 v154, 9, v1
    v_add_u32 v154, 131072, v154
    v_and_b32 v3, 31, v1
    s_mul_i32 s17, s22, 1536
    s_add_u32 s17, s17, 76032
    v_lshlrev_b32 v72, 5, v71
    v_add_lshl_u32 v72, v72, v3, 4
    v_add_u32 v72, s17, v72
    s_add_u32 s17, s17, 1024
    v_lshlrev_b32 v10, 6, v6
    v_add_u32 v10, s17, v10
    v_lshrrev_b32 v73, 4, v3
    s_lshl_b32 s17, s22, 1
    v_add_u32 v73, s17, v73
    v_lshl_add_u32 v73, v71, 3, v73
    v_lshlrev_b32 v73, 2, v73
    v_add_u32 v73, 82432, v73
    v_cvt_f32_u32 v8, v5
    s_mul_i32 s17, s22, 2624
    s_add_u32 s17, s17, 140416
    v_lshlrev_b32 v11, 6, v5
    v_lshl_add_u32 v11, v6, 4, v11
    v_add_u32 v11, s17, v11
    v_and_b32 v116, 255, v0
    v_lshlrev_b32 v2, 3, v116
    v_sub_u32 v2, 2047, v2
    s_mov_b32 s18, -24264
    v_cvt_f32_i32 v3, v2
    v_cmp_gt_i32 vcc, 128, v2
    v_cvt_pk_bf16_f32 v3, v3, 0
    v_add_u32 v100, 17024, v2
    v_add_u32 v2, -1, v2
    v_cndmask_b32 v3, v3, v100, vcc
    v_subrev_u32 v3, s18, v3
    v_lshlrev_b32 v100, 1, v3
    v_cvt_f32_i32 v3, v2
    v_cmp_gt_i32 vcc, 128, v2
    v_cvt_pk_bf16_f32 v3, v3, 0
    v_add_u32 v101, 17024, v2
    v_add_u32 v2, -1, v2
    v_cndmask_b32 v3, v3, v101, vcc
    v_subrev_u32 v3, s18, v3
    v_lshlrev_b32 v101, 1, v3
    v_cvt_f32_i32 v3, v2
    v_cmp_gt_i32 vcc, 128, v2
    v_cvt_pk_bf16_f32 v3, v3, 0
    v_add_u32 v102, 17024, v2
    v_add_u32 v2, -1, v2
    v_cndmask_b32 v3, v3, v102, vcc
    v_subrev_u32 v3, s18, v3
    v_lshlrev_b32 v102, 1, v3
    v_cvt_f32_i32 v3, v2
    v_cmp_gt_i32 vcc, 128, v2
    v_cvt_pk_bf16_f32 v3, v3, 0
    v_add_u32 v103, 17024, v2
    v_add_u32 v2, -1, v2
    v_cndmask_b32 v3, v3, v103, vcc
    v_subrev_u32 v3, s18, v3
    v_lshlrev_b32 v103, 1, v3
    v_cvt_f32_i32 v3, v2
    v_cmp_gt_i32 vcc, 128, v2
    v_cvt_pk_bf16_f32 v3, v3, 0
    v_add_u32 v104, 17024, v2
    v_add_u32 v2, -1, v2
    v_cndmask_b32 v3, v3, v104, vcc
    v_subrev_u32 v3, s18, v3
    v_lshlrev_b32 v104, 1, v3
    v_cvt_f32_i32 v3, v2
    v_cmp_gt_i32 vcc, 128, v2
    v_cvt_pk_bf16_f32 v3, v3, 0
    v_add_u32 v105, 17024, v2
    v_add_u32 v2, -1, v2
    v_cndmask_b32 v3, v3, v105, vcc
    v_subrev_u32 v3, s18, v3
    v_lshlrev_b32 v105, 1, v3
    v_cvt_f32_i32 v3, v2
    v_cmp_gt_i32 vcc, 128, v2
    v_cvt_pk_bf16_f32 v3, v3, 0
    v_add_u32 v106, 17024, v2
    v_add_u32 v2, -1, v2
    v_cndmask_b32 v3, v3, v106, vcc
    v_subrev_u32 v3, s18, v3
    v_lshlrev_b32 v106, 1, v3
    v_cvt_f32_i32 v3, v2
    v_cmp_gt_i32 vcc, 128, v2
    v_cvt_pk_bf16_f32 v3, v3, 0
    v_add_u32 v107, 17024, v2
    v_add_u32 v2, -1, v2
    v_cndmask_b32 v3, v3, v107, vcc
    v_subrev_u32 v3, s18, v3
    v_lshlrev_b32 v107, 1, v3
    v_cvt_f32_i32 v3, v2
    v_cmp_gt_i32 vcc, 128, v2
    v_cvt_pk_bf16_f32 v3, v3, 0
    v_add_u32 v108, 17024, v2
    v_add_u32 v2, -1, v2
    v_cndmask_b32 v3, v3, v108, vcc
    v_subrev_u32 v3, s18, v3
    v_lshlrev_b32 v108, 1, v3
    v_cvt_f32_i32 v3, v2
    v_cmp_gt_i32 vcc, 128, v2
    v_cvt_pk_bf16_f32 v3, v3, 0
    v_add_u32 v109, 17024, v2
    v_add_u32 v2, -1, v2
    v_cndmask_b32 v3, v3, v109, vcc
    v_subrev_u32 v3, s18, v3
    v_lshlrev_b32 v109, 1, v3
    v_cvt_f32_i32 v3, v2
    v_cmp_gt_i32 vcc, 128, v2
    v_cvt_pk_bf16_f32 v3, v3, 0
    v_add_u32 v110, 17024, v2
    v_cndmask_b32 v3, v3, v110, vcc
    v_subrev_u32 v3, s18, v3
    v_lshlrev_b32 v110, 1, v3
    v_lshlrev_b32 v111, 4, v116
    v_add_u32 v115, 50688, v111
    v_add_u32 v111, 140416, v111
    v_lshlrev_b32 v113, 3, v116
    v_add_u32 v113, 85264, v113
    v_cmp_eq_u32 vcc, 0, v116
    v_lshlrev_b32 v117, 16, v117
    s_nop 0
    v_cndmask_b32 v117, 0, v117, vcc
    v_lshlrev_b32 v64, 16, v64
    v_lshlrev_b32 v65, 16, v65
    v_lshlrev_b32 v66, 16, v66
    v_lshlrev_b32 v67, 16, v67
    v_lshlrev_b32 v70, 16, v70
    v_mul_f32 v70, 0x3fb8aa3b, v70
    v_mul_f32 v64, 0x3fb8aa3b, v64
    v_exp_f32 v70, v70
    v_exp_f32 v64, v64
    v_cvt_pk_bf16_f32 v70, v70, v70
    v_lshlrev_b32 v70, 16, v70
    v_cvt_pk_bf16_f32 v64, v64, v64
    v_lshlrev_b32 v64, 16, v64
    v_mul_f32 v64, v64, v70
    v_mul_f32 v64, 0xbfb8aa3b, v64
    v_mul_f32 v65, v65, v70
    v_mul_f32 v65, 0x3e22f983, v65
    v_add_f32 v70, v70, v70
    v_mul_f32 v66, v66, v70
    v_mul_f32 v67, v67, v70
    ds_write_b128 v72, v[64:67]
    ds_read_b128 v[12:15], v10 offset:0
    ds_read_b128 v[16:19], v10 offset:16
    ds_read_b128 v[20:23], v10 offset:32
    ds_read_b128 v[24:27], v10 offset:48
    v_add_u32 v10, 256, v10
    v_mul_f32 v74, 0x45000000, v64
    v_mul_f32 v75, 0x45000000, v65
    v_exp_f32 v74, v74
    v_fract_f32 v75, v75
    v_sin_f32 v76, v75
    v_cos_f32 v75, v75
    v_mul_f32 v76, v76, v67
    v_fma_f32 v75, v75, v66, -v76
    v_mul_f32 v75, v75, v74
    s_nop 1
    v_add_f32_dpp v75, v75, v75 row_ror:8 row_mask:0xf bank_mask:0xf
    s_nop 1
    v_add_f32_dpp v75, v75, v75 row_ror:4 row_mask:0xf bank_mask:0xf
    s_nop 1
    v_add_f32_dpp v75, v75, v75 row_ror:2 row_mask:0xf bank_mask:0xf
    s_nop 1
    v_add_f32_dpp v75, v75, v75 row_ror:1 row_mask:0xf bank_mask:0xf
    ds_write_b32 v73, v75
    v_mov_b32 v60, 0
    v_mov_b32 v61, 0
    v_mov_b32 v62, 0
    v_mov_b32 v63, 0
    v_mov_b32 v64, 0
    v_mov_b32 v65, 0
    v_mov_b32 v66, 0
    v_mov_b32 v67, 0
    v_mov_b32 v68, 0
    v_mov_b32 v69, 0
    v_mov_b32 v70, 0
    v_mov_b32 v71, 0
    v_mov_b32 v72, 0
    v_mov_b32 v73, 0
    v_mov_b32 v74, 0
    v_mov_b32 v75, 0
    s_waitcnt vmcnt(1)
    s_cmp_eq_u32 s40, 2
    s_cbranch_scc1 L_mega_kernel_j2_48
    s_cmp_eq_u32 s40, 1
    s_cbranch_scc1 L_mega_kernel_o2_49
    ds_read_b64_tr_b16 v[120:121], v140 offset:3072
    ds_read_b64_tr_b16 v[122:123], v140 offset:3968
    ds_read_b64_tr_b16 v[124:125], v140 offset:3200
    ds_read_b64_tr_b16 v[126:127], v140 offset:4096
    ds_read_b64_tr_b16 v[128:129], v140 offset:4864
    ds_read_b64_tr_b16 v[130:131], v140 offset:5760
    ds_read_b64_tr_b16 v[132:133], v140 offset:4992
    ds_read_b64_tr_b16 v[134:135], v140 offset:5888
    s_waitcnt lgkmcnt(0)
    s_mov_b32 exec_lo, 0
    s_mov_b32 exec_hi, 0xffff0000
    v_mov_b32 v124, 0x3f803f80
    v_mov_b32 v125, 0x3f803f80
    v_mov_b32 v126, 0x3f803f80
    v_mov_b32 v127, 0x3f803f80
    v_mov_b32 v132, 0x3f803f80
    v_mov_b32 v133, 0x3f803f80
    v_mov_b32 v134, 0x3f803f80
    v_mov_b32 v135, 0x3f803f80
    s_mov_b64 exec, -1
    buffer_store_dwordx4 v[120:123], v4, s[76:79], s39 offen offset:0 sc0 sc1
    buffer_store_dwordx4 v[124:127], v4, s[76:79], s39 offen offset:1024 sc0 sc1
    buffer_store_dwordx4 v[128:131], v4, s[76:79], s39 offen offset:2048 sc0 sc1
    buffer_store_dwordx4 v[132:135], v4, s[76:79], s39 offen offset:3072 sc0 sc1
    s_branch L_mega_kernel_j2_48
L_mega_kernel_o2_49:
    ds_read_b64_tr_b16 v[120:121], v140 offset:3072
    ds_read_b64_tr_b16 v[122:123], v140 offset:4352
    ds_read_b64_tr_b16 v[124:125], v140 offset:3712
    ds_read_b64_tr_b16 v[126:127], v140 offset:4992
    ds_read_b64_tr_b16 v[128:129], v140 offset:5632
    ds_read_b64_tr_b16 v[130:131], v140 offset:6912
    ds_read_b64_tr_b16 v[132:133], v140 offset:6272
    ds_read_b64_tr_b16 v[134:135], v140 offset:7552
    ds_read_b64_tr_b16 v[136:137], v141 offset:3200
    ds_read_b64_tr_b16 v[138:139], v141 offset:4480
    s_waitcnt lgkmcnt(0)
    buffer_store_dwordx4 v[120:123], v4, s[76:79], s39 offen offset:0 sc0 sc1
    buffer_store_dwordx4 v[124:127], v4, s[76:79], s39 offen offset:1280 sc0 sc1
    buffer_store_dwordx4 v[128:131], v4, s[76:79], s39 offen offset:2560 sc0 sc1
    buffer_store_dwordx4 v[132:135], v4, s[76:79], s39 offen offset:3840 sc0 sc1
    buffer_store_dwordx4 v[136:139], v142, s[76:79], s39 offen offset:1024 sc0 sc1
L_mega_kernel_j2_48:
    s_mov_b32 s56, 1
    s_branch L_mega_kernel_unit_2
L_mega_kernel_uret1:
    s_waitcnt vmcnt(0)
    v_mov_b32 v2, 161796
    v_mov_b32 v3, 1
    s_mov_b64 exec, 1
    ds_add_rtn_u32 v3, v2, v3
    s_waitcnt lgkmcnt(0)
    v_cmp_eq_u32 vcc, 3, v3
    s_mov_b64 exec, -1
    s_cbranch_vccz L_mega_kernel_np_50
    s_lshl_b32 s17, s2, 7
    v_mov_b32 v2, 131072
    v_mov_b32 v144, s20
    v_mov_b32 v145, s21
    s_mov_b64 exec, 1
    buffer_store_dwordx2 v[144:145], v2, s[68:71], s17 offen sc0 sc1
    s_mov_b64 exec, -1
L_mega_kernel_np_50:
    s_setprio 2
    s_mov_b32 s56, 2
    s_branch L_mega_kernel_unit_2
L_mega_kernel_uret2:
    ds_write_b128 v11, v[60:63]
    s_mov_b32 exec_lo, 0xff00ff00
    s_mov_b32 exec_hi, 0xff00ff00
    ds_write_b128 v11, v[64:67] offset:512
    ds_write_b128 v11, v[68:71] offset:1024
    ds_write_b128 v11, v[72:75] offset:1536
    s_mov_b64 exec, -1
    v_mov_b32 v2, 161812
    v_mov_b32 v3, 1
    s_waitcnt lgkmcnt(0)
    s_mov_b64 exec, 1
    ds_add_u32 v2, v3
    s_mov_b64 exec, -1
    v_mov_b32 v2, 161812
    s_mov_b32 s17, 0
L_mega_kernel_ls_51:
    ds_read_b32 v3, v2
    s_waitcnt lgkmcnt(0)
    v_cmp_gt_u32 vcc, 4, v3
    s_cbranch_vccz L_mega_kernel_lo_52
    s_add_u32 s17, s17, 1
    s_sleep 1
    s_cmp_lt_u32 s17, 0x400000
    s_cbranch_scc1 L_mega_kernel_ls_51
L_mega_kernel_lo_52:
    v_cmp_gt_u32 vcc, 160, v116
    v_min_u32 v2, 0, v1
    v_lshlrev_b32 v3, 5, v2
    v_add_u32 v3, 82496, v3
    ds_read_b128 v[44:47], v3
    ds_read_b128 v[48:51], v3 offset:16
    v_mul_u32_u24 v2, 1344, v2
    v_add_u32 v2, 86544, v2
    s_and_saveexec_b64 s[34:35], vcc
    s_cbranch_execz L_mega_kernel_vr_53
    ds_read_b128 v[12:15], v111 offset:0
    ds_read_b128 v[16:19], v111 offset:2624
    ds_read_b128 v[20:23], v111 offset:5248
    ds_read_b128 v[24:27], v111 offset:7872
    s_waitcnt lgkmcnt(0)
    v_pk_add_f32 v[12:13], v[12:13], v[16:17]
    v_pk_add_f32 v[20:21], v[20:21], v[24:25]
    v_pk_add_f32 v[14:15], v[14:15], v[18:19]
    v_pk_add_f32 v[22:23], v[22:23], v[26:27]
    v_pk_add_f32 v[12:13], v[12:13], v[20:21]
    v_pk_add_f32 v[14:15], v[14:15], v[22:23]
    v_add_f32 v12, v12, v117
    v_cvt_pk_bf16_f32 v16, v12, v13
    v_cvt_pk_bf16_f32 v17, v14, v15
    ds_write_b64 v113, v[16:17] offset:0
L_mega_kernel_vr_53:
    s_mov_b64 exec, s[34:35]
    s_waitcnt lgkmcnt(0)
    v_pk_add_f32 v[44:45], v[44:45], v[48:49]
    v_pk_add_f32 v[46:47], v[46:47], v[50:51]
    v_pk_add_f32 v[44:45], v[44:45], v[46:47]
    v_add_f32 v44, v44, v45
    v_cvt_pk_bf16_f32 v44, v44, v44
    ds_write_b16 v2, v44
    v_mov_b32 v2, 161812
    v_mov_b32 v3, 1
    s_waitcnt lgkmcnt(0)
    s_mov_b64 exec, 1
    ds_add_u32 v2, v3
    s_mov_b64 exec, -1
    v_mov_b32 v2, 161812
    s_mov_b32 s17, 0
L_mega_kernel_ls_54:
    ds_read_b32 v3, v2
    s_waitcnt lgkmcnt(0)
    v_cmp_gt_u32 vcc, 8, v3
    s_cbranch_vccz L_mega_kernel_lo_55
    s_add_u32 s17, s17, 1
    s_sleep 1
    s_cmp_lt_u32 s17, 0x400000
    s_cbranch_scc1 L_mega_kernel_ls_54
L_mega_kernel_lo_55:
    ds_read_u16 v60, v100 offset:2688
    ds_read_u16 v61, v101 offset:2688
    ds_read_u16 v62, v102 offset:2688
    ds_read_u16 v63, v103 offset:2688
    ds_read_u16 v64, v104 offset:2688
    ds_read_u16 v65, v105 offset:2688
    ds_read_u16 v66, v106 offset:2688
    ds_read_u16 v67, v107 offset:2688
    ds_read_u16 v68, v108 offset:2688
    ds_read_u16 v69, v109 offset:2688
    ds_read_u16 v70, v110 offset:2688
    s_waitcnt lgkmcnt(9)
    v_lshl_or_b32 v24, v61, 16, v60
    s_waitcnt lgkmcnt(7)
    v_lshl_or_b32 v25, v63, 16, v62
    s_waitcnt lgkmcnt(5)
    v_lshl_or_b32 v26, v65, 16, v64
    s_waitcnt lgkmcnt(3)
    v_lshl_or_b32 v27, v67, 16, v66
    ds_write_b128 v115, v[24:27] offset:12480
    v_lshl_or_b32 v20, v62, 16, v61
    v_lshl_or_b32 v21, v64, 16, v63
    v_lshl_or_b32 v22, v66, 16, v65
    s_waitcnt lgkmcnt(3)
    v_lshl_or_b32 v23, v68, 16, v67
    ds_write_b128 v115, v[20:23] offset:8320
    v_lshl_or_b32 v16, v63, 16, v62
    v_lshl_or_b32 v17, v65, 16, v64
    v_lshl_or_b32 v18, v67, 16, v66
    s_waitcnt lgkmcnt(3)
    v_lshl_or_b32 v19, v69, 16, v68
    ds_write_b128 v115, v[16:19] offset:4160
    v_lshl_or_b32 v12, v64, 16, v63
    v_lshl_or_b32 v13, v66, 16, v65
    v_lshl_or_b32 v14, v68, 16, v67
    s_waitcnt lgkmcnt(3)
    v_lshl_or_b32 v15, v70, 16, v69
    ds_write_b128 v115, v[12:15] offset:0
    v_mov_b32 v2, 161820
    v_mov_b32 v3, 1
    s_waitcnt lgkmcnt(0)
    s_mov_b64 exec, 1
    ds_add_u32 v2, v3
    s_mov_b64 exec, -1
    v_lshrrev_b32 v7, 5, v1
    v_mul_u32_u24 v7, 1536, v7
    v_lshl_add_u32 v7, v1, 4, v7
    s_add_u32 s28, s6, 0x500000
    s_addc_u32 s29, s7, 0
    s_mov_b32 s30, 0x280000
    s_mov_b32 s31, 0x00020000
    s_mul_i32 s24, s15, 163840
    s_lshl_b32 s17, s22, 9
    s_add_u32 s24, s24, s17
    s_lshr_b32 s17, s16, 2
    s_mul_i32 s17, s17, 8192
    s_add_u32 s24, s24, s17
    s_and_b32 s17, s16, 1
    s_mul_i32 s17, s17, 4096
    s_sub_u32 s25, s24, s17
    s_add_u32 s25, s25, 4096
    s_add_u32 s24, s24, s17
    s_cmp_lg_u32 s22, 0
    s_cbranch_scc1 L_mega_kernel_sp_56
    s_mov_b32 s86, 0
L_mega_kernel_poll_58:
    buffer_load_dwordx2 v[44:45], v154, s[68:71], 0 offen offset:0 sc1
    buffer_load_dwordx2 v[46:47], v154, s[68:71], 0 offen offset:128 sc1
    buffer_load_dwordx2 v[48:49], v154, s[68:71], 0 offen offset:256 sc1
    buffer_load_dwordx2 v[50:51], v154, s[68:71], 0 offen offset:384 sc1
    s_waitcnt vmcnt(0)
    v_cmp_ne_u64 vcc, s[20:21], v[44:45]
    v_cmp_ne_u64 s[34:35], s[20:21], v[46:47]
    s_nop 0
    s_or_b64 vcc, vcc, s[34:35]
    v_cmp_ne_u64 s[34:35], s[20:21], v[48:49]
    s_nop 0
    s_or_b64 vcc, vcc, s[34:35]
    v_cmp_ne_u64 s[34:35], s[20:21], v[50:51]
    s_nop 0
    s_or_b64 vcc, vcc, s[34:35]
    s_cbranch_vccz L_mega_kernel_ok_59
    s_add_u32 s86, s86, 1
    s_sleep 1
    s_cmp_lt_u32 s86, 0x100000
    s_cbranch_scc1 L_mega_kernel_poll_58
L_mega_kernel_ok_59:
    v_mov_b32 v2, 161804
    v_mov_b32 v3, 1
    s_waitcnt lgkmcnt(0)
    s_mov_b64 exec, 1
    ds_add_u32 v2, v3
    s_mov_b64 exec, -1
    s_branch L_mega_kernel_go_57
L_mega_kernel_sp_56:
    v_mov_b32 v2, 161804
    s_mov_b32 s17, 0
L_mega_kernel_ls_60:
    ds_read_b32 v3, v2
    s_waitcnt lgkmcnt(0)
    v_cmp_gt_u32 vcc, 1, v3
    s_cbranch_vccz L_mega_kernel_lo_61
    s_add_u32 s17, s17, 1
    s_sleep 1
    s_cmp_lt_u32 s17, 0x400000
    s_cbranch_scc1 L_mega_kernel_ls_60
L_mega_kernel_lo_61:
L_mega_kernel_go_57:
    s_setprio 0
    v_mov_b32 v13, 0x3f803f80
    v_mov_b32 v22, 0
    v_mov_b32 v23, 0
    s_add_u32 s17, s24, 0
    buffer_load_dwordx4 v[92:95], v7, s[28:31], s17 offen sc1
    s_add_u32 s17, s25, 0
    buffer_load_dwordx4 v[96:99], v7, s[28:31], s17 offen sc1
    s_add_u32 s17, s24, 16384
    buffer_load_dwordx4 v[100:103], v7, s[28:31], s17 offen sc1
    s_add_u32 s17, s25, 16384
    buffer_load_dwordx4 v[104:107], v7, s[28:31], s17 offen sc1
    s_add_u32 s17, s24, 32768
    buffer_load_dwordx4 v[108:111], v7, s[28:31], s17 offen sc1
    s_add_u32 s17, s25, 32768
    buffer_load_dwordx4 v[112:115], v7, s[28:31], s17 offen sc1
    s_add_u32 s17, s24, 49152
    buffer_load_dwordx4 v[116:119], v7, s[28:31], s17 offen sc1
    s_add_u32 s17, s25, 49152
    buffer_load_dwordx4 v[120:123], v7, s[28:31], s17 offen sc1
    s_add_u32 s17, s24, 65536
    buffer_load_dwordx4 v[124:127], v7, s[28:31], s17 offen sc1
    s_add_u32 s17, s25, 65536
    buffer_load_dwordx4 v[128:131], v7, s[28:31], s17 offen sc1
    s_waitcnt vmcnt(8)
    v_dot2_f32_bf16 v22, v92, v13, v22
    v_dot2_f32_bf16 v22, v93, v13, v22
    v_dot2_f32_bf16 v22, v94, v13, v22
    v_dot2_f32_bf16 v22, v95, v13, v22
    s_add_u32 s17, s24, 81920
    buffer_load_dwordx4 v[132:135], v7, s[28:31], s17 offen sc1
    s_waitcnt vmcnt(8)
    v_dot2_f32_bf16 v22, v96, v13, v22
    v_dot2_f32_bf16 v22, v97, v13, v22
    v_dot2_f32_bf16 v22, v98, v13, v22
    v_dot2_f32_bf16 v22, v99, v13, v22
    s_add_u32 s17, s25, 81920
    buffer_load_dwordx4 v[136:139], v7, s[28:31], s17 offen sc1
    s_waitcnt vmcnt(8)
    v_dot2_f32_bf16 v22, v100, v13, v22
    v_dot2_f32_bf16 v22, v101, v13, v22
    v_dot2_f32_bf16 v22, v102, v13, v22
    v_dot2_f32_bf16 v22, v103, v13, v22
    s_add_u32 s17, s24, 98304
    buffer_load_dwordx4 v[140:143], v7, s[28:31], s17 offen sc1
    s_waitcnt vmcnt(8)
    v_dot2_f32_bf16 v22, v104, v13, v22
    v_dot2_f32_bf16 v22, v105, v13, v22
    v_dot2_f32_bf16 v22, v106, v13, v22
    v_dot2_f32_bf16 v22, v107, v13, v22
    s_add_u32 s17, s25, 98304
    buffer_load_dwordx4 v[144:147], v7, s[28:31], s17 offen sc1
    s_waitcnt vmcnt(8)
    v_dot2_f32_bf16 v22, v108, v13, v22
    v_dot2_f32_bf16 v22, v109, v13, v22
    v_dot2_f32_bf16 v22, v110, v13, v22
    v_dot2_f32_bf16 v22, v111, v13, v22
    s_add_u32 s17, s24, 114688
    buffer_load_dwordx4 v[148:151], v7, s[28:31], s17 offen sc1
    s_waitcnt vmcnt(8)
    v_dot2_f32_bf16 v22, v112, v13, v22
    v_dot2_f32_bf16 v22, v113, v13, v22
    v_dot2_f32_bf16 v22, v114, v13, v22
    v_dot2_f32_bf16 v22, v115, v13, v22
    s_add_u32 s17, s25, 114688
    buffer_load_dwordx4 v[152:155], v7, s[28:31], s17 offen sc1
    s_waitcnt vmcnt(8)
    v_dot2_f32_bf16 v22, v116, v13, v22
    v_dot2_f32_bf16 v22, v117, v13, v22
    v_dot2_f32_bf16 v22, v118, v13, v22
    v_dot2_f32_bf16 v22, v119, v13, v22
    s_add_u32 s17, s24, 131072
    buffer_load_dwordx4 v[156:159], v7, s[28:31], s17 offen sc1
    s_waitcnt vmcnt(8)
    v_dot2_f32_bf16 v22, v120, v13, v22
    v_dot2_f32_bf16 v22, v121, v13, v22
    v_dot2_f32_bf16 v22, v122, v13, v22
    v_dot2_f32_bf16 v22, v123, v13, v22
    s_add_u32 s17, s25, 131072
    buffer_load_dwordx4 v[160:163], v7, s[28:31], s17 offen sc1
    s_waitcnt vmcnt(8)
    v_dot2_f32_bf16 v22, v124, v13, v22
    v_dot2_f32_bf16 v22, v125, v13, v22
    v_dot2_f32_bf16 v22, v126, v13, v22
    v_dot2_f32_bf16 v22, v127, v13, v22
    s_add_u32 s17, s24, 147456
    buffer_load_dwordx4 v[164:167], v7, s[28:31], s17 offen sc1
    s_waitcnt vmcnt(8)
    v_dot2_f32_bf16 v22, v128, v13, v22
    v_dot2_f32_bf16 v22, v129, v13, v22
    v_dot2_f32_bf16 v22, v130, v13, v22
    v_dot2_f32_bf16 v22, v131, v13, v22
    s_add_u32 s17, s25, 147456
    buffer_load_dwordx4 v[168:171], v7, s[28:31], s17 offen sc1
    s_waitcnt vmcnt(8)
    v_dot2_f32_bf16 v22, v132, v13, v22
    v_dot2_f32_bf16 v22, v133, v13, v22
    v_dot2_f32_bf16 v22, v134, v13, v22
    v_dot2_f32_bf16 v22, v135, v13, v22
    s_add_u32 s17, s24, 1310720
    buffer_load_dwordx4 v[172:175], v7, s[28:31], s17 offen sc1
    s_waitcnt vmcnt(8)
    v_dot2_f32_bf16 v22, v136, v13, v22
    v_dot2_f32_bf16 v22, v137, v13, v22
    v_dot2_f32_bf16 v22, v138, v13, v22
    v_dot2_f32_bf16 v22, v139, v13, v22
    s_add_u32 s17, s25, 1310720
    buffer_load_dwordx4 v[176:179], v7, s[28:31], s17 offen sc1
    s_waitcnt vmcnt(8)
    v_dot2_f32_bf16 v22, v140, v13, v22
    v_dot2_f32_bf16 v22, v141, v13, v22
    v_dot2_f32_bf16 v22, v142, v13, v22
    v_dot2_f32_bf16 v22, v143, v13, v22
    s_add_u32 s17, s24, 1327104
    buffer_load_dwordx4 v[180:183], v7, s[28:31], s17 offen sc1
    s_waitcnt vmcnt(8)
    v_dot2_f32_bf16 v22, v144, v13, v22
    v_dot2_f32_bf16 v22, v145, v13, v22
    v_dot2_f32_bf16 v22, v146, v13, v22
    v_dot2_f32_bf16 v22, v147, v13, v22
    s_add_u32 s17, s25, 1327104
    buffer_load_dwordx4 v[184:187], v7, s[28:31], s17 offen sc1
    s_waitcnt vmcnt(8)
    v_dot2_f32_bf16 v22, v148, v13, v22
    v_dot2_f32_bf16 v22, v149, v13, v22
    v_dot2_f32_bf16 v22, v150, v13, v22
    v_dot2_f32_bf16 v22, v151, v13, v22
    s_add_u32 s17, s24, 1343488
    buffer_load_dwordx4 v[188:191], v7, s[28:31], s17 offen sc1
    s_waitcnt vmcnt(8)
    v_dot2_f32_bf16 v22, v152, v13, v22
    v_dot2_f32_bf16 v22, v153, v13, v22
    v_dot2_f32_bf16 v22, v154, v13, v22
    v_dot2_f32_bf16 v22, v155, v13, v22
    s_add_u32 s17, s25, 1343488
    buffer_load_dwordx4 v[192:195], v7, s[28:31], s17 offen sc1
    s_waitcnt vmcnt(8)
    v_dot2_f32_bf16 v22, v156, v13, v22
    v_dot2_f32_bf16 v22, v157, v13, v22
    v_dot2_f32_bf16 v22, v158, v13, v22
    v_dot2_f32_bf16 v22, v159, v13, v22
    s_add_u32 s17, s24, 1359872
    buffer_load_dwordx4 v[196:199], v7, s[28:31], s17 offen sc1
    s_waitcnt vmcnt(8)
    v_dot2_f32_bf16 v22, v160, v13, v22
    v_dot2_f32_bf16 v22, v161, v13, v22
    v_dot2_f32_bf16 v22, v162, v13, v22
    v_dot2_f32_bf16 v22, v163, v13, v22
    s_add_u32 s17, s25, 1359872
    buffer_load_dwordx4 v[200:203], v7, s[28:31], s17 offen sc1
    s_waitcnt vmcnt(8)
    v_dot2_f32_bf16 v22, v164, v13, v22
    v_dot2_f32_bf16 v22, v165, v13, v22
    v_dot2_f32_bf16 v22, v166, v13, v22
    v_dot2_f32_bf16 v22, v167, v13, v22
    s_add_u32 s17, s24, 1376256
    buffer_load_dwordx4 v[204:207], v7, s[28:31], s17 offen sc1
    s_waitcnt vmcnt(8)
    v_dot2_f32_bf16 v22, v168, v13, v22
    v_dot2_f32_bf16 v22, v169, v13, v22
    v_dot2_f32_bf16 v22, v170, v13, v22
    v_dot2_f32_bf16 v22, v171, v13, v22
    s_add_u32 s17, s25, 1376256
    buffer_load_dwordx4 v[208:211], v7, s[28:31], s17 offen sc1
    s_waitcnt vmcnt(8)
    v_dot2_f32_bf16 v23, v172, v13, v23
    v_dot2_f32_bf16 v23, v173, v13, v23
    v_dot2_f32_bf16 v23, v174, v13, v23
    v_dot2_f32_bf16 v23, v175, v13, v23
    s_add_u32 s17, s24, 1392640
    buffer_load_dwordx4 v[212:215], v7, s[28:31], s17 offen sc1
    s_waitcnt vmcnt(8)
    v_dot2_f32_bf16 v23, v176, v13, v23
    v_dot2_f32_bf16 v23, v177, v13, v23
    v_dot2_f32_bf16 v23, v178, v13, v23
    v_dot2_f32_bf16 v23, v179, v13, v23
    s_add_u32 s17, s25, 1392640
    buffer_load_dwordx4 v[216:219], v7, s[28:31], s17 offen sc1
    s_waitcnt vmcnt(8)
    v_dot2_f32_bf16 v23, v180, v13, v23
    v_dot2_f32_bf16 v23, v181, v13, v23
    v_dot2_f32_bf16 v23, v182, v13, v23
    v_dot2_f32_bf16 v23, v183, v13, v23
    s_add_u32 s17, s24, 1409024
    buffer_load_dwordx4 v[220:223], v7, s[28:31], s17 offen sc1
    s_waitcnt vmcnt(8)
    v_dot2_f32_bf16 v23, v184, v13, v23
    v_dot2_f32_bf16 v23, v185, v13, v23
    v_dot2_f32_bf16 v23, v186, v13, v23
    v_dot2_f32_bf16 v23, v187, v13, v23
    s_add_u32 s17, s25, 1409024
    buffer_load_dwordx4 v[224:227], v7, s[28:31], s17 offen sc1
    s_waitcnt vmcnt(8)
    v_dot2_f32_bf16 v23, v188, v13, v23
    v_dot2_f32_bf16 v23, v189, v13, v23
    v_dot2_f32_bf16 v23, v190, v13, v23
    v_dot2_f32_bf16 v23, v191, v13, v23
    s_add_u32 s17, s24, 1425408
    buffer_load_dwordx4 v[228:231], v7, s[28:31], s17 offen sc1
    s_waitcnt vmcnt(8)
    v_dot2_f32_bf16 v23, v192, v13, v23
    v_dot2_f32_bf16 v23, v193, v13, v23
    v_dot2_f32_bf16 v23, v194, v13, v23
    v_dot2_f32_bf16 v23, v195, v13, v23
    s_add_u32 s17, s25, 1425408
    buffer_load_dwordx4 v[232:235], v7, s[28:31], s17 offen sc1
    s_waitcnt vmcnt(8)
    v_dot2_f32_bf16 v23, v196, v13, v23
    v_dot2_f32_bf16 v23, v197, v13, v23
    v_dot2_f32_bf16 v23, v198, v13, v23
    v_dot2_f32_bf16 v23, v199, v13, v23
    s_add_u32 s17, s24, 1441792
    buffer_load_dwordx4 v[236:239], v7, s[28:31], s17 offen sc1
    s_waitcnt vmcnt(8)
    v_dot2_f32_bf16 v23, v200, v13, v23
    v_dot2_f32_bf16 v23, v201, v13, v23
    v_dot2_f32_bf16 v23, v202, v13, v23
    v_dot2_f32_bf16 v23, v203, v13, v23
    s_add_u32 s17, s25, 1441792
    buffer_load_dwordx4 v[240:243], v7, s[28:31], s17 offen sc1
    s_waitcnt vmcnt(8)
    v_dot2_f32_bf16 v23, v204, v13, v23
    v_dot2_f32_bf16 v23, v205, v13, v23
    v_dot2_f32_bf16 v23, v206, v13, v23
    v_dot2_f32_bf16 v23, v207, v13, v23
    s_add_u32 s17, s24, 1458176
    buffer_load_dwordx4 v[244:247], v7, s[28:31], s17 offen sc1
    s_waitcnt vmcnt(8)
    v_dot2_f32_bf16 v23, v208, v13, v23
    v_dot2_f32_bf16 v23, v209, v13, v23
    v_dot2_f32_bf16 v23, v210, v13, v23
    v_dot2_f32_bf16 v23, v211, v13, v23
    s_add_u32 s17, s25, 1458176
    buffer_load_dwordx4 v[248:251], v7, s[28:31], s17 offen sc1
    s_waitcnt vmcnt(8)
    v_dot2_f32_bf16 v23, v212, v13, v23
    v_dot2_f32_bf16 v23, v213, v13, v23
    v_dot2_f32_bf16 v23, v214, v13, v23
    v_dot2_f32_bf16 v23, v215, v13, v23
    s_waitcnt vmcnt(8)
    v_dot2_f32_bf16 v23, v216, v13, v23
    v_dot2_f32_bf16 v23, v217, v13, v23
    v_dot2_f32_bf16 v23, v218, v13, v23
    v_dot2_f32_bf16 v23, v219, v13, v23
    s_waitcnt vmcnt(7)
    v_dot2_f32_bf16 v23, v220, v13, v23
    v_dot2_f32_bf16 v23, v221, v13, v23
    v_dot2_f32_bf16 v23, v222, v13, v23
    v_dot2_f32_bf16 v23, v223, v13, v23
    s_waitcnt vmcnt(6)
    v_dot2_f32_bf16 v23, v224, v13, v23
    v_dot2_f32_bf16 v23, v225, v13, v23
    v_dot2_f32_bf16 v23, v226, v13, v23
    v_dot2_f32_bf16 v23, v227, v13, v23
    s_waitcnt vmcnt(5)
    v_dot2_f32_bf16 v23, v228, v13, v23
    v_dot2_f32_bf16 v23, v229, v13, v23
    v_dot2_f32_bf16 v23, v230, v13, v23
    v_dot2_f32_bf16 v23, v231, v13, v23
    s_waitcnt vmcnt(4)
    v_dot2_f32_bf16 v23, v232, v13, v23
    v_dot2_f32_bf16 v23, v233, v13, v23
    v_dot2_f32_bf16 v23, v234, v13, v23
    v_dot2_f32_bf16 v23, v235, v13, v23
    s_waitcnt vmcnt(3)
    v_dot2_f32_bf16 v23, v236, v13, v23
    v_dot2_f32_bf16 v23, v237, v13, v23
    v_dot2_f32_bf16 v23, v238, v13, v23
    v_dot2_f32_bf16 v23, v239, v13, v23
    s_waitcnt vmcnt(2)
    v_dot2_f32_bf16 v23, v240, v13, v23
    v_dot2_f32_bf16 v23, v241, v13, v23
    v_dot2_f32_bf16 v23, v242, v13, v23
    v_dot2_f32_bf16 v23, v243, v13, v23
    s_waitcnt vmcnt(1)
    v_dot2_f32_bf16 v23, v244, v13, v23
    v_dot2_f32_bf16 v23, v245, v13, v23
    v_dot2_f32_bf16 v23, v246, v13, v23
    v_dot2_f32_bf16 v23, v247, v13, v23
    s_waitcnt vmcnt(0)
    v_dot2_f32_bf16 v23, v248, v13, v23
    v_dot2_f32_bf16 v23, v249, v13, v23
    v_dot2_f32_bf16 v23, v250, v13, v23
    v_dot2_f32_bf16 v23, v251, v13, v23
L_mega_kernel_sym_36:
    s_lshr_b32 s42, s16, 2
    s_lshr_b32 s57, s22, 1
    s_xor_b32 s57, s57, s42
    s_mov_b32 s60, 0xbdd2d3e8
    s_mov_b32 s61, 0xbdd2d3e8
    s_cmp_eq_u32 s15, 7
    s_cselect_b32 s58, 5, 7
    s_lshl_b32 s17, s22, 1
    s_sub_i32 s58, s58, s17
    s_max_i32 s58, s58, 0
    v_lshrrev_b32 v8, 5, v1
    v_and_b32 v9, 31, v1
    v_bfe_u32 v26, v1, 2, 2
    v_and_b32 v27, 3, v1
    v_lshlrev_b32 v4, 4, v1
    v_bfe_u32 v3, v1, 4, 1
    v_lshlrev_b32 v10, 6, v3
    v_xor_b32 v10, v10, v4
    v_lshl_add_u32 v18, v8, 3, v26
    v_lshlrev_b32 v18, 7, v18
    v_lshrrev_b32 v2, 1, v27
    v_lshl_add_u32 v2, v3, 1, v2
    s_lshl_b32 s17, s57, 2
    v_add_u32 v2, s17, v2
    v_lshrrev_b32 v3, 1, v26
    v_lshlrev_b32 v3, 2, v3
    v_xor_b32 v2, v2, v3
    v_lshl_add_u32 v18, v2, 4, v18
    v_and_b32 v2, 1, v27
    v_lshl_add_u32 v18, v2, 3, v18
    s_lshl_b32 s17, s42, 12
    s_and_b32 s18, s16, 1
    s_lshl_b32 s18, s18, 11
    s_add_u32 s17, s17, s18
    v_add_u32 v18, s17, v18
    v_xor_b32 v19, 64, v18
    v_xor_b32 v20, 2048, v18
    v_xor_b32 v21, 2048, v19
    v_mov_b32 v11, 0x3f803f80
    v_mov_b32 v28, 0
    v_mov_b32 v29, 0
    v_mov_b32 v30, 0
    v_mov_b32 v31, 0
    v_mov_b32 v32, 0
    v_mov_b32 v33, 0
    v_mov_b32 v34, 0
    v_mov_b32 v35, 0
    v_mov_b32 v36, 0
    v_mov_b32 v37, 0
    v_mov_b32 v38, 0
    v_mov_b32 v39, 0
    v_mov_b32 v40, 0
    v_mov_b32 v41, 0
    v_mov_b32 v42, 0
    v_mov_b32 v43, 0
    v_mov_b32 v44, 0
    v_mov_b32 v45, 0
    v_mov_b32 v46, 0
    v_mov_b32 v47, 0
    v_mov_b32 v48, 0
    v_mov_b32 v49, 0
    v_mov_b32 v50, 0
    v_mov_b32 v51, 0
    v_mov_b32 v52, 0
    v_mov_b32 v53, 0
    v_mov_b32 v54, 0
    v_mov_b32 v55, 0
    v_mov_b32 v56, 0
    v_mov_b32 v57, 0
    v_mov_b32 v58, 0
    v_mov_b32 v59, 0
    s_lshl_b32 s17, s16, 12
    v_add_u32 v12, s17, v4
    s_lshl_b32 s17, s57, 10
    s_add_u32 s17, s17, 114688
    v_lshlrev_b32 v15, 3, v9
    v_add_u32 v15, s17, v15
    s_lshl_b32 s17, s22, 8
    s_add_u32 s17, s17, 4096
    v_add_u32 v17, s17, v15
    s_lshl_b32 s17, s16, 7
    s_add_u32 s17, s17, 116736
    v_lshlrev_b32 v16, 2, v9
    v_add_u32 v16, s17, v16
    s_mul_i32 s17, s57, 7680
    s_lshl_b32 s18, s22, 6
    s_add_u32 s17, s17, s18
    v_mul_u32_u24 v13, 240, v9
    v_lshl_add_u32 v13, v8, 3, v13
    v_add_u32 v13, s17, v13
    v_lshl_add_u32 v2, v8, 3, v26
    v_mul_u32_u24 v14, 240, v2
    v_bfe_u32 v2, v1, 4, 1
    v_lshl_add_u32 v14, v2, 5, v14
    v_lshl_add_u32 v14, v27, 3, v14
    v_add_u32 v14, s17, v14
    s_lshl_b32 s78, s15, 5
    s_add_u32 s78, s78, s14
    s_mul_i32 s78, s78, 14336
    s_mul_i32 s17, s57, 7168
    s_add_u32 s78, s78, s17
    s_lshl_b32 s17, s22, 9
    s_add_u32 s78, s78, s17
    s_add_u32 s68, s6, 0x1400000
    s_addc_u32 s69, s7, 0
    s_mov_b32 s70, 0x380000
    s_mov_b32 s71, 0x00020000
    s_add_u32 s64, s6, 0xa80000
    s_addc_u32 s65, s7, 0
    s_mov_b32 s66, 0x280000
    s_mov_b32 s67, 0x00020000
    s_add_u32 s72, s6, 0xf90000
    s_addc_u32 s73, s7, 0
    s_mov_b32 s74, 0x20000
    s_mov_b32 s75, 0x00020000
    s_mov_b32 s48, s8
    s_mov_b32 s49, s9
    s_mov_b32 s50, 0x800000
    s_mov_b32 s51, 0x00020000
    s_add_u32 s44, s6, 0x940000
    s_addc_u32 s45, s7, 0
    s_mov_b32 s46, 0x30000
    s_mov_b32 s47, 0x00020000
    s_lshl_b32 s52, s14, 18
    s_lshl_b32 s17, s16, 15
    s_add_u32 s52, s52, s17
    s_lshl_b32 s32, s16, 10
    s_and_b32 s33, s14, 7
    s_mul_i32 s33, s33, 0
    v_lshrrev_b32 v5, 3, v1
    v_lshlrev_b32 v5, 12, v5
    v_lshrrev_b32 v2, 4, v1
    s_and_b32 s17, s16, 1
    s_lshl_b32 s17, s17, 2
    v_add_u32 v2, s17, v2
    v_xor_b32 v2, v2, v1
    v_and_b32 v2, 7, v2
    v_lshl_add_u32 v5, v2, 4, v5
    v_and_b32 v6, 15, v1
    v_lshrrev_b32 v2, 1, v6
    v_lshrrev_b32 v3, 4, v1
    s_lshl_b32 s17, s42, 2
    v_add_u32 v3, s17, v3
    v_xor_b32 v2, v2, v3
    v_lshlrev_b32 v6, 7, v6
    v_lshl_add_u32 v6, v2, 4, v6
    s_lshl_b32 s17, s22, 11
    s_add_u32 s17, s17, 81920
    v_add_u32 v6, s17, v6
    s_lshl_b32 s77, s22, 11
    s_mul_i32 s76, s14, 81920
    s_add_u32 s76, s76, s77
    s_lshl_b32 s79, s14, 12
    v_mov_b32 v24, 0
    v_mov_b32 v25, 0
    v_mov_b32 v26, 0
    v_mov_b32 v27, 0
    s_cmp_lg_u32 s16, 4
    s_cbranch_scc1 L_mega_kernel_np_62
    v_lshlrev_b32 v60, 9, v1
    v_add_u32 v60, 32768, v60
    s_mov_b32 s56, 0
L_mega_kernel_poll_63:
    buffer_load_dwordx2 v[62:63], v60, s[44:47], 0 offen offset:0 sc1
    buffer_load_dwordx2 v[64:65], v60, s[44:47], 0 offen offset:128 sc1
    buffer_load_dwordx2 v[66:67], v60, s[44:47], 0 offen offset:256 sc1
    buffer_load_dwordx2 v[68:69], v60, s[44:47], 0 offen offset:384 sc1
    s_waitcnt vmcnt(0)
    v_cmp_ne_u64 vcc, s[20:21], v[62:63]
    v_cmp_ne_u64 s[54:55], s[20:21], v[64:65]
    s_nop 0
    s_or_b64 vcc, vcc, s[54:55]
    v_cmp_ne_u64 s[54:55], s[20:21], v[66:67]
    s_nop 0
    s_or_b64 vcc, vcc, s[54:55]
    v_cmp_ne_u64 s[54:55], s[20:21], v[68:69]
    s_nop 0
    s_or_b64 vcc, vcc, s[54:55]
    s_cbranch_vccz L_mega_kernel_ok_64
    s_add_u32 s56, s56, 1
    s_cmp_lt_u32 s56, 0x100000
    s_cbranch_scc1 L_mega_kernel_poll_63
L_mega_kernel_ok_64:
L_mega_kernel_np_62:
    s_cmp_lg_u32 s42, 0
    s_cselect_b64 vcc, -1, 0
    s_cbranch_vccnz L_mega_kernel_c1_65
    v_mov_b32 v22, 0
    v_mov_b32 v23, 0
    s_waitcnt vmcnt(16)
    v_dot2_f32_bf16 v22, v92, v11, v22
    v_dot2_f32_bf16 v22, v93, v11, v22
    v_dot2_f32_bf16 v22, v94, v11, v22
    v_dot2_f32_bf16 v22, v95, v11, v22
    v_dot2_f32_bf16 v22, v96, v11, v22
    v_dot2_f32_bf16 v22, v97, v11, v22
    v_dot2_f32_bf16 v22, v98, v11, v22
    v_dot2_f32_bf16 v22, v99, v11, v22
    v_dot2_f32_bf16 v22, v100, v11, v22
    v_dot2_f32_bf16 v22, v101, v11, v22
    v_dot2_f32_bf16 v22, v102, v11, v22
    v_dot2_f32_bf16 v22, v103, v11, v22
    v_dot2_f32_bf16 v22, v104, v11, v22
    v_dot2_f32_bf16 v22, v105, v11, v22
    v_dot2_f32_bf16 v22, v106, v11, v22
    v_dot2_f32_bf16 v22, v107, v11, v22
    s_waitcnt vmcnt(12)
    v_dot2_f32_bf16 v22, v108, v11, v22
    v_dot2_f32_bf16 v22, v109, v11, v22
    v_dot2_f32_bf16 v22, v110, v11, v22
    v_dot2_f32_bf16 v22, v111, v11, v22
    v_dot2_f32_bf16 v22, v112, v11, v22
    v_dot2_f32_bf16 v22, v113, v11, v22
    v_dot2_f32_bf16 v22, v114, v11, v22
    v_dot2_f32_bf16 v22, v115, v11, v22
    v_dot2_f32_bf16 v22, v116, v11, v22
    v_dot2_f32_bf16 v22, v117, v11, v22
    v_dot2_f32_bf16 v22, v118, v11, v22
    v_dot2_f32_bf16 v22, v119, v11, v22
    v_dot2_f32_bf16 v22, v120, v11, v22
    v_dot2_f32_bf16 v22, v121, v11, v22
    v_dot2_f32_bf16 v22, v122, v11, v22
    v_dot2_f32_bf16 v22, v123, v11, v22
    s_waitcnt vmcnt(8)
    v_dot2_f32_bf16 v22, v124, v11, v22
    v_dot2_f32_bf16 v22, v125, v11, v22
    v_dot2_f32_bf16 v22, v126, v11, v22
    v_dot2_f32_bf16 v22, v127, v11, v22
    v_dot2_f32_bf16 v22, v128, v11, v22
    v_dot2_f32_bf16 v22, v129, v11, v22
    v_dot2_f32_bf16 v22, v130, v11, v22
    v_dot2_f32_bf16 v22, v131, v11, v22
    v_dot2_f32_bf16 v22, v132, v11, v22
    v_dot2_f32_bf16 v22, v133, v11, v22
    v_dot2_f32_bf16 v22, v134, v11, v22
    v_dot2_f32_bf16 v22, v135, v11, v22
    v_dot2_f32_bf16 v22, v136, v11, v22
    v_dot2_f32_bf16 v22, v137, v11, v22
    v_dot2_f32_bf16 v22, v138, v11, v22
    v_dot2_f32_bf16 v22, v139, v11, v22
    s_waitcnt vmcnt(4)
    v_dot2_f32_bf16 v22, v140, v11, v22
    v_dot2_f32_bf16 v22, v141, v11, v22
    v_dot2_f32_bf16 v22, v142, v11, v22
    v_dot2_f32_bf16 v22, v143, v11, v22
    v_dot2_f32_bf16 v22, v144, v11, v22
    v_dot2_f32_bf16 v22, v145, v11, v22
    v_dot2_f32_bf16 v22, v146, v11, v22
    v_dot2_f32_bf16 v22, v147, v11, v22
    v_dot2_f32_bf16 v22, v148, v11, v22
    v_dot2_f32_bf16 v22, v149, v11, v22
    v_dot2_f32_bf16 v22, v150, v11, v22
    v_dot2_f32_bf16 v22, v151, v11, v22
    v_dot2_f32_bf16 v22, v152, v11, v22
    v_dot2_f32_bf16 v22, v153, v11, v22
    v_dot2_f32_bf16 v22, v154, v11, v22
    v_dot2_f32_bf16 v22, v155, v11, v22
    s_waitcnt vmcnt(0)
    v_dot2_f32_bf16 v22, v156, v11, v22
    v_dot2_f32_bf16 v22, v157, v11, v22
    v_dot2_f32_bf16 v22, v158, v11, v22
    v_dot2_f32_bf16 v22, v159, v11, v22
    v_dot2_f32_bf16 v22, v160, v11, v22
    v_dot2_f32_bf16 v22, v161, v11, v22
    v_dot2_f32_bf16 v22, v162, v11, v22
    v_dot2_f32_bf16 v22, v163, v11, v22
    v_dot2_f32_bf16 v22, v164, v11, v22
    v_dot2_f32_bf16 v22, v165, v11, v22
    v_dot2_f32_bf16 v22, v166, v11, v22
    v_dot2_f32_bf16 v22, v167, v11, v22
    v_dot2_f32_bf16 v22, v168, v11, v22
    v_dot2_f32_bf16 v22, v169, v11, v22
    v_dot2_f32_bf16 v22, v170, v11, v22
    v_dot2_f32_bf16 v22, v171, v11, v22
L_mega_kernel_c1_65:
    s_barrier
    s_nop 0
    s_cbranch_vccz L_mega_kernel_nh_66
    s_add_u32 m0, s77, 0
    s_nop 0
    buffer_load_dwordx4 v10, s[64:67], s76 offen offset:0 sc1 lds
    buffer_load_dwordx4 v10, s[64:67], s76 offen offset:1024 sc1 lds
    s_add_u32 s76, s76, 8192
    s_add_u32 m0, s77, 8192
    s_nop 0
    buffer_load_dwordx4 v10, s[64:67], s76 offen offset:0 sc1 lds
    buffer_load_dwordx4 v10, s[64:67], s76 offen offset:1024 sc1 lds
    s_add_u32 s76, s76, 8192
    s_add_u32 m0, s77, 16384
    s_nop 0
    buffer_load_dwordx4 v10, s[64:67], s76 offen offset:0 sc1 lds
    buffer_load_dwordx4 v10, s[64:67], s76 offen offset:1024 sc1 lds
    s_add_u32 s76, s76, 8192
    s_add_u32 m0, s77, 24576
    s_nop 0
    buffer_load_dwordx4 v10, s[64:67], s76 offen offset:0 sc1 lds
    buffer_load_dwordx4 v10, s[64:67], s76 offen offset:1024 sc1 lds
    s_add_u32 s76, s76, 8192
    s_add_u32 m0, s77, 32768
    s_nop 0
    buffer_load_dwordx4 v10, s[64:67], s76 offen offset:0 sc1 lds
    buffer_load_dwordx4 v10, s[64:67], s76 offen offset:1024 sc1 lds
    s_add_u32 s76, s76, 8192
    s_add_u32 m0, s77, 40960
    s_nop 0
    buffer_load_dwordx4 v10, s[64:67], s76 offen offset:0 sc1 lds
    buffer_load_dwordx4 v10, s[64:67], s76 offen offset:1024 sc1 lds
    s_add_u32 s76, s76, 8192
    s_add_u32 m0, s77, 49152
    s_nop 0
    buffer_load_dwordx4 v10, s[64:67], s76 offen offset:0 sc1 lds
    buffer_load_dwordx4 v10, s[64:67], s76 offen offset:1024 sc1 lds
    s_add_u32 s76, s76, 8192
    s_add_u32 m0, s77, 57344
    s_nop 0
    buffer_load_dwordx4 v10, s[64:67], s76 offen offset:0 sc1 lds
    buffer_load_dwordx4 v10, s[64:67], s76 offen offset:1024 sc1 lds
    s_add_u32 s76, s76, 8192
L_mega_kernel_nh_66:
    v_mov_b32 v2, v22
    s_nop 1
    v_permlane32_swap_b32 v22, v2
    v_add_f32 v22, v22, v2
    ds_write_b32 v16, v22
    s_cbranch_vccz L_mega_kernel_rw_67
    s_waitcnt vmcnt(14)
L_mega_kernel_rw_67:
    s_barrier
    ds_read_b64_tr_b16 v[60:61], v18 offset:0
    ds_read_b64_tr_b16 v[62:63], v18 offset:512
    ds_read_b64_tr_b16 v[64:65], v19 offset:0
    ds_read_b64_tr_b16 v[66:67], v19 offset:512
    ds_read_b64_tr_b16 v[68:69], v20 offset:0
    ds_read_b64_tr_b16 v[70:71], v20 offset:512
    ds_read_b64_tr_b16 v[72:73], v21 offset:0
    ds_read_b64_tr_b16 v[74:75], v21 offset:512
    s_cbranch_vccz L_mega_kernel_rw_69
    s_waitcnt vmcnt(12)
L_mega_kernel_rw_69:
    s_barrier
    s_waitcnt lgkmcnt(6)
    v_mfma_f32_32x32x16_bf16 v[28:43], v[92:95], v[60:63], v[28:43]
    ds_read_b64_tr_b16 v[76:77], v18 offset:8192
    ds_read_b64_tr_b16 v[78:79], v18 offset:8704
    v_mfma_f32_4x4x4_16b_bf16 v[24:27], v[60:61], v[60:61], v[24:27]
    s_waitcnt lgkmcnt(6)
    v_mfma_f32_32x32x16_bf16 v[44:59], v[92:95], v[64:67], v[44:59]
    ds_read_b64_tr_b16 v[80:81], v19 offset:8192
    ds_read_b64_tr_b16 v[82:83], v19 offset:8704
    v_mfma_f32_4x4x4_16b_bf16 v[24:27], v[62:63], v[62:63], v[24:27]
    s_waitcnt lgkmcnt(6)
    v_mfma_f32_32x32x16_bf16 v[28:43], v[96:99], v[68:71], v[28:43]
    ds_read_b64_tr_b16 v[84:85], v20 offset:8192
    ds_read_b64_tr_b16 v[86:87], v20 offset:8704
    s_waitcnt lgkmcnt(6)
    v_mfma_f32_32x32x16_bf16 v[44:59], v[96:99], v[72:75], v[44:59]
    ds_read_b64_tr_b16 v[88:89], v21 offset:8192
    ds_read_b64_tr_b16 v[90:91], v21 offset:8704
    s_cbranch_vccz L_mega_kernel_rw_71
    s_waitcnt vmcnt(10)
L_mega_kernel_rw_71:
    s_barrier
    s_add_u32 m0, s32, 81920
    s_add_u32 s17, s52, 0
    buffer_load_dwordx4 v5, s[48:51], s17 offen lds
    s_add_u32 m0, s32, 90112
    s_add_u32 s17, s52, 128
    buffer_load_dwordx4 v5, s[48:51], s17 offen lds
    s_waitcnt lgkmcnt(6)
    v_mfma_f32_32x32x16_bf16 v[28:43], v[100:103], v[76:79], v[28:43]
    ds_read_b64_tr_b16 v[60:61], v18 offset:16384
    ds_read_b64_tr_b16 v[62:63], v18 offset:16896
    v_mfma_f32_4x4x4_16b_bf16 v[24:27], v[76:77], v[76:77], v[24:27]
    s_waitcnt lgkmcnt(6)
    v_mfma_f32_32x32x16_bf16 v[44:59], v[100:103], v[80:83], v[44:59]
    ds_read_b64_tr_b16 v[64:65], v19 offset:16384
    ds_read_b64_tr_b16 v[66:67], v19 offset:16896
    v_mfma_f32_4x4x4_16b_bf16 v[24:27], v[78:79], v[78:79], v[24:27]
    s_waitcnt lgkmcnt(6)
    v_mfma_f32_32x32x16_bf16 v[28:43], v[104:107], v[84:87], v[28:43]
    ds_read_b64_tr_b16 v[68:69], v20 offset:16384
    ds_read_b64_tr_b16 v[70:71], v20 offset:16896
    s_waitcnt lgkmcnt(6)
    v_mfma_f32_32x32x16_bf16 v[44:59], v[104:107], v[88:91], v[44:59]
    ds_read_b64_tr_b16 v[72:73], v21 offset:16384
    ds_read_b64_tr_b16 v[74:75], v21 offset:16896
    s_cbranch_vccz L_mega_kernel_rw_73
    s_waitcnt vmcnt(10)
L_mega_kernel_rw_73:
    s_barrier
    s_cmp_lg_u32 s16, 5
    s_cbranch_scc1 L_mega_kernel_g4_75
    v_lshlrev_b32 v92, 9, v1
    v_add_u32 v92, 163840, v92
    buffer_load_dwordx2 v[94:95], v92, s[44:47], 0 offen offset:0 sc1
    buffer_load_dwordx2 v[96:97], v92, s[44:47], 0 offen offset:128 sc1
    buffer_load_dwordx2 v[98:99], v92, s[44:47], 0 offen offset:256 sc1
    buffer_load_dwordx2 v[100:101], v92, s[44:47], 0 offen offset:384 sc1
L_mega_kernel_g4_75:
    s_add_u32 m0, s32, 98304
    s_add_u32 s17, s52, 256
    buffer_load_dwordx4 v5, s[48:51], s17 offen lds
    s_add_u32 m0, s32, 106496
    s_add_u32 s17, s52, 384
    buffer_load_dwordx4 v5, s[48:51], s17 offen lds
    s_waitcnt lgkmcnt(6)
    v_mfma_f32_32x32x16_bf16 v[28:43], v[108:111], v[60:63], v[28:43]
    ds_read_b64_tr_b16 v[76:77], v18 offset:24576
    ds_read_b64_tr_b16 v[78:79], v18 offset:25088
    v_mfma_f32_4x4x4_16b_bf16 v[24:27], v[60:61], v[60:61], v[24:27]
    s_waitcnt lgkmcnt(6)
    v_mfma_f32_32x32x16_bf16 v[44:59], v[108:111], v[64:67], v[44:59]
    ds_read_b64_tr_b16 v[80:81], v19 offset:24576
    ds_read_b64_tr_b16 v[82:83], v19 offset:25088
    v_mfma_f32_4x4x4_16b_bf16 v[24:27], v[62:63], v[62:63], v[24:27]
    s_waitcnt lgkmcnt(6)
    v_mfma_f32_32x32x16_bf16 v[28:43], v[112:115], v[68:71], v[28:43]
    ds_read_b64_tr_b16 v[84:85], v20 offset:24576
    ds_read_b64_tr_b16 v[86:87], v20 offset:25088
    s_waitcnt lgkmcnt(6)
    v_mfma_f32_32x32x16_bf16 v[44:59], v[112:115], v[72:75], v[44:59]
    ds_read_b64_tr_b16 v[88:89], v21 offset:24576
    ds_read_b64_tr_b16 v[90:91], v21 offset:25088
    s_cbranch_vccz L_mega_kernel_rw_76
    s_waitcnt vmcnt(10)
L_mega_kernel_rw_76:
    s_barrier
    s_add_u32 m0, s32, 121344
    s_add_u32 s17, s52, 512
    buffer_load_dwordx4 v5, s[48:51], s17 offen lds
    s_add_u32 m0, s32, 129536
    s_add_u32 s17, s52, 640
    buffer_load_dwordx4 v5, s[48:51], s17 offen lds
    s_waitcnt lgkmcnt(6)
    v_mfma_f32_32x32x16_bf16 v[28:43], v[116:119], v[76:79], v[28:43]
    ds_read_b64_tr_b16 v[60:61], v18 offset:32768
    ds_read_b64_tr_b16 v[62:63], v18 offset:33280
    v_mfma_f32_4x4x4_16b_bf16 v[24:27], v[76:77], v[76:77], v[24:27]
    s_waitcnt lgkmcnt(6)
    v_mfma_f32_32x32x16_bf16 v[44:59], v[116:119], v[80:83], v[44:59]
    ds_read_b64_tr_b16 v[64:65], v19 offset:32768
    ds_read_b64_tr_b16 v[66:67], v19 offset:33280
    v_mfma_f32_4x4x4_16b_bf16 v[24:27], v[78:79], v[78:79], v[24:27]
    s_waitcnt lgkmcnt(6)
    v_mfma_f32_32x32x16_bf16 v[28:43], v[120:123], v[84:87], v[28:43]
    ds_read_b64_tr_b16 v[68:69], v20 offset:32768
    ds_read_b64_tr_b16 v[70:71], v20 offset:33280
    s_waitcnt lgkmcnt(6)
    v_mfma_f32_32x32x16_bf16 v[44:59], v[120:123], v[88:91], v[44:59]
    ds_read_b64_tr_b16 v[72:73], v21 offset:32768
    ds_read_b64_tr_b16 v[74:75], v21 offset:33280
    s_cbranch_vccnz L_mega_kernel_cl_78
    s_add_u32 s17, s24, 1310720
    buffer_load_dwordx4 v[172:175], v7, s[28:31], s17 offen sc1
    s_add_u32 s17, s25, 1310720
    buffer_load_dwordx4 v[176:179], v7, s[28:31], s17 offen sc1
    s_add_u32 s17, s24, 1327104
    buffer_load_dwordx4 v[180:183], v7, s[28:31], s17 offen sc1
    s_add_u32 s17, s25, 1327104
    buffer_load_dwordx4 v[184:187], v7, s[28:31], s17 offen sc1
L_mega_kernel_cl_78:
    s_cbranch_vccz L_mega_kernel_rw_79
    s_waitcnt vmcnt(10)
L_mega_kernel_rw_79:
    s_barrier
    s_add_u32 m0, s32, 137728
    s_add_u32 s17, s52, 768
    buffer_load_dwordx4 v5, s[48:51], s17 offen lds
    s_add_u32 m0, s32, 145920
    s_add_u32 s17, s52, 896
    buffer_load_dwordx4 v5, s[48:51], s17 offen lds
    s_waitcnt lgkmcnt(6)
    v_mfma_f32_32x32x16_bf16 v[28:43], v[124:127], v[60:63], v[28:43]
    ds_read_b64_tr_b16 v[76:77], v18 offset:40960
    ds_read_b64_tr_b16 v[78:79], v18 offset:41472
    v_mfma_f32_4x4x4_16b_bf16 v[24:27], v[60:61], v[60:61], v[24:27]
    s_waitcnt lgkmcnt(6)
    v_mfma_f32_32x32x16_bf16 v[44:59], v[124:127], v[64:67], v[44:59]
    ds_read_b64_tr_b16 v[80:81], v19 offset:40960
    ds_read_b64_tr_b16 v[82:83], v19 offset:41472
    v_mfma_f32_4x4x4_16b_bf16 v[24:27], v[62:63], v[62:63], v[24:27]
    s_waitcnt lgkmcnt(6)
    v_mfma_f32_32x32x16_bf16 v[28:43], v[128:131], v[68:71], v[28:43]
    ds_read_b64_tr_b16 v[84:85], v20 offset:40960
    ds_read_b64_tr_b16 v[86:87], v20 offset:41472
    s_waitcnt lgkmcnt(6)
    v_mfma_f32_32x32x16_bf16 v[44:59], v[128:131], v[72:75], v[44:59]
    ds_read_b64_tr_b16 v[88:89], v21 offset:40960
    ds_read_b64_tr_b16 v[90:91], v21 offset:41472
    s_cbranch_vccnz L_mega_kernel_cl_81
    s_add_u32 s17, s24, 1343488
    buffer_load_dwordx4 v[188:191], v7, s[28:31], s17 offen sc1
    s_add_u32 s17, s25, 1343488
    buffer_load_dwordx4 v[192:195], v7, s[28:31], s17 offen sc1
    s_add_u32 s17, s24, 1359872
    buffer_load_dwordx4 v[196:199], v7, s[28:31], s17 offen sc1
    s_add_u32 s17, s25, 1359872
    buffer_load_dwordx4 v[200:203], v7, s[28:31], s17 offen sc1
L_mega_kernel_cl_81:
    s_cbranch_vccz L_mega_kernel_rw_82
    s_waitcnt vmcnt(6)
    s_branch L_mega_kernel_rx_83
L_mega_kernel_rw_82:
    s_waitcnt vmcnt(14)
L_mega_kernel_rx_83:
    s_cmp_lg_u32 s16, 5
    s_cbranch_scc1 L_mega_kernel_g5_84
    s_waitcnt vmcnt(6)
    v_cmp_ne_u64 vcc, s[20:21], v[94:95]
    v_cmp_ne_u64 s[54:55], s[20:21], v[96:97]
    s_nop 0
    s_or_b64 vcc, vcc, s[54:55]
    v_cmp_ne_u64 s[54:55], s[20:21], v[98:99]
    s_nop 0
    s_or_b64 vcc, vcc, s[54:55]
    v_cmp_ne_u64 s[54:55], s[20:21], v[100:101]
    s_nop 0
    s_or_b64 vcc, vcc, s[54:55]
    s_cbranch_vccz L_mega_kernel_g7_85
    s_mov_b32 s56, 0
L_mega_kernel_poll_86:
    buffer_load_dwordx2 v[94:95], v92, s[44:47], 0 offen offset:0 sc1
    buffer_load_dwordx2 v[96:97], v92, s[44:47], 0 offen offset:128 sc1
    buffer_load_dwordx2 v[98:99], v92, s[44:47], 0 offen offset:256 sc1
    buffer_load_dwordx2 v[100:101], v92, s[44:47], 0 offen offset:384 sc1
    s_waitcnt vmcnt(0)
    v_cmp_ne_u64 vcc, s[20:21], v[94:95]
    v_cmp_ne_u64 s[54:55], s[20:21], v[96:97]
    s_nop 0
    s_or_b64 vcc, vcc, s[54:55]
    v_cmp_ne_u64 s[54:55], s[20:21], v[98:99]
    s_nop 0
    s_or_b64 vcc, vcc, s[54:55]
    v_cmp_ne_u64 s[54:55], s[20:21], v[100:101]
    s_nop 0
    s_or_b64 vcc, vcc, s[54:55]
    s_cbranch_vccz L_mega_kernel_ok_87
    s_add_u32 s56, s56, 1
    s_cmp_lt_u32 s56, 0x100000
    s_cbranch_scc1 L_mega_kernel_poll_86
L_mega_kernel_ok_87:
L_mega_kernel_g7_85:
    s_mov_b64 vcc, -1
L_mega_kernel_g5_84:
    s_barrier
    s_cbranch_vccz L_mega_kernel_g6_88
    s_add_u32 m0, s77, 65536
    s_nop 0
    buffer_load_dwordx4 v10, s[64:67], s76 offen offset:0 sc1 lds
    buffer_load_dwordx4 v10, s[64:67], s76 offen offset:1024 sc1 lds
    s_add_u32 s76, s76, 8192
    s_add_u32 m0, s77, 73728
    s_nop 0
    buffer_load_dwordx4 v10, s[64:67], s76 offen offset:0 sc1 lds
    buffer_load_dwordx4 v10, s[64:67], s76 offen offset:1024 sc1 lds
    s_add_u32 s76, s76, 8192
L_mega_kernel_g6_88:
    s_waitcnt lgkmcnt(6)
    v_mfma_f32_32x32x16_bf16 v[28:43], v[132:135], v[76:79], v[28:43]
    ds_read_b128 v[124:127], v6 offset:0
    ds_read_b128 v[128:131], v6 offset:8192
    ds_read_b64_tr_b16 v[60:61], v18 offset:49152
    ds_read_b64_tr_b16 v[62:63], v18 offset:49664
    v_mfma_f32_4x4x4_16b_bf16 v[24:27], v[76:77], v[76:77], v[24:27]
    s_waitcnt lgkmcnt(8)
    v_mfma_f32_32x32x16_bf16 v[44:59], v[132:135], v[80:83], v[44:59]
    ds_read_b64_tr_b16 v[64:65], v19 offset:49152
    ds_read_b64_tr_b16 v[66:67], v19 offset:49664
    v_mfma_f32_4x4x4_16b_bf16 v[24:27], v[78:79], v[78:79], v[24:27]
    s_waitcnt lgkmcnt(8)
    v_mfma_f32_32x32x16_bf16 v[28:43], v[136:139], v[84:87], v[28:43]
    ds_read_b64_tr_b16 v[68:69], v20 offset:49152
    ds_read_b64_tr_b16 v[70:71], v20 offset:49664
    s_waitcnt lgkmcnt(8)
    v_mfma_f32_32x32x16_bf16 v[44:59], v[136:139], v[88:91], v[44:59]
    ds_read_b64_tr_b16 v[72:73], v21 offset:49152
    ds_read_b64_tr_b16 v[74:75], v21 offset:49664
    v_add_u32 v18, 57344, v18
    v_add_u32 v19, 57344, v19
    v_add_u32 v20, 57344, v20
    v_add_u32 v21, 57344, v21
    s_waitcnt lgkmcnt(8)
    s_cbranch_vccnz L_mega_kernel_cl_89
    s_add_u32 s17, s24, 1376256
    buffer_load_dwordx4 v[204:207], v7, s[28:31], s17 offen sc1
    s_add_u32 s17, s25, 1376256
    buffer_load_dwordx4 v[208:211], v7, s[28:31], s17 offen sc1
    s_add_u32 s17, s24, 1392640
    buffer_load_dwordx4 v[212:215], v7, s[28:31], s17 offen sc1
    s_add_u32 s17, s25, 1392640
    buffer_load_dwordx4 v[216:219], v7, s[28:31], s17 offen sc1
L_mega_kernel_cl_89:
    s_cbranch_vccz L_mega_kernel_rw_90
    s_waitcnt vmcnt(8)
    s_branch L_mega_kernel_rx_91
L_mega_kernel_rw_90:
    s_waitcnt vmcnt(16)
L_mega_kernel_rx_91:
    s_barrier
    s_waitcnt lgkmcnt(6)
    v_mfma_f32_32x32x16_bf16 v[28:43], v[140:143], v[60:63], v[28:43]
    ds_read_b128 v[132:135], v6 offset:16384
    ds_read_b128 v[136:139], v6 offset:24576
    ds_read_b64_tr_b16 v[76:77], v18 offset:0
    ds_read_b64_tr_b16 v[78:79], v18 offset:512
    v_mfma_f32_4x4x4_16b_bf16 v[24:27], v[60:61], v[60:61], v[24:27]
    s_waitcnt lgkmcnt(8)
    v_mfma_f32_32x32x16_bf16 v[44:59], v[140:143], v[64:67], v[44:59]
    ds_read_b64_tr_b16 v[80:81], v19 offset:0
    ds_read_b64_tr_b16 v[82:83], v19 offset:512
    v_mfma_f32_4x4x4_16b_bf16 v[24:27], v[62:63], v[62:63], v[24:27]
    s_waitcnt lgkmcnt(8)
    v_mfma_f32_32x32x16_bf16 v[28:43], v[144:147], v[68:71], v[28:43]
    ds_read_b64_tr_b16 v[84:85], v20 offset:0
    ds_read_b64_tr_b16 v[86:87], v20 offset:512
    s_waitcnt lgkmcnt(8)
    v_mfma_f32_32x32x16_bf16 v[44:59], v[144:147], v[72:75], v[44:59]
    ds_read_b64_tr_b16 v[88:89], v21 offset:0
    ds_read_b64_tr_b16 v[90:91], v21 offset:512
    s_waitcnt lgkmcnt(8)
    s_cbranch_vccnz L_mega_kernel_cl_92
    s_add_u32 s17, s24, 1409024
    buffer_load_dwordx4 v[220:223], v7, s[28:31], s17 offen sc1
    s_add_u32 s17, s25, 1409024
    buffer_load_dwordx4 v[224:227], v7, s[28:31], s17 offen sc1
    s_add_u32 s17, s24, 1425408
    buffer_load_dwordx4 v[228:231], v7, s[28:31], s17 offen sc1
    s_add_u32 s17, s25, 1425408
    buffer_load_dwordx4 v[232:235], v7, s[28:31], s17 offen sc1
L_mega_kernel_cl_92:
    s_cbranch_vccz L_mega_kernel_rw_93
    s_waitcnt vmcnt(2)
    s_branch L_mega_kernel_rx_94
L_mega_kernel_rw_93:
    s_waitcnt vmcnt(18)
L_mega_kernel_rx_94:
    s_barrier
    s_waitcnt lgkmcnt(6)
    v_mfma_f32_32x32x16_bf16 v[28:43], v[148:151], v[76:79], v[28:43]
    ds_read_b128 v[140:143], v6 offset:39424
    ds_read_b128 v[144:147], v6 offset:47616
    ds_read_b64_tr_b16 v[60:61], v18 offset:8192
    ds_read_b64_tr_b16 v[62:63], v18 offset:8704
    v_mfma_f32_4x4x4_16b_bf16 v[24:27], v[76:77], v[76:77], v[24:27]
    s_waitcnt lgkmcnt(8)
    v_mfma_f32_32x32x16_bf16 v[44:59], v[148:151], v[80:83], v[44:59]
    ds_read_b64_tr_b16 v[64:65], v19 offset:8192
    ds_read_b64_tr_b16 v[66:67], v19 offset:8704
    v_mfma_f32_4x4x4_16b_bf16 v[24:27], v[78:79], v[78:79], v[24:27]
    s_waitcnt lgkmcnt(8)
    v_mfma_f32_32x32x16_bf16 v[28:43], v[152:155], v[84:87], v[28:43]
    ds_read_b64_tr_b16 v[68:69], v20 offset:8192
    ds_read_b64_tr_b16 v[70:71], v20 offset:8704
    s_waitcnt lgkmcnt(8)
    v_mfma_f32_32x32x16_bf16 v[44:59], v[152:155], v[88:91], v[44:59]
    ds_read_b64_tr_b16 v[72:73], v21 offset:8192
    ds_read_b64_tr_b16 v[74:75], v21 offset:8704
    s_waitcnt lgkmcnt(8)
    s_cbranch_vccnz L_mega_kernel_cl_95
    s_add_u32 s17, s24, 1441792
    buffer_load_dwordx4 v[236:239], v7, s[28:31], s17 offen sc1
    s_add_u32 s17, s25, 1441792
    buffer_load_dwordx4 v[240:243], v7, s[28:31], s17 offen sc1
    s_add_u32 s17, s24, 1458176
    buffer_load_dwordx4 v[244:247], v7, s[28:31], s17 offen sc1
    s_add_u32 s17, s25, 1458176
    buffer_load_dwordx4 v[248:251], v7, s[28:31], s17 offen sc1
L_mega_kernel_cl_95:
    s_cbranch_vccz L_mega_kernel_rw_96
    s_waitcnt vmcnt(0)
    s_branch L_mega_kernel_rx_97
L_mega_kernel_rw_96:
    s_waitcnt vmcnt(16)
L_mega_kernel_rx_97:
    s_barrier
    s_add_u32 m0, s32, 121344
    s_add_u32 s17, s52, 1024
    buffer_load_dwordx4 v5, s[48:51], s17 offen lds
    s_add_u32 m0, s32, 129536
    s_add_u32 s17, s52, 1152
    buffer_load_dwordx4 v5, s[48:51], s17 offen lds
    s_waitcnt lgkmcnt(6)
    v_mfma_f32_32x32x16_bf16 v[28:43], v[156:159], v[60:63], v[28:43]
    ds_read_b128 v[148:151], v6 offset:55808
    ds_read_b128 v[152:155], v6 offset:64000
    ds_read_b64_tr_b16 v[76:77], v18 offset:16384
    ds_read_b64_tr_b16 v[78:79], v18 offset:16896
    v_mfma_f32_4x4x4_16b_bf16 v[24:27], v[60:61], v[60:61], v[24:27]
    s_waitcnt lgkmcnt(8)
    v_mfma_f32_32x32x16_bf16 v[44:59], v[156:159], v[64:67], v[44:59]
    ds_read_b64_tr_b16 v[80:81], v19 offset:16384
    ds_read_b64_tr_b16 v[82:83], v19 offset:16896
    v_mfma_f32_4x4x4_16b_bf16 v[24:27], v[62:63], v[62:63], v[24:27]
    s_waitcnt lgkmcnt(8)
    v_mfma_f32_32x32x16_bf16 v[28:43], v[160:163], v[68:71], v[28:43]
    ds_read_b64_tr_b16 v[84:85], v20 offset:16384
    ds_read_b64_tr_b16 v[86:87], v20 offset:16896
    s_waitcnt lgkmcnt(8)
    v_mfma_f32_32x32x16_bf16 v[44:59], v[160:163], v[72:75], v[44:59]
    ds_read_b64_tr_b16 v[88:89], v21 offset:16384
    ds_read_b64_tr_b16 v[90:91], v21 offset:16896
    v_add_u32 v18, 4294909952, v18
    v_add_u32 v19, 4294909952, v19
    v_add_u32 v20, 4294909952, v20
    v_add_u32 v21, 4294909952, v21
    s_waitcnt lgkmcnt(8)
    s_waitcnt lgkmcnt(0)
    v_mfma_f32_32x32x16_bf16 v[28:43], v[164:167], v[76:79], v[28:43]
    v_mfma_f32_4x4x4_16b_bf16 v[24:27], v[76:77], v[76:77], v[24:27]
    v_mfma_f32_32x32x16_bf16 v[44:59], v[164:167], v[80:83], v[44:59]
    s_nop 0
    v_mfma_f32_4x4x4_16b_bf16 v[24:27], v[78:79], v[78:79], v[24:27]
    v_mfma_f32_32x32x16_bf16 v[28:43], v[168:171], v[84:87], v[28:43]
    v_mfma_f32_32x32x16_bf16 v[44:59], v[168:171], v[88:91], v[44:59]
    s_mov_b64 s[54:55], vcc
    s_mov_b32 vcc_lo, 0xaaaaaaaa
    s_mov_b32 vcc_hi, 0xaaaaaaaa
    v_cndmask_b32 v24, v24, v25, vcc
    v_cndmask_b32 v26, v26, v27, vcc
    s_mov_b32 vcc_lo, 0xcccccccc
    s_mov_b32 vcc_hi, 0xcccccccc
    v_cndmask_b32 v25, v24, v26, vcc
    s_mov_b64 vcc, s[54:55]
    v_mov_b32 v2, v25
    s_nop 1
    v_permlane32_swap_b32 v25, v2
    v_add_f32 v25, v25, v2
    s_and_b32 s17, s16, 1
    s_lshl_b32 s18, s42, 1
    s_add_u32 s17, s17, s18
    s_lshl_b32 s17, s17, 8
    v_add_u32 v2, s17, v15
    ds_write_b32 v2, v25 offset:4
    s_cmp_lg_u32 s22, 3
    s_cbranch_scc1 L_mega_kernel_m3_98
    v_xor_b32 v3, 1024, v2
    ds_write_b32 v2, v36
    ds_write_b32 v3, v52
L_mega_kernel_m3_98:
    v_add_u32 v3, 81920, v12
    ds_write_b128 v3, v[44:47] offset:0
    ds_write_b128 v3, v[48:51] offset:1024
    ds_write_b128 v3, v[52:55] offset:2048
    ds_write_b128 v3, v[56:59] offset:3072
    v_xor_b32 v3, 16384, v12
    v_add_u32 v3, 81920, v3
    s_lshl_b32 s17, s22, 7
    s_add_u32 s17, s17, 116736
    v_lshlrev_b32 v2, 4, v8
    v_add_u32 v2, s17, v2
    s_waitcnt lgkmcnt(0)
    s_barrier
    ds_read_b64 v[116:117], v15 offset:0
    ds_read_b64 v[118:119], v15 offset:256
    ds_read_b64 v[120:121], v15 offset:512
    ds_read_b64 v[122:123], v15 offset:768
    ds_read_b128 v[76:79], v3 offset:0
    ds_read_b128 v[80:83], v3 offset:1024
    ds_read_b128 v[84:87], v3 offset:2048
    ds_read_b128 v[88:91], v3 offset:3072
    ds_read_b128 v[100:103], v2 offset:0
    ds_read_b128 v[104:107], v2 offset:32
    ds_read_b128 v[108:111], v2 offset:64
    ds_read_b128 v[112:115], v2 offset:96
    ds_read_b128 v[44:47], v2 offset:512
    ds_read_b128 v[48:51], v2 offset:544
    ds_read_b128 v[52:55], v2 offset:576
    ds_read_b128 v[56:59], v2 offset:608
    s_waitcnt lgkmcnt(12)
    v_add_f32 v24, v118, v122
    v_add_f32 v116, v117, v119
    v_add_f32 v120, v121, v123
    v_add_f32 v25, v116, v120
    v_mul_f32 v24, 0x3acccccd, v24
    v_mul_f32 v25, 0x3acccccd, v25
    v_fma_f32 v25, -v24, v24, v25
    v_max_f32 v25, 0, v25
    v_cvt_pk_bf16_f32 v60, v24, v24
    v_lshlrev_b32 v60, 16, v60
    v_cvt_pk_bf16_f32 v25, v25, v25
    v_lshlrev_b32 v25, 16, v25
    v_add_f32 v25, 0x3727c5ac, v25
    v_cvt_pk_bf16_f32 v25, v25, v25
    v_lshlrev_b32 v25, 16, v25
    v_sqrt_f32 v25, v25
    s_nop 0
    v_cvt_pk_bf16_f32 v25, v25, v25
    v_lshlrev_b32 v25, 16, v25
    v_rcp_f32 v62, v25
    v_mov_b32 v22, v60
    v_mov_b32 v10, v62
    v_mul_f32 v65, v10, v10
    v_mul_f32 v64, 0xc0135761, v10
    v_mul_f32 v65, 0x3d372713, v65
    v_rcp_f32 v62, v10
    v_mul_f32 v65, v65, v64
    s_waitcnt lgkmcnt(8)
    v_pk_add_f32 v[28:29], v[28:29], v[76:77]
    v_pk_add_f32 v[30:31], v[30:31], v[78:79]
    v_pk_add_f32 v[32:33], v[32:33], v[80:81]
    v_pk_add_f32 v[34:35], v[34:35], v[82:83]
    v_pk_add_f32 v[36:37], v[36:37], v[84:85]
    v_pk_add_f32 v[38:39], v[38:39], v[86:87]
    v_pk_add_f32 v[40:41], v[40:41], v[88:89]
    v_pk_add_f32 v[42:43], v[42:43], v[90:91]
    s_waitcnt lgkmcnt(0)
    v_pk_add_f32 v[100:101], v[100:101], v[44:45]
    v_pk_add_f32 v[102:103], v[102:103], v[46:47]
    v_pk_add_f32 v[104:105], v[104:105], v[48:49]
    v_pk_add_f32 v[106:107], v[106:107], v[50:51]
    v_pk_add_f32 v[108:109], v[108:109], v[52:53]
    v_pk_add_f32 v[110:111], v[110:111], v[54:55]
    v_pk_add_f32 v[112:113], v[112:113], v[56:57]
    v_pk_add_f32 v[114:115], v[114:115], v[58:59]
    v_mov_b32 v24, 0
    v_mov_b32 v25, 0
    s_cmp_le_u32 s58, 0
    s_cbranch_scc1 L_mega_kernel_z2d_99
    v_pk_fma_f32 v[28:29], v[100:101], v[60:61], v[28:29] op_sel_hi:[1,0,1] neg_lo:[1,0,0] neg_hi:[1,0,0]
    v_pk_fma_f32 v[30:31], v[102:103], v[60:61], v[30:31] op_sel_hi:[1,0,1] neg_lo:[1,0,0] neg_hi:[1,0,0]
    v_pk_fma_f32 v[32:33], v[104:105], v[60:61], v[32:33] op_sel_hi:[1,0,1] neg_lo:[1,0,0] neg_hi:[1,0,0]
    v_pk_fma_f32 v[34:35], v[106:107], v[60:61], v[34:35] op_sel_hi:[1,0,1] neg_lo:[1,0,0] neg_hi:[1,0,0]
    v_pk_mul_f32 v[116:117], v[28:29], v[28:29]
    v_pk_mul_f32 v[118:119], v[30:31], v[30:31]
    v_pk_mul_f32 v[120:121], v[32:33], v[32:33]
    v_pk_mul_f32 v[122:123], v[34:35], v[34:35]
    v_pk_fma_f32 v[116:117], v[116:117], v[64:65], v[64:65] op_sel:[0,1,0] op_sel_hi:[1,1,0]
    v_pk_fma_f32 v[118:119], v[118:119], v[64:65], v[64:65] op_sel:[0,1,0] op_sel_hi:[1,1,0]
    v_pk_fma_f32 v[120:121], v[120:121], v[64:65], v[64:65] op_sel:[0,1,0] op_sel_hi:[1,1,0]
    v_pk_fma_f32 v[122:123], v[122:123], v[64:65], v[64:65] op_sel:[0,1,0] op_sel_hi:[1,1,0]
    v_pk_mul_f32 v[116:117], v[116:117], v[28:29]
    v_pk_mul_f32 v[118:119], v[118:119], v[30:31]
    v_pk_mul_f32 v[120:121], v[120:121], v[32:33]
    v_pk_mul_f32 v[122:123], v[122:123], v[34:35]
    v_exp_f32 v116, v116
    v_exp_f32 v118, v118
    v_exp_f32 v120, v120
    v_exp_f32 v122, v122
    v_exp_f32 v117, v117
    v_exp_f32 v119, v119
    v_exp_f32 v121, v121
    v_exp_f32 v123, v123
    v_pk_fma_f32 v[116:117], v[116:117], v[62:63], v[62:63] op_sel_hi:[1,0,0]
    v_pk_fma_f32 v[118:119], v[118:119], v[62:63], v[62:63] op_sel_hi:[1,0,0]
    v_pk_fma_f32 v[120:121], v[120:121], v[62:63], v[62:63] op_sel_hi:[1,0,0]
    v_pk_fma_f32 v[122:123], v[122:123], v[62:63], v[62:63] op_sel_hi:[1,0,0]
    v_rcp_f32 v116, v116
    v_rcp_f32 v118, v118
    v_rcp_f32 v120, v120
    v_rcp_f32 v122, v122
    v_rcp_f32 v117, v117
    v_rcp_f32 v119, v119
    v_rcp_f32 v121, v121
    v_rcp_f32 v123, v123
    v_pk_mul_f32 v[28:29], v[28:29], v[116:117]
    v_pk_mul_f32 v[30:31], v[30:31], v[118:119]
    v_pk_mul_f32 v[32:33], v[32:33], v[120:121]
    v_pk_mul_f32 v[34:35], v[34:35], v[122:123]
    v_cvt_pk_bf16_f32 v92, v28, v29
    v_cvt_pk_bf16_f32 v93, v30, v31
    v_cvt_pk_bf16_f32 v94, v32, v33
    v_cvt_pk_bf16_f32 v95, v34, v35
    v_dot2_f32_bf16 v24, v92, v11, v24
    v_dot2_f32_bf16 v25, v92, v92, v25
    v_dot2_f32_bf16 v24, v93, v11, v24
    v_dot2_f32_bf16 v25, v93, v93, v25
    v_dot2_f32_bf16 v24, v94, v11, v24
    v_dot2_f32_bf16 v25, v94, v94, v25
    v_dot2_f32_bf16 v24, v95, v11, v24
    v_dot2_f32_bf16 v25, v95, v95, v25
    s_cmp_le_u32 s58, 1
    s_cbranch_scc1 L_mega_kernel_z2d_99
    v_pk_fma_f32 v[36:37], v[108:109], v[60:61], v[36:37] op_sel_hi:[1,0,1] neg_lo:[1,0,0] neg_hi:[1,0,0]
    v_pk_fma_f32 v[38:39], v[110:111], v[60:61], v[38:39] op_sel_hi:[1,0,1] neg_lo:[1,0,0] neg_hi:[1,0,0]
    v_pk_fma_f32 v[40:41], v[112:113], v[60:61], v[40:41] op_sel_hi:[1,0,1] neg_lo:[1,0,0] neg_hi:[1,0,0]
    v_pk_fma_f32 v[42:43], v[114:115], v[60:61], v[42:43] op_sel_hi:[1,0,1] neg_lo:[1,0,0] neg_hi:[1,0,0]
    v_pk_mul_f32 v[116:117], v[36:37], v[36:37]
    v_pk_mul_f32 v[118:119], v[38:39], v[38:39]
    v_pk_mul_f32 v[120:121], v[40:41], v[40:41]
    v_pk_mul_f32 v[122:123], v[42:43], v[42:43]
    v_pk_fma_f32 v[116:117], v[116:117], v[64:65], v[64:65] op_sel:[0,1,0] op_sel_hi:[1,1,0]
    v_pk_fma_f32 v[118:119], v[118:119], v[64:65], v[64:65] op_sel:[0,1,0] op_sel_hi:[1,1,0]
    v_pk_fma_f32 v[120:121], v[120:121], v[64:65], v[64:65] op_sel:[0,1,0] op_sel_hi:[1,1,0]
    v_pk_fma_f32 v[122:123], v[122:123], v[64:65], v[64:65] op_sel:[0,1,0] op_sel_hi:[1,1,0]
    v_pk_mul_f32 v[116:117], v[116:117], v[36:37]
    v_pk_mul_f32 v[118:119], v[118:119], v[38:39]
    v_pk_mul_f32 v[120:121], v[120:121], v[40:41]
    v_pk_mul_f32 v[122:123], v[122:123], v[42:43]
    v_exp_f32 v116, v116
    v_exp_f32 v118, v118
    v_exp_f32 v120, v120
    v_exp_f32 v122, v122
    v_exp_f32 v117, v117
    v_exp_f32 v119, v119
    v_exp_f32 v121, v121
    v_exp_f32 v123, v123
    v_pk_fma_f32 v[116:117], v[116:117], v[62:63], v[62:63] op_sel_hi:[1,0,0]
    v_pk_fma_f32 v[118:119], v[118:119], v[62:63], v[62:63] op_sel_hi:[1,0,0]
    v_pk_fma_f32 v[120:121], v[120:121], v[62:63], v[62:63] op_sel_hi:[1,0,0]
    v_pk_fma_f32 v[122:123], v[122:123], v[62:63], v[62:63] op_sel_hi:[1,0,0]
    v_rcp_f32 v116, v116
    v_rcp_f32 v118, v118
    v_rcp_f32 v120, v120
    v_rcp_f32 v122, v122
    v_rcp_f32 v117, v117
    v_rcp_f32 v119, v119
    v_rcp_f32 v121, v121
    v_rcp_f32 v123, v123
    v_pk_mul_f32 v[36:37], v[36:37], v[116:117]
    v_pk_mul_f32 v[38:39], v[38:39], v[118:119]
    v_pk_mul_f32 v[40:41], v[40:41], v[120:121]
    v_pk_mul_f32 v[42:43], v[42:43], v[122:123]
    v_cvt_pk_bf16_f32 v96, v36, v37
    v_cvt_pk_bf16_f32 v97, v38, v39
    v_cvt_pk_bf16_f32 v98, v40, v41
    v_cvt_pk_bf16_f32 v99, v42, v43
    v_dot2_f32_bf16 v24, v96, v11, v24
    v_dot2_f32_bf16 v25, v96, v96, v25
    v_dot2_f32_bf16 v24, v97, v11, v24
    v_dot2_f32_bf16 v25, v97, v97, v25
    v_dot2_f32_bf16 v24, v98, v11, v24
    v_dot2_f32_bf16 v25, v98, v98, v25
    v_dot2_f32_bf16 v24, v99, v11, v24
    v_dot2_f32_bf16 v25, v99, v99, v25
L_mega_kernel_z2d_99:
    s_nop 1
    v_mov_b32 v2, v24
    s_nop 1
    v_permlane32_swap_b32 v24, v2
    v_add_f32 v24, v24, v2
    v_mov_b32 v2, v25
    s_nop 1
    v_permlane32_swap_b32 v25, v2
    v_add_f32 v25, v25, v2
    ds_write_b64 v17, v[24:25]
    s_waitcnt vmcnt(0)
    v_mov_b32 v28, 0
    v_mov_b32 v29, 0
    v_mov_b32 v30, 0
    v_mov_b32 v31, 0
    v_mov_b32 v32, 0
    v_mov_b32 v33, 0
    v_mov_b32 v34, 0
    v_mov_b32 v35, 0
    v_mov_b32 v36, 0
    v_mov_b32 v37, 0
    v_mov_b32 v38, 0
    v_mov_b32 v39, 0
    v_mov_b32 v40, 0
    v_mov_b32 v41, 0
    v_mov_b32 v42, 0
    v_mov_b32 v43, 0
    v_mov_b32 v44, 0
    v_mov_b32 v45, 0
    v_mov_b32 v46, 0
    v_mov_b32 v47, 0
    v_mov_b32 v48, 0
    v_mov_b32 v49, 0
    v_mov_b32 v50, 0
    v_mov_b32 v51, 0
    v_mov_b32 v52, 0
    v_mov_b32 v53, 0
    v_mov_b32 v54, 0
    v_mov_b32 v55, 0
    v_mov_b32 v56, 0
    v_mov_b32 v57, 0
    v_mov_b32 v58, 0
    v_mov_b32 v59, 0
    s_waitcnt lgkmcnt(0)
    s_barrier
    ds_read_b128 v[156:159], v6 offset:39424
    ds_read_b128 v[160:163], v6 offset:47616
    s_add_u32 m0, s32, 137728
    s_add_u32 s17, s52, 1280
    buffer_load_dwordx4 v5, s[48:51], s17 offen lds
    s_add_u32 m0, s32, 145920
    s_add_u32 s17, s52, 1408
    buffer_load_dwordx4 v5, s[48:51], s17 offen lds
    s_add_u32 m0, s32, 81920
    s_add_u32 s17, s52, 1536
    buffer_load_dwordx4 v5, s[48:51], s17 offen lds
    s_add_u32 m0, s32, 90112
    s_add_u32 s17, s52, 1664
    buffer_load_dwordx4 v5, s[48:51], s17 offen lds
    s_add_u32 m0, s32, 98304
    s_add_u32 s17, s52, 1792
    buffer_load_dwordx4 v5, s[48:51], s17 offen lds
    s_add_u32 m0, s32, 106496
    s_add_u32 s17, s52, 1920
    buffer_load_dwordx4 v5, s[48:51], s17 offen lds
    s_cmp_lg_u32 s16, 7
    s_cbranch_scc1 L_mega_kernel_w7_100
    v_lshlrev_b32 v2, 10, v8
    v_lshl_add_u32 v2, v9, 3, v2
    v_add_u32 v2, 118784, v2
    ds_read_b64 v[100:101], v2 offset:0
    ds_read_b64 v[102:103], v2 offset:256
    ds_read_b64 v[104:105], v2 offset:512
    ds_read_b64 v[106:107], v2 offset:768
    v_lshlrev_b32 v116, 3, v1
    s_lshl_b32 s18, s15, 9
    s_add_u32 s18, s18, s79
    s_waitcnt lgkmcnt(0)
    v_pk_add_f32 v[100:101], v[100:101], v[102:103]
    v_pk_add_f32 v[104:105], v[104:105], v[106:107]
    v_pk_add_f32 v[100:101], v[100:101], v[104:105]
    v_and_b32 v101, 0x7fffffff, v101
    buffer_store_dwordx2 v[100:101], v116, s[72:75], s18 offen sc0 sc1
L_mega_kernel_w7_100:
    s_cbranch_vccnz L_mega_kernel_c2_101
    v_dot2_f32_bf16 v23, v172, v11, v23
    v_dot2_f32_bf16 v23, v173, v11, v23
    v_dot2_f32_bf16 v23, v174, v11, v23
    v_dot2_f32_bf16 v23, v175, v11, v23
    v_dot2_f32_bf16 v23, v176, v11, v23
    v_dot2_f32_bf16 v23, v177, v11, v23
    v_dot2_f32_bf16 v23, v178, v11, v23
    v_dot2_f32_bf16 v23, v179, v11, v23
    v_dot2_f32_bf16 v23, v180, v11, v23
    v_dot2_f32_bf16 v23, v181, v11, v23
    v_dot2_f32_bf16 v23, v182, v11, v23
    v_dot2_f32_bf16 v23, v183, v11, v23
    v_dot2_f32_bf16 v23, v184, v11, v23
    v_dot2_f32_bf16 v23, v185, v11, v23
    v_dot2_f32_bf16 v23, v186, v11, v23
    v_dot2_f32_bf16 v23, v187, v11, v23
    v_dot2_f32_bf16 v23, v188, v11, v23
    v_dot2_f32_bf16 v23, v189, v11, v23
    v_dot2_f32_bf16 v23, v190, v11, v23
    v_dot2_f32_bf16 v23, v191, v11, v23
    v_dot2_f32_bf16 v23, v192, v11, v23
    v_dot2_f32_bf16 v23, v193, v11, v23
    v_dot2_f32_bf16 v23, v194, v11, v23
    v_dot2_f32_bf16 v23, v195, v11, v23
    v_dot2_f32_bf16 v23, v196, v11, v23
    v_dot2_f32_bf16 v23, v197, v11, v23
    v_dot2_f32_bf16 v23, v198, v11, v23
    v_dot2_f32_bf16 v23, v199, v11, v23
    v_dot2_f32_bf16 v23, v200, v11, v23
    v_dot2_f32_bf16 v23, v201, v11, v23
    v_dot2_f32_bf16 v23, v202, v11, v23
    v_dot2_f32_bf16 v23, v203, v11, v23
    v_dot2_f32_bf16 v23, v204, v11, v23
    v_dot2_f32_bf16 v23, v205, v11, v23
    v_dot2_f32_bf16 v23, v206, v11, v23
    v_dot2_f32_bf16 v23, v207, v11, v23
    v_dot2_f32_bf16 v23, v208, v11, v23
    v_dot2_f32_bf16 v23, v209, v11, v23
    v_dot2_f32_bf16 v23, v210, v11, v23
    v_dot2_f32_bf16 v23, v211, v11, v23
    v_dot2_f32_bf16 v23, v212, v11, v23
    v_dot2_f32_bf16 v23, v213, v11, v23
    v_dot2_f32_bf16 v23, v214, v11, v23
    v_dot2_f32_bf16 v23, v215, v11, v23
    v_dot2_f32_bf16 v23, v216, v11, v23
    v_dot2_f32_bf16 v23, v217, v11, v23
    v_dot2_f32_bf16 v23, v218, v11, v23
    v_dot2_f32_bf16 v23, v219, v11, v23
    v_dot2_f32_bf16 v23, v220, v11, v23
    v_dot2_f32_bf16 v23, v221, v11, v23
    v_dot2_f32_bf16 v23, v222, v11, v23
    v_dot2_f32_bf16 v23, v223, v11, v23
    v_dot2_f32_bf16 v23, v224, v11, v23
    v_dot2_f32_bf16 v23, v225, v11, v23
    v_dot2_f32_bf16 v23, v226, v11, v23
    v_dot2_f32_bf16 v23, v227, v11, v23
    v_dot2_f32_bf16 v23, v228, v11, v23
    v_dot2_f32_bf16 v23, v229, v11, v23
    v_dot2_f32_bf16 v23, v230, v11, v23
    v_dot2_f32_bf16 v23, v231, v11, v23
    v_dot2_f32_bf16 v23, v232, v11, v23
    v_dot2_f32_bf16 v23, v233, v11, v23
    v_dot2_f32_bf16 v23, v234, v11, v23
    v_dot2_f32_bf16 v23, v235, v11, v23
    v_dot2_f32_bf16 v23, v236, v11, v23
    v_dot2_f32_bf16 v23, v237, v11, v23
    v_dot2_f32_bf16 v23, v238, v11, v23
    v_dot2_f32_bf16 v23, v239, v11, v23
    v_dot2_f32_bf16 v23, v240, v11, v23
    v_dot2_f32_bf16 v23, v241, v11, v23
    v_dot2_f32_bf16 v23, v242, v11, v23
    v_dot2_f32_bf16 v23, v243, v11, v23
    v_dot2_f32_bf16 v23, v244, v11, v23
    v_dot2_f32_bf16 v23, v245, v11, v23
    v_dot2_f32_bf16 v23, v246, v11, v23
    v_dot2_f32_bf16 v23, v247, v11, v23
    v_dot2_f32_bf16 v23, v248, v11, v23
    v_dot2_f32_bf16 v23, v249, v11, v23
    v_dot2_f32_bf16 v23, v250, v11, v23
    v_dot2_f32_bf16 v23, v251, v11, v23
L_mega_kernel_c2_101:
    v_mul_u32_u24 v120, 1792, v8
    v_lshl_add_u32 v120, v9, 4, v120
    ds_read_b64_tr_b16 v[60:61], v18 offset:0
    ds_read_b64_tr_b16 v[62:63], v18 offset:512
    ds_read_b64_tr_b16 v[64:65], v19 offset:0
    ds_read_b64_tr_b16 v[66:67], v19 offset:512
    ds_read_b64_tr_b16 v[68:69], v20 offset:0
    ds_read_b64_tr_b16 v[70:71], v20 offset:512
    ds_read_b64_tr_b16 v[72:73], v21 offset:0
    ds_read_b64_tr_b16 v[74:75], v21 offset:512
    s_waitcnt lgkmcnt(8)
    v_lshlrev_b32 v118, 11, v8
    v_lshl_add_u32 v118, v9, 3, v118
    s_lshl_b32 s17, s57, 8
    s_add_u32 s79, s79, s17
    s_barrier
    s_add_u32 m0, s32, 121344
    s_add_u32 s17, s52, 2048
    buffer_load_dwordx4 v5, s[48:51], s17 offen lds
    s_add_u32 m0, s32, 129536
    s_add_u32 s17, s52, 2176
    buffer_load_dwordx4 v5, s[48:51], s17 offen lds
    s_waitcnt lgkmcnt(6)
    v_mfma_f32_32x32x16_bf16 v[28:43], v[172:175], v[60:63], v[28:43]
    ds_read_b64_tr_b16 v[76:77], v18 offset:8192
    ds_read_b64_tr_b16 v[78:79], v18 offset:8704
    s_waitcnt lgkmcnt(6)
    v_mfma_f32_32x32x16_bf16 v[44:59], v[172:175], v[64:67], v[44:59]
    ds_read_b64_tr_b16 v[80:81], v19 offset:8192
    ds_read_b64_tr_b16 v[82:83], v19 offset:8704
    s_waitcnt lgkmcnt(6)
    v_mfma_f32_32x32x16_bf16 v[28:43], v[176:179], v[68:71], v[28:43]
    ds_read_b64_tr_b16 v[84:85], v20 offset:8192
    ds_read_b64_tr_b16 v[86:87], v20 offset:8704
    s_waitcnt lgkmcnt(6)
    v_mfma_f32_32x32x16_bf16 v[44:59], v[176:179], v[72:75], v[44:59]
    ds_read_b64_tr_b16 v[88:89], v21 offset:8192
    ds_read_b64_tr_b16 v[90:91], v21 offset:8704
    s_waitcnt lgkmcnt(6)
    v_mfma_f32_32x32x16_bf16 v[28:43], v[180:183], v[76:79], v[28:43]
    ds_read_b64_tr_b16 v[60:61], v18 offset:16384
    ds_read_b64_tr_b16 v[62:63], v18 offset:16896
    s_waitcnt lgkmcnt(6)
    v_mfma_f32_32x32x16_bf16 v[44:59], v[180:183], v[80:83], v[44:59]
    ds_read_b64_tr_b16 v[64:65], v19 offset:16384
    ds_read_b64_tr_b16 v[66:67], v19 offset:16896
    s_waitcnt lgkmcnt(6)
    v_mfma_f32_32x32x16_bf16 v[28:43], v[184:187], v[84:87], v[28:43]
    ds_read_b64_tr_b16 v[68:69], v20 offset:16384
    ds_read_b64_tr_b16 v[70:71], v20 offset:16896
    s_waitcnt lgkmcnt(6)
    v_mfma_f32_32x32x16_bf16 v[44:59], v[184:187], v[88:91], v[44:59]
    ds_read_b64_tr_b16 v[72:73], v21 offset:16384
    ds_read_b64_tr_b16 v[74:75], v21 offset:16896
    s_waitcnt vmcnt(4)
    s_barrier
    s_waitcnt lgkmcnt(6)
    v_mfma_f32_32x32x16_bf16 v[28:43], v[188:191], v[60:63], v[28:43]
    ds_read_b128 v[164:167], v6 offset:55808
    ds_read_b128 v[168:171], v6 offset:64000
    ds_read_b128 v[172:175], v6 offset:0
    ds_read_b128 v[176:179], v6 offset:8192
    ds_read_b64_tr_b16 v[76:77], v18 offset:24576
    ds_read_b64_tr_b16 v[78:79], v18 offset:25088
    s_waitcnt lgkmcnt(10)
    v_mfma_f32_32x32x16_bf16 v[44:59], v[188:191], v[64:67], v[44:59]
    ds_read_b64_tr_b16 v[80:81], v19 offset:24576
    ds_read_b64_tr_b16 v[82:83], v19 offset:25088
    s_waitcnt lgkmcnt(10)
    v_mfma_f32_32x32x16_bf16 v[28:43], v[192:195], v[68:71], v[28:43]
    ds_read_b64_tr_b16 v[84:85], v20 offset:24576
    ds_read_b64_tr_b16 v[86:87], v20 offset:25088
    s_waitcnt lgkmcnt(10)
    v_mfma_f32_32x32x16_bf16 v[44:59], v[192:195], v[72:75], v[44:59]
    ds_read_b64_tr_b16 v[88:89], v21 offset:24576
    ds_read_b64_tr_b16 v[90:91], v21 offset:25088
    s_waitcnt lgkmcnt(8)
    buffer_load_dwordx2 v[100:101], v118, s[72:75], s79 offen offset:0 sc1
    buffer_load_dwordx2 v[102:103], v118, s[72:75], s79 offen offset:512 sc1
    buffer_load_dwordx2 v[104:105], v118, s[72:75], s79 offen offset:1024 sc1
    buffer_load_dwordx2 v[106:107], v118, s[72:75], s79 offen offset:1536 sc1
    s_waitcnt vmcnt(4)
    s_barrier
    s_add_u32 m0, s32, 137728
    s_add_u32 s17, s52, 2304
    buffer_load_dwordx4 v5, s[48:51], s17 offen lds
    s_add_u32 m0, s32, 145920
    s_add_u32 s17, s52, 2432
    buffer_load_dwordx4 v5, s[48:51], s17 offen lds
    s_waitcnt lgkmcnt(6)
    v_mfma_f32_32x32x16_bf16 v[28:43], v[196:199], v[76:79], v[28:43]
    ds_read_b128 v[180:183], v6 offset:16384
    ds_read_b128 v[184:187], v6 offset:24576
    ds_read_b128 v[188:191], v6 offset:39424
    ds_read_b128 v[192:195], v6 offset:47616
    ds_read_b64_tr_b16 v[60:61], v18 offset:32768
    ds_read_b64_tr_b16 v[62:63], v18 offset:33280
    s_waitcnt lgkmcnt(10)
    v_mfma_f32_32x32x16_bf16 v[44:59], v[196:199], v[80:83], v[44:59]
    ds_read_b64_tr_b16 v[64:65], v19 offset:32768
    ds_read_b64_tr_b16 v[66:67], v19 offset:33280
    s_waitcnt lgkmcnt(10)
    v_mfma_f32_32x32x16_bf16 v[28:43], v[200:203], v[84:87], v[28:43]
    ds_read_b64_tr_b16 v[68:69], v20 offset:32768
    ds_read_b64_tr_b16 v[70:71], v20 offset:33280
    s_waitcnt lgkmcnt(10)
    v_mfma_f32_32x32x16_bf16 v[44:59], v[200:203], v[88:91], v[44:59]
    ds_read_b64_tr_b16 v[72:73], v21 offset:32768
    ds_read_b64_tr_b16 v[74:75], v21 offset:33280
    s_waitcnt lgkmcnt(8)
    s_mov_b64 s[54:55], vcc
    s_waitcnt vmcnt(2)
    s_mov_b32 s56, 0
L_mega_kernel_poll_102:
    v_or3_b32 v2, v101, v103, v105
    v_or_b32 v2, v2, v107
    v_cmp_gt_i32 vcc, 0, v2
    s_cbranch_vccz L_mega_kernel_ok_103
    buffer_load_dwordx2 v[100:101], v118, s[72:75], s79 offen offset:0 sc1
    buffer_load_dwordx2 v[102:103], v118, s[72:75], s79 offen offset:512 sc1
    buffer_load_dwordx2 v[104:105], v118, s[72:75], s79 offen offset:1024 sc1
    buffer_load_dwordx2 v[106:107], v118, s[72:75], s79 offen offset:1536 sc1
    s_add_u32 s56, s56, 1
    s_waitcnt vmcnt(0)
    s_cmp_lt_u32 s56, 0x100000
    s_cbranch_scc1 L_mega_kernel_poll_102
L_mega_kernel_ok_103:
    s_mov_b64 vcc, s[54:55]
    v_pk_add_f32 v[100:101], v[100:101], v[102:103]
    v_pk_add_f32 v[104:105], v[104:105], v[106:107]
    v_pk_add_f32 v[100:101], v[100:101], v[104:105]
    v_mov_b32 v2, v100
    s_nop 1
    v_permlane32_swap_b32 v100, v2
    v_add_f32 v100, v100, v2
    v_mov_b32 v2, v101
    s_nop 1
    v_permlane32_swap_b32 v101, v2
    v_add_f32 v101, v101, v2
    v_mul_f32 v100, 0x3a97b426, v100
    v_mul_f32 v101, 0x3a97b426, v101
    v_fma_f32 v101, -v100, v100, v101
    v_max_f32 v101, 0, v101
    v_cvt_pk_bf16_f32 v116, v100, v100
    v_lshlrev_b32 v116, 16, v116
    v_cvt_pk_bf16_f32 v101, v101, v101
    v_lshlrev_b32 v101, 16, v101
    v_add_f32 v101, 0x3727c5ac, v101
    v_cvt_pk_bf16_f32 v101, v101, v101
    v_lshlrev_b32 v101, 16, v101
    v_sqrt_f32 v101, v101
    s_nop 0
    v_cvt_pk_bf16_f32 v101, v101, v101
    v_lshlrev_b32 v101, 16, v101
    v_rcp_f32 v117, v101
    s_cmp_le_u32 s58, 0
    s_cbranch_scc1 L_mega_kernel_z2rd_105
    v_lshlrev_b32 v100, 16, v92
    v_lshlrev_b32 v102, 16, v93
    v_lshlrev_b32 v104, 16, v94
    v_lshlrev_b32 v106, 16, v95
    v_and_b32 v101, 0xffff0000, v92
    v_and_b32 v103, 0xffff0000, v93
    v_and_b32 v105, 0xffff0000, v94
    v_and_b32 v107, 0xffff0000, v95
    v_pk_add_f32 v[100:101], v[100:101], v[116:117] op_sel_hi:[1,0] neg_lo:[0,1] neg_hi:[0,1]
    v_pk_add_f32 v[102:103], v[102:103], v[116:117] op_sel_hi:[1,0] neg_lo:[0,1] neg_hi:[0,1]
    v_pk_add_f32 v[104:105], v[104:105], v[116:117] op_sel_hi:[1,0] neg_lo:[0,1] neg_hi:[0,1]
    v_pk_add_f32 v[106:107], v[106:107], v[116:117] op_sel_hi:[1,0] neg_lo:[0,1] neg_hi:[0,1]
    v_pk_mul_f32 v[100:101], v[100:101], v[116:117] op_sel:[0,1] op_sel_hi:[1,1]
    v_pk_mul_f32 v[102:103], v[102:103], v[116:117] op_sel:[0,1] op_sel_hi:[1,1]
    v_pk_mul_f32 v[104:105], v[104:105], v[116:117] op_sel:[0,1] op_sel_hi:[1,1]
    v_pk_mul_f32 v[106:107], v[106:107], v[116:117] op_sel:[0,1] op_sel_hi:[1,1]
    v_cvt_pk_bf16_f32 v92, v100, v101
    v_cvt_pk_bf16_f32 v93, v102, v103
    v_cvt_pk_bf16_f32 v94, v104, v105
    v_cvt_pk_bf16_f32 v95, v106, v107
    ds_write_b64 v13, v[92:93] offset:0
    ds_write_b64 v13, v[94:95] offset:16
    s_cmp_le_u32 s58, 1
    s_cbranch_scc1 L_mega_kernel_z2rd_105
    v_lshlrev_b32 v100, 16, v96
    v_lshlrev_b32 v102, 16, v97
    v_lshlrev_b32 v104, 16, v98
    v_lshlrev_b32 v106, 16, v99
    v_and_b32 v101, 0xffff0000, v96
    v_and_b32 v103, 0xffff0000, v97
    v_and_b32 v105, 0xffff0000, v98
    v_and_b32 v107, 0xffff0000, v99
    v_pk_add_f32 v[100:101], v[100:101], v[116:117] op_sel_hi:[1,0] neg_lo:[0,1] neg_hi:[0,1]
    v_pk_add_f32 v[102:103], v[102:103], v[116:117] op_sel_hi:[1,0] neg_lo:[0,1] neg_hi:[0,1]
    v_pk_add_f32 v[104:105], v[104:105], v[116:117] op_sel_hi:[1,0] neg_lo:[0,1] neg_hi:[0,1]
    v_pk_add_f32 v[106:107], v[106:107], v[116:117] op_sel_hi:[1,0] neg_lo:[0,1] neg_hi:[0,1]
    v_pk_mul_f32 v[100:101], v[100:101], v[116:117] op_sel:[0,1] op_sel_hi:[1,1]
    v_pk_mul_f32 v[102:103], v[102:103], v[116:117] op_sel:[0,1] op_sel_hi:[1,1]
    v_pk_mul_f32 v[104:105], v[104:105], v[116:117] op_sel:[0,1] op_sel_hi:[1,1]
    v_pk_mul_f32 v[106:107], v[106:107], v[116:117] op_sel:[0,1] op_sel_hi:[1,1]
    v_cvt_pk_bf16_f32 v96, v100, v101
    v_cvt_pk_bf16_f32 v97, v102, v103
    v_cvt_pk_bf16_f32 v98, v104, v105
    v_cvt_pk_bf16_f32 v99, v106, v107
    ds_write_b64 v13, v[96:97] offset:32
    ds_write_b64 v13, v[98:99] offset:48
L_mega_kernel_z2rd_105:
    ds_read_b64_tr_b16 v[100:101], v14 offset:0
    ds_read_b64_tr_b16 v[102:103], v14 offset:960
    ds_read_b64_tr_b16 v[104:105], v14 offset:3840
    ds_read_b64_tr_b16 v[106:107], v14 offset:4800
    s_cmp_ge_u32 s58, 2
    s_cselect_b32 s17, -1, 0xffff
    s_cmp_eq_u32 s58, 0
    s_waitcnt lgkmcnt(0)
    s_cbranch_scc1 L_mega_kernel_z2st_104
    s_mov_b32 exec_lo, s17
    s_mov_b32 exec_hi, s17
    buffer_store_dwordx4 v[100:103], v120, s[68:71], s78 offen sc0 sc1
    buffer_store_dwordx4 v[104:107], v120, s[68:71], s78 offen offset:3584 sc0 sc1
    s_mov_b64 exec, -1
L_mega_kernel_z2st_104:
    s_waitcnt vmcnt(0)
    s_barrier
    s_add_u32 m0, s32, 121344
    s_add_u32 s17, s52, 2560
    buffer_load_dwordx4 v5, s[48:51], s17 offen lds
    s_add_u32 m0, s32, 129536
    s_add_u32 s17, s52, 2688
    buffer_load_dwordx4 v5, s[48:51], s17 offen lds
    v_mfma_f32_32x32x16_bf16 v[28:43], v[204:207], v[60:63], v[28:43]
    ds_read_b128 v[196:199], v6 offset:55808
    ds_read_b128 v[200:203], v6 offset:64000
    ds_read_b64_tr_b16 v[76:77], v18 offset:40960
    ds_read_b64_tr_b16 v[78:79], v18 offset:41472
    v_mfma_f32_32x32x16_bf16 v[44:59], v[204:207], v[64:67], v[44:59]
    ds_read_b64_tr_b16 v[80:81], v19 offset:40960
    ds_read_b64_tr_b16 v[82:83], v19 offset:41472
    v_mfma_f32_32x32x16_bf16 v[28:43], v[208:211], v[68:71], v[28:43]
    ds_read_b64_tr_b16 v[84:85], v20 offset:40960
    ds_read_b64_tr_b16 v[86:87], v20 offset:41472
    v_mfma_f32_32x32x16_bf16 v[44:59], v[208:211], v[72:75], v[44:59]
    ds_read_b64_tr_b16 v[88:89], v21 offset:40960
    ds_read_b64_tr_b16 v[90:91], v21 offset:41472
    s_waitcnt lgkmcnt(8)
    s_barrier
    s_add_u32 m0, s32, 137728
    s_add_u32 s17, s52, 2816
    buffer_load_dwordx4 v5, s[48:51], s17 offen lds
    s_add_u32 m0, s32, 145920
    s_add_u32 s17, s52, 2944
    buffer_load_dwordx4 v5, s[48:51], s17 offen lds
    s_waitcnt lgkmcnt(6)
    v_mfma_f32_32x32x16_bf16 v[28:43], v[212:215], v[76:79], v[28:43]
    ds_read_b64_tr_b16 v[60:61], v18 offset:49152
    ds_read_b64_tr_b16 v[62:63], v18 offset:49664
    s_waitcnt lgkmcnt(6)
    v_mfma_f32_32x32x16_bf16 v[44:59], v[212:215], v[80:83], v[44:59]
    ds_read_b64_tr_b16 v[64:65], v19 offset:49152
    ds_read_b64_tr_b16 v[66:67], v19 offset:49664
    s_waitcnt lgkmcnt(6)
    v_mfma_f32_32x32x16_bf16 v[28:43], v[216:219], v[84:87], v[28:43]
    ds_read_b64_tr_b16 v[68:69], v20 offset:49152
    ds_read_b64_tr_b16 v[70:71], v20 offset:49664
    s_waitcnt lgkmcnt(6)
    v_mfma_f32_32x32x16_bf16 v[44:59], v[216:219], v[88:91], v[44:59]
    ds_read_b64_tr_b16 v[72:73], v21 offset:49152
    ds_read_b64_tr_b16 v[74:75], v21 offset:49664
    v_add_u32 v18, 57344, v18
    v_add_u32 v19, 57344, v19
    v_add_u32 v20, 57344, v20
    v_add_u32 v21, 57344, v21
    s_waitcnt vmcnt(0)
    s_mov_b64 s[54:55], vcc
    s_lshl_b32 s76, s15, 5
    s_add_u32 s76, s76, s14
    v_mov_b32 v2, 161836
    v_mov_b32 v3, 1
    s_mov_b64 exec, 1
    ds_add_rtn_u32 v3, v2, v3
    s_waitcnt lgkmcnt(0)
    v_cmp_eq_u32 vcc, 7, v3
    s_mov_b64 exec, -1
    s_cbranch_vccz L_mega_kernel_np_106
    s_lshl_b32 s17, s76, 7
    v_mov_b32 v2, 65536
    v_mov_b32 v108, s20
    v_mov_b32 v109, s21
    s_mov_b64 exec, 1
    buffer_store_dwordx2 v[108:109], v2, s[44:47], s17 offen sc0 sc1
    s_mov_b64 exec, -1
L_mega_kernel_np_106:
    s_mov_b64 vcc, s[54:55]
    s_barrier
    s_add_u32 m0, s32, 81920
    s_add_u32 s17, s52, 3072
    buffer_load_dwordx4 v5, s[48:51], s17 offen lds
    s_add_u32 m0, s32, 90112
    s_add_u32 s17, s52, 3200
    buffer_load_dwordx4 v5, s[48:51], s17 offen lds
    v_mfma_f32_32x32x16_bf16 v[28:43], v[220:223], v[60:63], v[28:43]
    ds_read_b128 v[204:207], v6 offset:39424
    ds_read_b128 v[208:211], v6 offset:47616
    ds_read_b64_tr_b16 v[76:77], v18 offset:0
    ds_read_b64_tr_b16 v[78:79], v18 offset:512
    v_mfma_f32_32x32x16_bf16 v[44:59], v[220:223], v[64:67], v[44:59]
    ds_read_b64_tr_b16 v[80:81], v19 offset:0
    ds_read_b64_tr_b16 v[82:83], v19 offset:512
    v_mfma_f32_32x32x16_bf16 v[28:43], v[224:227], v[68:71], v[28:43]
    ds_read_b64_tr_b16 v[84:85], v20 offset:0
    ds_read_b64_tr_b16 v[86:87], v20 offset:512
    v_mfma_f32_32x32x16_bf16 v[44:59], v[224:227], v[72:75], v[44:59]
    ds_read_b64_tr_b16 v[88:89], v21 offset:0
    ds_read_b64_tr_b16 v[90:91], v21 offset:512
    s_waitcnt lgkmcnt(8)
    s_barrier
    s_add_u32 m0, s32, 121344
    s_add_u32 s17, s52, 3328
    buffer_load_dwordx4 v5, s[48:51], s17 offen lds
    s_add_u32 m0, s32, 129536
    s_add_u32 s17, s52, 3456
    buffer_load_dwordx4 v5, s[48:51], s17 offen lds
    s_waitcnt lgkmcnt(6)
    v_mfma_f32_32x32x16_bf16 v[28:43], v[228:231], v[76:79], v[28:43]
    ds_read_b128 v[212:215], v6 offset:55808
    ds_read_b128 v[216:219], v6 offset:64000
    ds_read_b64_tr_b16 v[60:61], v18 offset:8192
    ds_read_b64_tr_b16 v[62:63], v18 offset:8704
    s_waitcnt lgkmcnt(8)
    v_mfma_f32_32x32x16_bf16 v[44:59], v[228:231], v[80:83], v[44:59]
    ds_read_b64_tr_b16 v[64:65], v19 offset:8192
    ds_read_b64_tr_b16 v[66:67], v19 offset:8704
    s_waitcnt lgkmcnt(8)
    v_mfma_f32_32x32x16_bf16 v[28:43], v[232:235], v[84:87], v[28:43]
    ds_read_b64_tr_b16 v[68:69], v20 offset:8192
    ds_read_b64_tr_b16 v[70:71], v20 offset:8704
    s_waitcnt lgkmcnt(8)
    v_mfma_f32_32x32x16_bf16 v[44:59], v[232:235], v[88:91], v[44:59]
    ds_read_b64_tr_b16 v[72:73], v21 offset:8192
    ds_read_b64_tr_b16 v[74:75], v21 offset:8704
    s_waitcnt lgkmcnt(8)
    s_barrier
    s_add_u32 m0, s32, 137728
    s_add_u32 s17, s52, 3584
    buffer_load_dwordx4 v5, s[48:51], s17 offen lds
    s_add_u32 m0, s32, 145920
    s_add_u32 s17, s52, 3712
    buffer_load_dwordx4 v5, s[48:51], s17 offen lds
    s_waitcnt lgkmcnt(6)
    v_mfma_f32_32x32x16_bf16 v[28:43], v[236:239], v[60:63], v[28:43]
    ds_read_b64_tr_b16 v[76:77], v18 offset:16384
    ds_read_b64_tr_b16 v[78:79], v18 offset:16896
    s_waitcnt lgkmcnt(6)
    v_mfma_f32_32x32x16_bf16 v[44:59], v[236:239], v[64:67], v[44:59]
    ds_read_b64_tr_b16 v[80:81], v19 offset:16384
    ds_read_b64_tr_b16 v[82:83], v19 offset:16896
    s_waitcnt lgkmcnt(6)
    v_mfma_f32_32x32x16_bf16 v[28:43], v[240:243], v[68:71], v[28:43]
    ds_read_b64_tr_b16 v[84:85], v20 offset:16384
    ds_read_b64_tr_b16 v[86:87], v20 offset:16896
    s_waitcnt lgkmcnt(6)
    v_mfma_f32_32x32x16_bf16 v[44:59], v[240:243], v[72:75], v[44:59]
    ds_read_b64_tr_b16 v[88:89], v21 offset:16384
    ds_read_b64_tr_b16 v[90:91], v21 offset:16896
    v_add_u32 v18, 4294909952, v18
    v_add_u32 v19, 4294909952, v19
    v_add_u32 v20, 4294909952, v20
    v_add_u32 v21, 4294909952, v21
    s_lshl_b32 s76, s15, 5
    v_and_b32 v108, 31, v1
    v_lshlrev_b32 v108, 7, v108
    s_lshl_b32 s17, s76, 7
    v_add_u32 v108, s17, v108
    v_add_u32 v108, 65536, v108
    s_cmp_lg_u32 s16, 0
    s_cbranch_scc1 L_mega_kernel_q0_107
    buffer_load_dwordx2 v[110:111], v108, s[44:47], 0 offen offset:0 sc1
L_mega_kernel_q0_107:
    s_waitcnt vmcnt(4)
    s_barrier
    s_add_u32 m0, s32, 98304
    s_add_u32 s17, s52, 3840
    buffer_load_dwordx4 v5, s[48:51], s17 offen lds
    s_add_u32 m0, s32, 106496
    s_add_u32 s17, s52, 3968
    buffer_load_dwordx4 v5, s[48:51], s17 offen lds
    s_waitcnt lgkmcnt(6)
    v_mfma_f32_32x32x16_bf16 v[28:43], v[244:247], v[76:79], v[28:43]
    ds_read_b128 v[220:223], v6 offset:0
    ds_read_b128 v[224:227], v6 offset:8192
    s_waitcnt lgkmcnt(6)
    v_mfma_f32_32x32x16_bf16 v[44:59], v[244:247], v[80:83], v[44:59]
    s_waitcnt lgkmcnt(4)
    v_mfma_f32_32x32x16_bf16 v[28:43], v[248:251], v[84:87], v[28:43]
    s_waitcnt lgkmcnt(2)
    v_mfma_f32_32x32x16_bf16 v[44:59], v[248:251], v[88:91], v[44:59]
    s_waitcnt lgkmcnt(0)
    v_mov_b32 v2, v23
    s_nop 1
    v_permlane32_swap_b32 v23, v2
    v_add_f32 v23, v23, v2
    ds_write_b32 v16, v23 offset:1024
    s_waitcnt vmcnt(0)
    s_cmp_lg_u32 s16, 0
    s_nop 0
    s_cbranch_scc1 L_mega_kernel_q1_108
    s_mov_b32 s56, 0
L_mega_kernel_poll_109:
    s_waitcnt vmcnt(0)
    v_cmp_ne_u64 vcc, s[20:21], v[110:111]
    s_cbranch_vccz L_mega_kernel_ok_110
    buffer_load_dwordx2 v[110:111], v108, s[44:47], 0 offen offset:0 sc1
    s_add_u32 s56, s56, 1
    s_cmp_lt_u32 s56, 0x100000
    s_cbranch_scc1 L_mega_kernel_poll_109
L_mega_kernel_ok_110:
L_mega_kernel_q1_108:
    v_add_u32 v3, 49152, v12
    ds_write_b128 v3, v[44:47] offset:0
    ds_write_b128 v3, v[48:51] offset:1024
    ds_write_b128 v3, v[52:55] offset:2048
    ds_write_b128 v3, v[56:59] offset:3072
    v_xor_b32 v3, 16384, v12
    v_add_u32 v3, 49152, v3
    s_lshl_b32 s17, s22, 7
    s_add_u32 s17, s17, 117760
    v_lshlrev_b32 v2, 4, v8
    v_add_u32 v2, s17, v2
    s_waitcnt lgkmcnt(0)
    s_barrier
    ds_read_b128 v[228:231], v6 offset:39424
    ds_read_b128 v[232:235], v6 offset:47616
    ds_read_b128 v[236:239], v6 offset:55808
    ds_read_b128 v[240:243], v6 offset:64000
    ds_read_b128 v[244:247], v6 offset:16384
    ds_read_b128 v[248:251], v6 offset:24576
    s_waitcnt lgkmcnt(0)
    ds_read_b128 v[76:79], v3 offset:0
    ds_read_b128 v[80:83], v3 offset:1024
    ds_read_b128 v[84:87], v3 offset:2048
    ds_read_b128 v[88:91], v3 offset:3072
    ds_read_b128 v[100:103], v2 offset:0
    ds_read_b128 v[104:107], v2 offset:32
    ds_read_b128 v[108:111], v2 offset:64
    ds_read_b128 v[112:115], v2 offset:96
    ds_read_b128 v[44:47], v2 offset:512
    ds_read_b128 v[48:51], v2 offset:544
    ds_read_b128 v[52:55], v2 offset:576
    ds_read_b128 v[56:59], v2 offset:608
    s_add_u32 s36, s6, 0x1400000
    s_addc_u32 s37, s7, 0
    s_mov_b32 s38, 0x380000
    s_mov_b32 s39, 0x00020000
    s_mul_i32 s41, s16, 1792
    s_mul_i32 s40, s15, 458752
    s_add_u32 s40, s40, s41
    s_mov_b32 s35, s40
    s_add_u32 s34, s40, 458752
    s_mul_i32 s17, s33, 14336
    s_add_u32 s40, s40, s17
    s_add_u32 m0, s41, 16384
    s_nop 0
    buffer_load_dwordx4 v4, s[36:39], s40 offen sc1 lds
    s_mov_b32 exec_hi, 0xffff
    buffer_load_dwordx4 v4, s[36:39], s40 offen offset:1024 sc1 lds
    s_mov_b32 exec_hi, -1
    s_add_u32 s40, s40, 14336
    s_add_u32 m0, s41, 30720
    s_nop 0
    buffer_load_dwordx4 v4, s[36:39], s40 offen sc1 lds
    s_mov_b32 exec_hi, 0xffff
    buffer_load_dwordx4 v4, s[36:39], s40 offen offset:1024 sc1 lds
    s_mov_b32 exec_hi, -1
    s_add_u32 s40, s40, 14336
    v_mov_b32 v60, v22
    v_mul_f32 v65, v10, v10
    v_mul_f32 v64, 0xc0135761, v10
    v_mul_f32 v65, 0x3d372713, v65
    v_rcp_f32 v62, v10
    v_mul_f32 v65, v65, v64
    s_waitcnt lgkmcnt(8)
    v_pk_add_f32 v[28:29], v[28:29], v[76:77]
    v_pk_add_f32 v[30:31], v[30:31], v[78:79]
    v_pk_add_f32 v[32:33], v[32:33], v[80:81]
    v_pk_add_f32 v[34:35], v[34:35], v[82:83]
    v_pk_add_f32 v[36:37], v[36:37], v[84:85]
    v_pk_add_f32 v[38:39], v[38:39], v[86:87]
    v_pk_add_f32 v[40:41], v[40:41], v[88:89]
    v_pk_add_f32 v[42:43], v[42:43], v[90:91]
    s_waitcnt lgkmcnt(0)
    v_pk_add_f32 v[100:101], v[100:101], v[44:45]
    v_pk_add_f32 v[102:103], v[102:103], v[46:47]
    v_pk_add_f32 v[104:105], v[104:105], v[48:49]
    v_pk_add_f32 v[106:107], v[106:107], v[50:51]
    v_pk_add_f32 v[108:109], v[108:109], v[52:53]
    v_pk_add_f32 v[110:111], v[110:111], v[54:55]
    v_pk_add_f32 v[112:113], v[112:113], v[56:57]
    v_pk_add_f32 v[114:115], v[114:115], v[58:59]
    v_add_u32 v3, 0, v13
    s_cmp_le_u32 s58, 0
    s_cbranch_scc1 L_mega_kernel_z1d_111
    v_pk_fma_f32 v[28:29], v[100:101], v[60:61], v[28:29] op_sel_hi:[1,0,1] neg_lo:[1,0,0] neg_hi:[1,0,0]
    v_pk_fma_f32 v[30:31], v[102:103], v[60:61], v[30:31] op_sel_hi:[1,0,1] neg_lo:[1,0,0] neg_hi:[1,0,0]
    v_pk_fma_f32 v[32:33], v[104:105], v[60:61], v[32:33] op_sel_hi:[1,0,1] neg_lo:[1,0,0] neg_hi:[1,0,0]
    v_pk_fma_f32 v[34:35], v[106:107], v[60:61], v[34:35] op_sel_hi:[1,0,1] neg_lo:[1,0,0] neg_hi:[1,0,0]
    v_pk_mul_f32 v[116:117], v[28:29], v[28:29]
    v_pk_mul_f32 v[118:119], v[30:31], v[30:31]
    v_pk_mul_f32 v[120:121], v[32:33], v[32:33]
    v_pk_mul_f32 v[122:123], v[34:35], v[34:35]
    v_pk_fma_f32 v[116:117], v[116:117], v[64:65], v[64:65] op_sel:[0,1,0] op_sel_hi:[1,1,0]
    v_pk_fma_f32 v[118:119], v[118:119], v[64:65], v[64:65] op_sel:[0,1,0] op_sel_hi:[1,1,0]
    v_pk_fma_f32 v[120:121], v[120:121], v[64:65], v[64:65] op_sel:[0,1,0] op_sel_hi:[1,1,0]
    v_pk_fma_f32 v[122:123], v[122:123], v[64:65], v[64:65] op_sel:[0,1,0] op_sel_hi:[1,1,0]
    v_pk_mul_f32 v[116:117], v[116:117], v[28:29]
    v_pk_mul_f32 v[118:119], v[118:119], v[30:31]
    v_pk_mul_f32 v[120:121], v[120:121], v[32:33]
    v_pk_mul_f32 v[122:123], v[122:123], v[34:35]
    v_exp_f32 v116, v116
    v_exp_f32 v118, v118
    v_exp_f32 v120, v120
    v_exp_f32 v122, v122
    v_exp_f32 v117, v117
    v_exp_f32 v119, v119
    v_exp_f32 v121, v121
    v_exp_f32 v123, v123
    v_pk_fma_f32 v[116:117], v[116:117], v[62:63], v[62:63] op_sel_hi:[1,0,0]
    v_pk_fma_f32 v[118:119], v[118:119], v[62:63], v[62:63] op_sel_hi:[1,0,0]
    v_pk_fma_f32 v[120:121], v[120:121], v[62:63], v[62:63] op_sel_hi:[1,0,0]
    v_pk_fma_f32 v[122:123], v[122:123], v[62:63], v[62:63] op_sel_hi:[1,0,0]
    v_rcp_f32 v116, v116
    v_rcp_f32 v118, v118
    v_rcp_f32 v120, v120
    v_rcp_f32 v122, v122
    v_rcp_f32 v117, v117
    v_rcp_f32 v119, v119
    v_rcp_f32 v121, v121
    v_rcp_f32 v123, v123
    v_pk_mul_f32 v[28:29], v[28:29], v[116:117]
    v_pk_mul_f32 v[30:31], v[30:31], v[118:119]
    v_pk_mul_f32 v[32:33], v[32:33], v[120:121]
    v_pk_mul_f32 v[34:35], v[34:35], v[122:123]
    v_cvt_pk_bf16_f32 v76, v28, v29
    v_cvt_pk_bf16_f32 v77, v30, v31
    v_cvt_pk_bf16_f32 v78, v32, v33
    v_cvt_pk_bf16_f32 v79, v34, v35
    ds_write_b64 v3, v[76:77] offset:0
    ds_write_b64 v3, v[78:79] offset:16
    s_cmp_le_u32 s58, 1
    s_cbranch_scc1 L_mega_kernel_z1d_111
    v_pk_fma_f32 v[36:37], v[108:109], v[60:61], v[36:37] op_sel_hi:[1,0,1] neg_lo:[1,0,0] neg_hi:[1,0,0]
    v_pk_fma_f32 v[38:39], v[110:111], v[60:61], v[38:39] op_sel_hi:[1,0,1] neg_lo:[1,0,0] neg_hi:[1,0,0]
    v_pk_fma_f32 v[40:41], v[112:113], v[60:61], v[40:41] op_sel_hi:[1,0,1] neg_lo:[1,0,0] neg_hi:[1,0,0]
    v_pk_fma_f32 v[42:43], v[114:115], v[60:61], v[42:43] op_sel_hi:[1,0,1] neg_lo:[1,0,0] neg_hi:[1,0,0]
    v_pk_mul_f32 v[116:117], v[36:37], v[36:37]
    v_pk_mul_f32 v[118:119], v[38:39], v[38:39]
    v_pk_mul_f32 v[120:121], v[40:41], v[40:41]
    v_pk_mul_f32 v[122:123], v[42:43], v[42:43]
    v_pk_fma_f32 v[116:117], v[116:117], v[64:65], v[64:65] op_sel:[0,1,0] op_sel_hi:[1,1,0]
    v_pk_fma_f32 v[118:119], v[118:119], v[64:65], v[64:65] op_sel:[0,1,0] op_sel_hi:[1,1,0]
    v_pk_fma_f32 v[120:121], v[120:121], v[64:65], v[64:65] op_sel:[0,1,0] op_sel_hi:[1,1,0]
    v_pk_fma_f32 v[122:123], v[122:123], v[64:65], v[64:65] op_sel:[0,1,0] op_sel_hi:[1,1,0]
    v_pk_mul_f32 v[116:117], v[116:117], v[36:37]
    v_pk_mul_f32 v[118:119], v[118:119], v[38:39]
    v_pk_mul_f32 v[120:121], v[120:121], v[40:41]
    v_pk_mul_f32 v[122:123], v[122:123], v[42:43]
    v_exp_f32 v116, v116
    v_exp_f32 v118, v118
    v_exp_f32 v120, v120
    v_exp_f32 v122, v122
    v_exp_f32 v117, v117
    v_exp_f32 v119, v119
    v_exp_f32 v121, v121
    v_exp_f32 v123, v123
    v_pk_fma_f32 v[116:117], v[116:117], v[62:63], v[62:63] op_sel_hi:[1,0,0]
    v_pk_fma_f32 v[118:119], v[118:119], v[62:63], v[62:63] op_sel_hi:[1,0,0]
    v_pk_fma_f32 v[120:121], v[120:121], v[62:63], v[62:63] op_sel_hi:[1,0,0]
    v_pk_fma_f32 v[122:123], v[122:123], v[62:63], v[62:63] op_sel_hi:[1,0,0]
    v_rcp_f32 v116, v116
    v_rcp_f32 v118, v118
    v_rcp_f32 v120, v120
    v_rcp_f32 v122, v122
    v_rcp_f32 v117, v117
    v_rcp_f32 v119, v119
    v_rcp_f32 v121, v121
    v_rcp_f32 v123, v123
    v_pk_mul_f32 v[36:37], v[36:37], v[116:117]
    v_pk_mul_f32 v[38:39], v[38:39], v[118:119]
    v_pk_mul_f32 v[40:41], v[40:41], v[120:121]
    v_pk_mul_f32 v[42:43], v[42:43], v[122:123]
    v_cvt_pk_bf16_f32 v80, v36, v37
    v_cvt_pk_bf16_f32 v81, v38, v39
    v_cvt_pk_bf16_f32 v82, v40, v41
    v_cvt_pk_bf16_f32 v83, v42, v43
    ds_write_b64 v3, v[80:81] offset:32
    ds_write_b64 v3, v[82:83] offset:48
L_mega_kernel_z1d_111:
    v_lshrrev_b32 v8, 4, v1
    v_and_b32 v9, 15, v1
    v_mul_u32_u24 v2, 1792, v8
    v_lshl_add_u32 v2, v9, 4, v2
    v_add_u32 v2, 16384, v2
    s_mul_i32 s17, s42, 8192
    v_add_u32 v10, s17, v2
    s_mul_i32 s17, s42, 6400
    v_add_u32 v11, s17, v2
    v_mov_b32 v12, v10
    v_mov_b32 v13, v11
    v_mov_b32 v28, 0
    v_mov_b32 v29, 0
    v_mov_b32 v30, 0
    v_mov_b32 v31, 0
    v_mov_b32 v32, 0
    v_mov_b32 v33, 0
    v_mov_b32 v34, 0
    v_mov_b32 v35, 0
    v_mov_b32 v36, 0
    v_mov_b32 v37, 0
    v_mov_b32 v38, 0
    v_mov_b32 v39, 0
    v_mov_b32 v40, 0
    v_mov_b32 v41, 0
    v_mov_b32 v42, 0
    v_mov_b32 v43, 0
    v_mov_b32 v44, 0
    v_mov_b32 v45, 0
    v_mov_b32 v46, 0
    v_mov_b32 v47, 0
    v_mov_b32 v48, 0
    v_mov_b32 v49, 0
    v_mov_b32 v50, 0
    v_mov_b32 v51, 0
    v_mov_b32 v52, 0
    v_mov_b32 v53, 0
    v_mov_b32 v54, 0
    v_mov_b32 v55, 0
    s_cmp_eq_u32 s15, 7
    s_cselect_b32 s68, 1, 3
    s_cmp_eq_u32 s42, 0
    s_cselect_b32 s68, 4, s68
    s_mul_i32 s17, s14, 54
    s_mul_i32 s18, s15, 7
    s_add_u32 s17, s17, s18
    s_lshl_b32 s18, s42, 2
    s_add_u32 s17, s17, s18
    s_lshl_b32 s17, s17, 11
    s_lshl_b32 s18, s22, 8
    s_add_u32 s17, s17, s18
    v_and_b32 v14, 1, v8
    v_lshlrev_b32 v14, 10, v14
    v_lshl_add_u32 v14, v9, 4, v14
    v_lshrrev_b32 v2, 1, v8
    v_lshl_add_u32 v14, v2, 3, v14
    v_add_u32 v14, s17, v14
    s_mul_i32 s17, s22, 3840
    s_lshl_b32 s18, s42, 7
    s_add_u32 s17, s17, s18
    s_add_u32 s17, s17, 0
    v_mul_u32_u24 v15, 240, v9
    v_lshl_add_u32 v15, v8, 3, v15
    v_add_u32 v15, s17, v15
    s_lshl_b32 s17, s16, 12
    s_add_u32 s17, s17, 88064
    v_add_u32 v16, s17, v4
    s_xor_b32 s17, s16, 4
    s_lshl_b32 s17, s17, 2
    s_add_u32 s17, s17, s42
    s_lshl_b32 s17, s17, 10
    s_add_u32 s17, s17, 88064
    v_add_u32 v17, s17, v4
    s_lshl_b32 s17, s14, 6
    s_lshl_b32 s18, s22, 4
    s_add_u32 s17, s17, s18
    v_add_lshl_u32 v2, v9, s17, 1
    s_mov_b32 s64, s10
    s_mov_b32 s65, s11
    s_mov_b32 s66, 0x1000
    s_mov_b32 s67, 0x00020000
    s_add_u32 s60, s6, 0x1800000
    s_addc_u32 s61, s7, 0
    s_mov_b32 s62, 0x360000
    s_mov_b32 s63, 0x00020000
    s_add_u32 s72, s6, 0x780000
    s_addc_u32 s73, s7, 0
    s_mov_b32 s74, 0x10e000
    s_mov_b32 s75, 0x00020000
    buffer_load_ushort v18, v2, s[64:67], 0 offen
    s_mul_i32 s76, s15, 138240
    s_mul_i32 s17, s16, 1280
    s_add_u32 s76, s76, s17
    s_waitcnt vmcnt(0) lgkmcnt(0)
    s_barrier
    s_add_u32 m0, s41, 45056
    s_nop 0
    buffer_load_dwordx4 v4, s[36:39], s40 offen sc1 lds
    s_mov_b32 exec_hi, 0xffff
    buffer_load_dwordx4 v4, s[36:39], s40 offen offset:1024 sc1 lds
    s_mov_b32 exec_hi, -1
    s_add_u32 s40, s40, 14336
    s_add_u32 m0, s41, 59392
    s_nop 0
    buffer_load_dwordx4 v4, s[36:39], s40 offen sc1 lds
    s_mov_b32 exec_hi, 0xffff
    buffer_load_dwordx4 v4, s[36:39], s40 offen offset:1024 sc1 lds
    s_mov_b32 exec_hi, -1
    s_add_u32 s40, s40, 14336
    s_add_u32 m0, s41, 73728
    s_nop 0
    buffer_load_dwordx4 v4, s[36:39], s40 offen sc1 lds
    s_mov_b32 exec_hi, 0xffff
    buffer_load_dwordx4 v4, s[36:39], s40 offen offset:1024 sc1 lds
    s_mov_b32 exec_hi, -1
    s_add_u32 s40, s40, 14336
    s_waitcnt lgkmcnt(0)
    s_barrier
    ds_read_b128 v[56:59], v12 offset:0
    ds_read_b128 v[60:63], v12 offset:256
    ds_read_b128 v[64:67], v12 offset:512
    ds_read_b128 v[68:71], v13 offset:768
    ds_read_b128 v[72:75], v13 offset:1024
    ds_read_b128 v[76:79], v13 offset:1280
    ds_read_b128 v[80:83], v13 offset:1536
    s_add_u32 m0, s41, 88064
    s_nop 0
    buffer_load_dwordx4 v4, s[36:39], s40 offen sc1 lds
    s_mov_b32 exec_hi, 0xffff
    buffer_load_dwordx4 v4, s[36:39], s40 offen offset:1024 sc1 lds
    s_mov_b32 exec_hi, -1
    s_add_u32 s40, s40, 14336
    s_barrier
    s_waitcnt lgkmcnt(6)
    v_mfma_f32_16x16x32_bf16 v[28:31], v[56:59], v[124:127], v[28:31]
    ds_read_b128 v[84:87], v12 offset:14336
    s_waitcnt lgkmcnt(6)
    v_mfma_f32_16x16x32_bf16 v[32:35], v[60:63], v[124:127], v[32:35]
    ds_read_b128 v[88:91], v12 offset:14592
    s_waitcnt lgkmcnt(6)
    v_mfma_f32_16x16x32_bf16 v[36:39], v[64:67], v[124:127], v[36:39]
    ds_read_b128 v[92:95], v12 offset:14848
    s_waitcnt lgkmcnt(6)
    v_mfma_f32_16x16x32_bf16 v[40:43], v[68:71], v[124:127], v[40:43]
    ds_read_b128 v[96:99], v13 offset:15104
    s_waitcnt lgkmcnt(6)
    v_mfma_f32_16x16x32_bf16 v[44:47], v[72:75], v[124:127], v[44:47]
    ds_read_b128 v[100:103], v13 offset:15360
    s_waitcnt lgkmcnt(6)
    v_mfma_f32_16x16x32_bf16 v[48:51], v[76:79], v[124:127], v[48:51]
    ds_read_b128 v[104:107], v13 offset:15616
    s_waitcnt lgkmcnt(6)
    v_mfma_f32_16x16x32_bf16 v[52:55], v[80:83], v[124:127], v[52:55]
    ds_read_b128 v[108:111], v13 offset:15872
    s_add_u32 m0, s41, 102400
    s_nop 0
    buffer_load_dwordx4 v4, s[36:39], s40 offen sc1 lds
    s_mov_b32 exec_hi, 0xffff
    buffer_load_dwordx4 v4, s[36:39], s40 offen offset:1024 sc1 lds
    s_mov_b32 exec_hi, -1
    s_add_u32 s40, s40, 14336
    s_waitcnt vmcnt(8)
    s_barrier
    s_waitcnt lgkmcnt(6)
    v_mfma_f32_16x16x32_bf16 v[28:31], v[84:87], v[128:131], v[28:31]
    ds_read_b128 v[56:59], v12 offset:28672
    s_waitcnt lgkmcnt(6)
    v_mfma_f32_16x16x32_bf16 v[32:35], v[88:91], v[128:131], v[32:35]
    ds_read_b128 v[60:63], v12 offset:28928
    s_waitcnt lgkmcnt(6)
    v_mfma_f32_16x16x32_bf16 v[36:39], v[92:95], v[128:131], v[36:39]
    ds_read_b128 v[64:67], v12 offset:29184
    s_waitcnt lgkmcnt(6)
    v_mfma_f32_16x16x32_bf16 v[40:43], v[96:99], v[128:131], v[40:43]
    ds_read_b128 v[68:71], v13 offset:29440
    s_waitcnt lgkmcnt(6)
    v_mfma_f32_16x16x32_bf16 v[44:47], v[100:103], v[128:131], v[44:47]
    ds_read_b128 v[72:75], v13 offset:29696
    s_waitcnt lgkmcnt(6)
    v_mfma_f32_16x16x32_bf16 v[48:51], v[104:107], v[128:131], v[48:51]
    ds_read_b128 v[76:79], v13 offset:29952
    s_waitcnt lgkmcnt(6)
    v_mfma_f32_16x16x32_bf16 v[52:55], v[108:111], v[128:131], v[52:55]
    ds_read_b128 v[80:83], v13 offset:30208
    s_add_u32 m0, s41, 16384
    s_nop 0
    buffer_load_dwordx4 v4, s[36:39], s40 offen sc1 lds
    s_mov_b32 exec_hi, 0xffff
    buffer_load_dwordx4 v4, s[36:39], s40 offen offset:1024 sc1 lds
    s_mov_b32 exec_hi, -1
    s_add_u32 s40, s40, 14336
    s_waitcnt vmcnt(8)
    s_barrier
    s_waitcnt lgkmcnt(6)
    v_mfma_f32_16x16x32_bf16 v[28:31], v[56:59], v[132:135], v[28:31]
    ds_read_b128 v[84:87], v12 offset:43008
    s_waitcnt lgkmcnt(6)
    v_mfma_f32_16x16x32_bf16 v[32:35], v[60:63], v[132:135], v[32:35]
    ds_read_b128 v[88:91], v12 offset:43264
    s_waitcnt lgkmcnt(6)
    v_mfma_f32_16x16x32_bf16 v[36:39], v[64:67], v[132:135], v[36:39]
    ds_read_b128 v[92:95], v12 offset:43520
    s_waitcnt lgkmcnt(6)
    v_mfma_f32_16x16x32_bf16 v[40:43], v[68:71], v[132:135], v[40:43]
    ds_read_b128 v[96:99], v13 offset:43776
    s_waitcnt lgkmcnt(6)
    v_mfma_f32_16x16x32_bf16 v[44:47], v[72:75], v[132:135], v[44:47]
    ds_read_b128 v[100:103], v13 offset:44032
    s_waitcnt lgkmcnt(6)
    v_mfma_f32_16x16x32_bf16 v[48:51], v[76:79], v[132:135], v[48:51]
    ds_read_b128 v[104:107], v13 offset:44288
    s_waitcnt lgkmcnt(6)
    v_mfma_f32_16x16x32_bf16 v[52:55], v[80:83], v[132:135], v[52:55]
    ds_read_b128 v[108:111], v13 offset:44544
    v_add_u32 v12, 57344, v10
    v_add_u32 v13, 57344, v11
    s_add_u32 m0, s41, 30720
    s_nop 0
    buffer_load_dwordx4 v4, s[36:39], s40 offen sc1 lds
    s_mov_b32 exec_hi, 0xffff
    buffer_load_dwordx4 v4, s[36:39], s40 offen offset:1024 sc1 lds
    s_mov_b32 exec_hi, -1
    s_add_u32 s40, s40, 14336
    s_waitcnt vmcnt(8)
    s_barrier
    s_waitcnt lgkmcnt(6)
    v_mfma_f32_16x16x32_bf16 v[28:31], v[84:87], v[136:139], v[28:31]
    ds_read_b128 v[56:59], v12 offset:0
    s_waitcnt lgkmcnt(6)
    v_mfma_f32_16x16x32_bf16 v[32:35], v[88:91], v[136:139], v[32:35]
    ds_read_b128 v[60:63], v12 offset:256
    s_waitcnt lgkmcnt(6)
    v_mfma_f32_16x16x32_bf16 v[36:39], v[92:95], v[136:139], v[36:39]
    ds_read_b128 v[64:67], v12 offset:512
    s_waitcnt lgkmcnt(6)
    v_mfma_f32_16x16x32_bf16 v[40:43], v[96:99], v[136:139], v[40:43]
    ds_read_b128 v[68:71], v13 offset:768
    s_waitcnt lgkmcnt(6)
    v_mfma_f32_16x16x32_bf16 v[44:47], v[100:103], v[136:139], v[44:47]
    ds_read_b128 v[72:75], v13 offset:1024
    s_waitcnt lgkmcnt(6)
    v_mfma_f32_16x16x32_bf16 v[48:51], v[104:107], v[136:139], v[48:51]
    ds_read_b128 v[76:79], v13 offset:1280
    s_waitcnt lgkmcnt(6)
    v_mfma_f32_16x16x32_bf16 v[52:55], v[108:111], v[136:139], v[52:55]
    ds_read_b128 v[80:83], v13 offset:1536
    s_add_u32 m0, s41, 45056
    s_nop 0
    buffer_load_dwordx4 v4, s[36:39], s40 offen sc1 lds
    s_mov_b32 exec_hi, 0xffff
    buffer_load_dwordx4 v4, s[36:39], s40 offen offset:1024 sc1 lds
    s_mov_b32 exec_hi, -1
    s_add_u32 s40, s40, 14336
    s_waitcnt vmcnt(8)
    s_barrier
    s_waitcnt lgkmcnt(6)
    v_mfma_f32_16x16x32_bf16 v[28:31], v[56:59], v[140:143], v[28:31]
    ds_read_b128 v[84:87], v12 offset:14336
    s_waitcnt lgkmcnt(6)
    v_mfma_f32_16x16x32_bf16 v[32:35], v[60:63], v[140:143], v[32:35]
    ds_read_b128 v[88:91], v12 offset:14592
    s_waitcnt lgkmcnt(6)
    v_mfma_f32_16x16x32_bf16 v[36:39], v[64:67], v[140:143], v[36:39]
    ds_read_b128 v[92:95], v12 offset:14848
    s_waitcnt lgkmcnt(6)
    v_mfma_f32_16x16x32_bf16 v[40:43], v[68:71], v[140:143], v[40:43]
    ds_read_b128 v[96:99], v13 offset:15104
    s_waitcnt lgkmcnt(6)
    v_mfma_f32_16x16x32_bf16 v[44:47], v[72:75], v[140:143], v[44:47]
    ds_read_b128 v[100:103], v13 offset:15360
    s_waitcnt lgkmcnt(6)
    v_mfma_f32_16x16x32_bf16 v[48:51], v[76:79], v[140:143], v[48:51]
    ds_read_b128 v[104:107], v13 offset:15616
    s_waitcnt lgkmcnt(6)
    v_mfma_f32_16x16x32_bf16 v[52:55], v[80:83], v[140:143], v[52:55]
    ds_read_b128 v[108:111], v13 offset:15872
    s_add_u32 m0, s41, 59392
    s_nop 0
    buffer_load_dwordx4 v4, s[36:39], s40 offen sc1 lds
    s_mov_b32 exec_hi, 0xffff
    buffer_load_dwordx4 v4, s[36:39], s40 offen offset:1024 sc1 lds
    s_mov_b32 exec_hi, -1
    s_add_u32 s40, s40, 14336
    s_waitcnt vmcnt(8)
    s_barrier
    s_waitcnt lgkmcnt(6)
    v_mfma_f32_16x16x32_bf16 v[28:31], v[84:87], v[144:147], v[28:31]
    ds_read_b128 v[56:59], v12 offset:28672
    s_waitcnt lgkmcnt(6)
    v_mfma_f32_16x16x32_bf16 v[32:35], v[88:91], v[144:147], v[32:35]
    ds_read_b128 v[60:63], v12 offset:28928
    s_waitcnt lgkmcnt(6)
    v_mfma_f32_16x16x32_bf16 v[36:39], v[92:95], v[144:147], v[36:39]
    ds_read_b128 v[64:67], v12 offset:29184
    s_waitcnt lgkmcnt(6)
    v_mfma_f32_16x16x32_bf16 v[40:43], v[96:99], v[144:147], v[40:43]
    ds_read_b128 v[68:71], v13 offset:29440
    s_waitcnt lgkmcnt(6)
    v_mfma_f32_16x16x32_bf16 v[44:47], v[100:103], v[144:147], v[44:47]
    ds_read_b128 v[72:75], v13 offset:29696
    s_waitcnt lgkmcnt(6)
    v_mfma_f32_16x16x32_bf16 v[48:51], v[104:107], v[144:147], v[48:51]
    ds_read_b128 v[76:79], v13 offset:29952
    s_waitcnt lgkmcnt(6)
    v_mfma_f32_16x16x32_bf16 v[52:55], v[108:111], v[144:147], v[52:55]
    ds_read_b128 v[80:83], v13 offset:30208
    v_mov_b32 v12, v10
    v_mov_b32 v13, v11
    s_add_u32 m0, s41, 73728
    s_nop 0
    buffer_load_dwordx4 v4, s[36:39], s40 offen sc1 lds
    s_mov_b32 exec_hi, 0xffff
    buffer_load_dwordx4 v4, s[36:39], s40 offen offset:1024 sc1 lds
    s_mov_b32 exec_hi, -1
    s_add_u32 s40, s40, 14336
    s_waitcnt vmcnt(8)
    s_barrier
    s_waitcnt lgkmcnt(6)
    v_mfma_f32_16x16x32_bf16 v[28:31], v[56:59], v[148:151], v[28:31]
    ds_read_b128 v[84:87], v12 offset:0
    s_waitcnt lgkmcnt(6)
    v_mfma_f32_16x16x32_bf16 v[32:35], v[60:63], v[148:151], v[32:35]
    ds_read_b128 v[88:91], v12 offset:256
    s_waitcnt lgkmcnt(6)
    v_mfma_f32_16x16x32_bf16 v[36:39], v[64:67], v[148:151], v[36:39]
    ds_read_b128 v[92:95], v12 offset:512
    s_waitcnt lgkmcnt(6)
    v_mfma_f32_16x16x32_bf16 v[40:43], v[68:71], v[148:151], v[40:43]
    ds_read_b128 v[96:99], v13 offset:768
    s_waitcnt lgkmcnt(6)
    v_mfma_f32_16x16x32_bf16 v[44:47], v[72:75], v[148:151], v[44:47]
    ds_read_b128 v[100:103], v13 offset:1024
    s_waitcnt lgkmcnt(6)
    v_mfma_f32_16x16x32_bf16 v[48:51], v[76:79], v[148:151], v[48:51]
    ds_read_b128 v[104:107], v13 offset:1280
    s_waitcnt lgkmcnt(6)
    v_mfma_f32_16x16x32_bf16 v[52:55], v[80:83], v[148:151], v[52:55]
    ds_read_b128 v[108:111], v13 offset:1536
    s_add_u32 m0, s41, 88064
    s_nop 0
    buffer_load_dwordx4 v4, s[36:39], s40 offen sc1 lds
    s_mov_b32 exec_hi, 0xffff
    buffer_load_dwordx4 v4, s[36:39], s40 offen offset:1024 sc1 lds
    s_mov_b32 exec_hi, -1
    s_add_u32 s40, s40, 14336
    s_waitcnt vmcnt(8)
    s_barrier
    s_waitcnt lgkmcnt(6)
    v_mfma_f32_16x16x32_bf16 v[28:31], v[84:87], v[152:155], v[28:31]
    ds_read_b128 v[56:59], v12 offset:14336
    s_waitcnt lgkmcnt(6)
    v_mfma_f32_16x16x32_bf16 v[32:35], v[88:91], v[152:155], v[32:35]
    ds_read_b128 v[60:63], v12 offset:14592
    s_waitcnt lgkmcnt(6)
    v_mfma_f32_16x16x32_bf16 v[36:39], v[92:95], v[152:155], v[36:39]
    ds_read_b128 v[64:67], v12 offset:14848
    s_waitcnt lgkmcnt(6)
    v_mfma_f32_16x16x32_bf16 v[40:43], v[96:99], v[152:155], v[40:43]
    ds_read_b128 v[68:71], v13 offset:15104
    s_waitcnt lgkmcnt(6)
    v_mfma_f32_16x16x32_bf16 v[44:47], v[100:103], v[152:155], v[44:47]
    ds_read_b128 v[72:75], v13 offset:15360
    s_waitcnt lgkmcnt(6)
    v_mfma_f32_16x16x32_bf16 v[48:51], v[104:107], v[152:155], v[48:51]
    ds_read_b128 v[76:79], v13 offset:15616
    s_waitcnt lgkmcnt(6)
    v_mfma_f32_16x16x32_bf16 v[52:55], v[108:111], v[152:155], v[52:55]
    ds_read_b128 v[80:83], v13 offset:15872
    s_add_u32 m0, s41, 102400
    s_nop 0
    buffer_load_dwordx4 v4, s[36:39], s40 offen sc1 lds
    s_mov_b32 exec_hi, 0xffff
    buffer_load_dwordx4 v4, s[36:39], s40 offen offset:1024 sc1 lds
    s_mov_b32 exec_hi, -1
    s_add_u32 s40, s40, 14336
    s_waitcnt vmcnt(8)
    s_barrier
    s_waitcnt lgkmcnt(6)
    v_mfma_f32_16x16x32_bf16 v[28:31], v[56:59], v[156:159], v[28:31]
    ds_read_b128 v[84:87], v12 offset:28672
    s_waitcnt lgkmcnt(6)
    v_mfma_f32_16x16x32_bf16 v[32:35], v[60:63], v[156:159], v[32:35]
    ds_read_b128 v[88:91], v12 offset:28928
    s_waitcnt lgkmcnt(6)
    v_mfma_f32_16x16x32_bf16 v[36:39], v[64:67], v[156:159], v[36:39]
    ds_read_b128 v[92:95], v12 offset:29184
    s_waitcnt lgkmcnt(6)
    v_mfma_f32_16x16x32_bf16 v[40:43], v[68:71], v[156:159], v[40:43]
    ds_read_b128 v[96:99], v13 offset:29440
    s_waitcnt lgkmcnt(6)
    v_mfma_f32_16x16x32_bf16 v[44:47], v[72:75], v[156:159], v[44:47]
    ds_read_b128 v[100:103], v13 offset:29696
    s_waitcnt lgkmcnt(6)
    v_mfma_f32_16x16x32_bf16 v[48:51], v[76:79], v[156:159], v[48:51]
    ds_read_b128 v[104:107], v13 offset:29952
    s_waitcnt lgkmcnt(6)
    v_mfma_f32_16x16x32_bf16 v[52:55], v[80:83], v[156:159], v[52:55]
    ds_read_b128 v[108:111], v13 offset:30208
    s_add_u32 m0, s41, 16384
    s_nop 0
    buffer_load_dwordx4 v4, s[36:39], s40 offen sc1 lds
    s_mov_b32 exec_hi, 0xffff
    buffer_load_dwordx4 v4, s[36:39], s40 offen offset:1024 sc1 lds
    s_mov_b32 exec_hi, -1
    s_add_u32 s40, s40, 14336
    s_waitcnt vmcnt(8)
    s_barrier
    s_waitcnt lgkmcnt(6)
    v_mfma_f32_16x16x32_bf16 v[28:31], v[84:87], v[160:163], v[28:31]
    ds_read_b128 v[56:59], v12 offset:43008
    s_waitcnt lgkmcnt(6)
    v_mfma_f32_16x16x32_bf16 v[32:35], v[88:91], v[160:163], v[32:35]
    ds_read_b128 v[60:63], v12 offset:43264
    s_waitcnt lgkmcnt(6)
    v_mfma_f32_16x16x32_bf16 v[36:39], v[92:95], v[160:163], v[36:39]
    ds_read_b128 v[64:67], v12 offset:43520
    s_waitcnt lgkmcnt(6)
    v_mfma_f32_16x16x32_bf16 v[40:43], v[96:99], v[160:163], v[40:43]
    ds_read_b128 v[68:71], v13 offset:43776
    s_waitcnt lgkmcnt(6)
    v_mfma_f32_16x16x32_bf16 v[44:47], v[100:103], v[160:163], v[44:47]
    ds_read_b128 v[72:75], v13 offset:44032
    s_waitcnt lgkmcnt(6)
    v_mfma_f32_16x16x32_bf16 v[48:51], v[104:107], v[160:163], v[48:51]
    ds_read_b128 v[76:79], v13 offset:44288
    s_waitcnt lgkmcnt(6)
    v_mfma_f32_16x16x32_bf16 v[52:55], v[108:111], v[160:163], v[52:55]
    ds_read_b128 v[80:83], v13 offset:44544
    v_add_u32 v12, 57344, v10
    v_add_u32 v13, 57344, v11
    s_add_u32 m0, s41, 30720
    s_nop 0
    buffer_load_dwordx4 v4, s[36:39], s40 offen sc1 lds
    s_mov_b32 exec_hi, 0xffff
    buffer_load_dwordx4 v4, s[36:39], s40 offen offset:1024 sc1 lds
    s_mov_b32 exec_hi, -1
    s_add_u32 s40, s40, 14336
    s_waitcnt vmcnt(8)
    s_barrier
    s_waitcnt lgkmcnt(6)
    v_mfma_f32_16x16x32_bf16 v[28:31], v[56:59], v[164:167], v[28:31]
    ds_read_b128 v[84:87], v12 offset:0
    s_waitcnt lgkmcnt(6)
    v_mfma_f32_16x16x32_bf16 v[32:35], v[60:63], v[164:167], v[32:35]
    ds_read_b128 v[88:91], v12 offset:256
    s_waitcnt lgkmcnt(6)
    v_mfma_f32_16x16x32_bf16 v[36:39], v[64:67], v[164:167], v[36:39]
    ds_read_b128 v[92:95], v12 offset:512
    s_waitcnt lgkmcnt(6)
    v_mfma_f32_16x16x32_bf16 v[40:43], v[68:71], v[164:167], v[40:43]
    ds_read_b128 v[96:99], v13 offset:768
    s_waitcnt lgkmcnt(6)
    v_mfma_f32_16x16x32_bf16 v[44:47], v[72:75], v[164:167], v[44:47]
    ds_read_b128 v[100:103], v13 offset:1024
    s_waitcnt lgkmcnt(6)
    v_mfma_f32_16x16x32_bf16 v[48:51], v[76:79], v[164:167], v[48:51]
    ds_read_b128 v[104:107], v13 offset:1280
    s_waitcnt lgkmcnt(6)
    v_mfma_f32_16x16x32_bf16 v[52:55], v[80:83], v[164:167], v[52:55]
    ds_read_b128 v[108:111], v13 offset:1536
    s_add_u32 m0, s41, 45056
    s_nop 0
    buffer_load_dwordx4 v4, s[36:39], s40 offen sc1 lds
    s_mov_b32 exec_hi, 0xffff
    buffer_load_dwordx4 v4, s[36:39], s40 offen offset:1024 sc1 lds
    s_mov_b32 exec_hi, -1
    s_add_u32 s40, s40, 14336
    s_waitcnt vmcnt(8)
    s_barrier
    s_waitcnt lgkmcnt(6)
    v_mfma_f32_16x16x32_bf16 v[28:31], v[84:87], v[168:171], v[28:31]
    ds_read_b128 v[56:59], v12 offset:14336
    s_waitcnt lgkmcnt(6)
    v_mfma_f32_16x16x32_bf16 v[32:35], v[88:91], v[168:171], v[32:35]
    ds_read_b128 v[60:63], v12 offset:14592
    s_waitcnt lgkmcnt(6)
    v_mfma_f32_16x16x32_bf16 v[36:39], v[92:95], v[168:171], v[36:39]
    ds_read_b128 v[64:67], v12 offset:14848
    s_waitcnt lgkmcnt(6)
    v_mfma_f32_16x16x32_bf16 v[40:43], v[96:99], v[168:171], v[40:43]
    ds_read_b128 v[68:71], v13 offset:15104
    s_waitcnt lgkmcnt(6)
    v_mfma_f32_16x16x32_bf16 v[44:47], v[100:103], v[168:171], v[44:47]
    ds_read_b128 v[72:75], v13 offset:15360
    s_waitcnt lgkmcnt(6)
    v_mfma_f32_16x16x32_bf16 v[48:51], v[104:107], v[168:171], v[48:51]
    ds_read_b128 v[76:79], v13 offset:15616
    s_waitcnt lgkmcnt(6)
    v_mfma_f32_16x16x32_bf16 v[52:55], v[108:111], v[168:171], v[52:55]
    ds_read_b128 v[80:83], v13 offset:15872
    s_add_u32 m0, s41, 59392
    s_nop 0
    buffer_load_dwordx4 v4, s[36:39], s40 offen sc1 lds
    s_mov_b32 exec_hi, 0xffff
    buffer_load_dwordx4 v4, s[36:39], s40 offen offset:1024 sc1 lds
    s_mov_b32 exec_hi, -1
    s_add_u32 s40, s40, 14336
    s_waitcnt vmcnt(8)
    s_barrier
    s_waitcnt lgkmcnt(6)
    v_mfma_f32_16x16x32_bf16 v[28:31], v[56:59], v[172:175], v[28:31]
    ds_read_b128 v[84:87], v12 offset:28672
    s_waitcnt lgkmcnt(6)
    v_mfma_f32_16x16x32_bf16 v[32:35], v[60:63], v[172:175], v[32:35]
    ds_read_b128 v[88:91], v12 offset:28928
    s_waitcnt lgkmcnt(6)
    v_mfma_f32_16x16x32_bf16 v[36:39], v[64:67], v[172:175], v[36:39]
    ds_read_b128 v[92:95], v12 offset:29184
    s_waitcnt lgkmcnt(6)
    v_mfma_f32_16x16x32_bf16 v[40:43], v[68:71], v[172:175], v[40:43]
    ds_read_b128 v[96:99], v13 offset:29440
    s_waitcnt lgkmcnt(6)
    v_mfma_f32_16x16x32_bf16 v[44:47], v[72:75], v[172:175], v[44:47]
    ds_read_b128 v[100:103], v13 offset:29696
    s_waitcnt lgkmcnt(6)
    v_mfma_f32_16x16x32_bf16 v[48:51], v[76:79], v[172:175], v[48:51]
    ds_read_b128 v[104:107], v13 offset:29952
    s_waitcnt lgkmcnt(6)
    v_mfma_f32_16x16x32_bf16 v[52:55], v[80:83], v[172:175], v[52:55]
    ds_read_b128 v[108:111], v13 offset:30208
    v_mov_b32 v12, v10
    v_mov_b32 v13, v11
    s_add_u32 m0, s41, 73728
    s_nop 0
    buffer_load_dwordx4 v4, s[36:39], s40 offen sc1 lds
    s_mov_b32 exec_hi, 0xffff
    buffer_load_dwordx4 v4, s[36:39], s40 offen offset:1024 sc1 lds
    s_mov_b32 exec_hi, -1
    s_add_u32 s40, s40, 14336
    s_waitcnt vmcnt(8)
    s_barrier
    s_waitcnt lgkmcnt(6)
    v_mfma_f32_16x16x32_bf16 v[28:31], v[84:87], v[176:179], v[28:31]
    ds_read_b128 v[56:59], v12 offset:0
    s_waitcnt lgkmcnt(6)
    v_mfma_f32_16x16x32_bf16 v[32:35], v[88:91], v[176:179], v[32:35]
    ds_read_b128 v[60:63], v12 offset:256
    s_waitcnt lgkmcnt(6)
    v_mfma_f32_16x16x32_bf16 v[36:39], v[92:95], v[176:179], v[36:39]
    ds_read_b128 v[64:67], v12 offset:512
    s_waitcnt lgkmcnt(6)
    v_mfma_f32_16x16x32_bf16 v[40:43], v[96:99], v[176:179], v[40:43]
    ds_read_b128 v[68:71], v13 offset:768
    s_waitcnt lgkmcnt(6)
    v_mfma_f32_16x16x32_bf16 v[44:47], v[100:103], v[176:179], v[44:47]
    ds_read_b128 v[72:75], v13 offset:1024
    s_waitcnt lgkmcnt(6)
    v_mfma_f32_16x16x32_bf16 v[48:51], v[104:107], v[176:179], v[48:51]
    ds_read_b128 v[76:79], v13 offset:1280
    s_waitcnt lgkmcnt(6)
    v_mfma_f32_16x16x32_bf16 v[52:55], v[108:111], v[176:179], v[52:55]
    ds_read_b128 v[80:83], v13 offset:1536
    s_add_u32 m0, s41, 88064
    s_nop 0
    buffer_load_dwordx4 v4, s[36:39], s40 offen sc1 lds
    s_mov_b32 exec_hi, 0xffff
    buffer_load_dwordx4 v4, s[36:39], s40 offen offset:1024 sc1 lds
    s_mov_b32 exec_hi, -1
    s_add_u32 s40, s40, 14336
    s_waitcnt vmcnt(8)
    s_barrier
    s_waitcnt lgkmcnt(6)
    v_mfma_f32_16x16x32_bf16 v[28:31], v[56:59], v[180:183], v[28:31]
    ds_read_b128 v[84:87], v12 offset:14336
    s_waitcnt lgkmcnt(6)
    v_mfma_f32_16x16x32_bf16 v[32:35], v[60:63], v[180:183], v[32:35]
    ds_read_b128 v[88:91], v12 offset:14592
    s_waitcnt lgkmcnt(6)
    v_mfma_f32_16x16x32_bf16 v[36:39], v[64:67], v[180:183], v[36:39]
    ds_read_b128 v[92:95], v12 offset:14848
    s_waitcnt lgkmcnt(6)
    v_mfma_f32_16x16x32_bf16 v[40:43], v[68:71], v[180:183], v[40:43]
    ds_read_b128 v[96:99], v13 offset:15104
    s_waitcnt lgkmcnt(6)
    v_mfma_f32_16x16x32_bf16 v[44:47], v[72:75], v[180:183], v[44:47]
    ds_read_b128 v[100:103], v13 offset:15360
    s_waitcnt lgkmcnt(6)
    v_mfma_f32_16x16x32_bf16 v[48:51], v[76:79], v[180:183], v[48:51]
    ds_read_b128 v[104:107], v13 offset:15616
    s_waitcnt lgkmcnt(6)
    v_mfma_f32_16x16x32_bf16 v[52:55], v[80:83], v[180:183], v[52:55]
    ds_read_b128 v[108:111], v13 offset:15872
    s_add_u32 m0, s41, 102400
    s_nop 0
    buffer_load_dwordx4 v4, s[36:39], s40 offen sc1 lds
    s_mov_b32 exec_hi, 0xffff
    buffer_load_dwordx4 v4, s[36:39], s40 offen offset:1024 sc1 lds
    s_mov_b32 exec_hi, -1
    s_add_u32 s40, s40, 14336
    s_waitcnt vmcnt(8)
    s_barrier
    s_waitcnt lgkmcnt(6)
    v_mfma_f32_16x16x32_bf16 v[28:31], v[84:87], v[184:187], v[28:31]
    ds_read_b128 v[56:59], v12 offset:28672
    s_waitcnt lgkmcnt(6)
    v_mfma_f32_16x16x32_bf16 v[32:35], v[88:91], v[184:187], v[32:35]
    ds_read_b128 v[60:63], v12 offset:28928
    s_waitcnt lgkmcnt(6)
    v_mfma_f32_16x16x32_bf16 v[36:39], v[92:95], v[184:187], v[36:39]
    ds_read_b128 v[64:67], v12 offset:29184
    s_waitcnt lgkmcnt(6)
    v_mfma_f32_16x16x32_bf16 v[40:43], v[96:99], v[184:187], v[40:43]
    ds_read_b128 v[68:71], v13 offset:29440
    s_waitcnt lgkmcnt(6)
    v_mfma_f32_16x16x32_bf16 v[44:47], v[100:103], v[184:187], v[44:47]
    ds_read_b128 v[72:75], v13 offset:29696
    s_waitcnt lgkmcnt(6)
    v_mfma_f32_16x16x32_bf16 v[48:51], v[104:107], v[184:187], v[48:51]
    ds_read_b128 v[76:79], v13 offset:29952
    s_waitcnt lgkmcnt(6)
    v_mfma_f32_16x16x32_bf16 v[52:55], v[108:111], v[184:187], v[52:55]
    ds_read_b128 v[80:83], v13 offset:30208
    s_add_u32 m0, s41, 16384
    s_nop 0
    buffer_load_dwordx4 v4, s[36:39], s40 offen sc1 lds
    s_mov_b32 exec_hi, 0xffff
    buffer_load_dwordx4 v4, s[36:39], s40 offen offset:1024 sc1 lds
    s_mov_b32 exec_hi, -1
    s_add_u32 s40, s40, 14336
    s_waitcnt vmcnt(8)
    s_barrier
    s_waitcnt lgkmcnt(6)
    v_mfma_f32_16x16x32_bf16 v[28:31], v[56:59], v[188:191], v[28:31]
    ds_read_b128 v[84:87], v12 offset:43008
    s_waitcnt lgkmcnt(6)
    v_mfma_f32_16x16x32_bf16 v[32:35], v[60:63], v[188:191], v[32:35]
    ds_read_b128 v[88:91], v12 offset:43264
    s_waitcnt lgkmcnt(6)
    v_mfma_f32_16x16x32_bf16 v[36:39], v[64:67], v[188:191], v[36:39]
    ds_read_b128 v[92:95], v12 offset:43520
    s_waitcnt lgkmcnt(6)
    v_mfma_f32_16x16x32_bf16 v[40:43], v[68:71], v[188:191], v[40:43]
    ds_read_b128 v[96:99], v13 offset:43776
    s_waitcnt lgkmcnt(6)
    v_mfma_f32_16x16x32_bf16 v[44:47], v[72:75], v[188:191], v[44:47]
    ds_read_b128 v[100:103], v13 offset:44032
    s_waitcnt lgkmcnt(6)
    v_mfma_f32_16x16x32_bf16 v[48:51], v[76:79], v[188:191], v[48:51]
    ds_read_b128 v[104:107], v13 offset:44288
    s_waitcnt lgkmcnt(6)
    v_mfma_f32_16x16x32_bf16 v[52:55], v[80:83], v[188:191], v[52:55]
    ds_read_b128 v[108:111], v13 offset:44544
    v_add_u32 v12, 57344, v10
    v_add_u32 v13, 57344, v11
    s_add_u32 m0, s41, 30720
    s_nop 0
    buffer_load_dwordx4 v4, s[36:39], s40 offen sc1 lds
    s_mov_b32 exec_hi, 0xffff
    buffer_load_dwordx4 v4, s[36:39], s40 offen offset:1024 sc1 lds
    s_mov_b32 exec_hi, -1
    s_add_u32 s40, s40, 14336
    s_waitcnt vmcnt(8)
    s_barrier
    s_waitcnt lgkmcnt(6)
    v_mfma_f32_16x16x32_bf16 v[28:31], v[84:87], v[192:195], v[28:31]
    ds_read_b128 v[56:59], v12 offset:0
    s_waitcnt lgkmcnt(6)
    v_mfma_f32_16x16x32_bf16 v[32:35], v[88:91], v[192:195], v[32:35]
    ds_read_b128 v[60:63], v12 offset:256
    s_waitcnt lgkmcnt(6)
    v_mfma_f32_16x16x32_bf16 v[36:39], v[92:95], v[192:195], v[36:39]
    ds_read_b128 v[64:67], v12 offset:512
    s_waitcnt lgkmcnt(6)
    v_mfma_f32_16x16x32_bf16 v[40:43], v[96:99], v[192:195], v[40:43]
    ds_read_b128 v[68:71], v13 offset:768
    s_waitcnt lgkmcnt(6)
    v_mfma_f32_16x16x32_bf16 v[44:47], v[100:103], v[192:195], v[44:47]
    ds_read_b128 v[72:75], v13 offset:1024
    s_waitcnt lgkmcnt(6)
    v_mfma_f32_16x16x32_bf16 v[48:51], v[104:107], v[192:195], v[48:51]
    ds_read_b128 v[76:79], v13 offset:1280
    s_waitcnt lgkmcnt(6)
    v_mfma_f32_16x16x32_bf16 v[52:55], v[108:111], v[192:195], v[52:55]
    ds_read_b128 v[80:83], v13 offset:1536
    s_add_u32 m0, s41, 45056
    s_nop 0
    buffer_load_dwordx4 v4, s[36:39], s40 offen sc1 lds
    s_mov_b32 exec_hi, 0xffff
    buffer_load_dwordx4 v4, s[36:39], s40 offen offset:1024 sc1 lds
    s_mov_b32 exec_hi, -1
    s_add_u32 s40, s40, 14336
    s_waitcnt vmcnt(8)
    s_barrier
    s_waitcnt lgkmcnt(6)
    v_mfma_f32_16x16x32_bf16 v[28:31], v[56:59], v[196:199], v[28:31]
    ds_read_b128 v[84:87], v12 offset:14336
    s_waitcnt lgkmcnt(6)
    v_mfma_f32_16x16x32_bf16 v[32:35], v[60:63], v[196:199], v[32:35]
    ds_read_b128 v[88:91], v12 offset:14592
    s_waitcnt lgkmcnt(6)
    v_mfma_f32_16x16x32_bf16 v[36:39], v[64:67], v[196:199], v[36:39]
    ds_read_b128 v[92:95], v12 offset:14848
    s_waitcnt lgkmcnt(6)
    v_mfma_f32_16x16x32_bf16 v[40:43], v[68:71], v[196:199], v[40:43]
    ds_read_b128 v[96:99], v13 offset:15104
    s_waitcnt lgkmcnt(6)
    v_mfma_f32_16x16x32_bf16 v[44:47], v[72:75], v[196:199], v[44:47]
    ds_read_b128 v[100:103], v13 offset:15360
    s_waitcnt lgkmcnt(6)
    v_mfma_f32_16x16x32_bf16 v[48:51], v[76:79], v[196:199], v[48:51]
    ds_read_b128 v[104:107], v13 offset:15616
    s_waitcnt lgkmcnt(6)
    v_mfma_f32_16x16x32_bf16 v[52:55], v[80:83], v[196:199], v[52:55]
    ds_read_b128 v[108:111], v13 offset:15872
    s_add_u32 m0, s41, 59392
    s_nop 0
    buffer_load_dwordx4 v4, s[36:39], s40 offen sc1 lds
    s_mov_b32 exec_hi, 0xffff
    buffer_load_dwordx4 v4, s[36:39], s40 offen offset:1024 sc1 lds
    s_mov_b32 exec_hi, -1
    s_add_u32 s40, s40, 14336
    s_waitcnt vmcnt(8)
    s_barrier
    s_waitcnt lgkmcnt(6)
    v_mfma_f32_16x16x32_bf16 v[28:31], v[84:87], v[200:203], v[28:31]
    ds_read_b128 v[56:59], v12 offset:28672
    s_waitcnt lgkmcnt(6)
    v_mfma_f32_16x16x32_bf16 v[32:35], v[88:91], v[200:203], v[32:35]
    ds_read_b128 v[60:63], v12 offset:28928
    s_waitcnt lgkmcnt(6)
    v_mfma_f32_16x16x32_bf16 v[36:39], v[92:95], v[200:203], v[36:39]
    ds_read_b128 v[64:67], v12 offset:29184
    s_waitcnt lgkmcnt(6)
    v_mfma_f32_16x16x32_bf16 v[40:43], v[96:99], v[200:203], v[40:43]
    ds_read_b128 v[68:71], v13 offset:29440
    s_waitcnt lgkmcnt(6)
    v_mfma_f32_16x16x32_bf16 v[44:47], v[100:103], v[200:203], v[44:47]
    ds_read_b128 v[72:75], v13 offset:29696
    s_waitcnt lgkmcnt(6)
    v_mfma_f32_16x16x32_bf16 v[48:51], v[104:107], v[200:203], v[48:51]
    ds_read_b128 v[76:79], v13 offset:29952
    s_waitcnt lgkmcnt(6)
    v_mfma_f32_16x16x32_bf16 v[52:55], v[108:111], v[200:203], v[52:55]
    ds_read_b128 v[80:83], v13 offset:30208
    v_mov_b32 v12, v10
    v_mov_b32 v13, v11
    s_add_u32 m0, s41, 73728
    s_nop 0
    buffer_load_dwordx4 v4, s[36:39], s40 offen sc1 lds
    s_mov_b32 exec_hi, 0xffff
    buffer_load_dwordx4 v4, s[36:39], s40 offen offset:1024 sc1 lds
    s_mov_b32 exec_hi, -1
    s_add_u32 s40, s40, 14336
    s_waitcnt vmcnt(8)
    s_barrier
    s_waitcnt lgkmcnt(6)
    v_mfma_f32_16x16x32_bf16 v[28:31], v[56:59], v[204:207], v[28:31]
    ds_read_b128 v[84:87], v12 offset:0
    s_waitcnt lgkmcnt(6)
    v_mfma_f32_16x16x32_bf16 v[32:35], v[60:63], v[204:207], v[32:35]
    ds_read_b128 v[88:91], v12 offset:256
    s_waitcnt lgkmcnt(6)
    v_mfma_f32_16x16x32_bf16 v[36:39], v[64:67], v[204:207], v[36:39]
    ds_read_b128 v[92:95], v12 offset:512
    s_waitcnt lgkmcnt(6)
    v_mfma_f32_16x16x32_bf16 v[40:43], v[68:71], v[204:207], v[40:43]
    ds_read_b128 v[96:99], v13 offset:768
    s_waitcnt lgkmcnt(6)
    v_mfma_f32_16x16x32_bf16 v[44:47], v[72:75], v[204:207], v[44:47]
    ds_read_b128 v[100:103], v13 offset:1024
    s_waitcnt lgkmcnt(6)
    v_mfma_f32_16x16x32_bf16 v[48:51], v[76:79], v[204:207], v[48:51]
    ds_read_b128 v[104:107], v13 offset:1280
    s_waitcnt lgkmcnt(6)
    v_mfma_f32_16x16x32_bf16 v[52:55], v[80:83], v[204:207], v[52:55]
    ds_read_b128 v[108:111], v13 offset:1536
    s_add_u32 m0, s41, 88064
    s_nop 0
    buffer_load_dwordx4 v4, s[36:39], s40 offen sc1 lds
    s_mov_b32 exec_hi, 0xffff
    buffer_load_dwordx4 v4, s[36:39], s40 offen offset:1024 sc1 lds
    s_mov_b32 exec_hi, -1
    s_add_u32 s40, s40, 14336
    s_waitcnt vmcnt(8)
    s_barrier
    s_waitcnt lgkmcnt(6)
    v_mfma_f32_16x16x32_bf16 v[28:31], v[84:87], v[208:211], v[28:31]
    ds_read_b128 v[56:59], v12 offset:14336
    s_waitcnt lgkmcnt(6)
    v_mfma_f32_16x16x32_bf16 v[32:35], v[88:91], v[208:211], v[32:35]
    ds_read_b128 v[60:63], v12 offset:14592
    s_waitcnt lgkmcnt(6)
    v_mfma_f32_16x16x32_bf16 v[36:39], v[92:95], v[208:211], v[36:39]
    ds_read_b128 v[64:67], v12 offset:14848
    s_waitcnt lgkmcnt(6)
    v_mfma_f32_16x16x32_bf16 v[40:43], v[96:99], v[208:211], v[40:43]
    ds_read_b128 v[68:71], v13 offset:15104
    s_waitcnt lgkmcnt(6)
    v_mfma_f32_16x16x32_bf16 v[44:47], v[100:103], v[208:211], v[44:47]
    ds_read_b128 v[72:75], v13 offset:15360
    s_waitcnt lgkmcnt(6)
    v_mfma_f32_16x16x32_bf16 v[48:51], v[104:107], v[208:211], v[48:51]
    ds_read_b128 v[76:79], v13 offset:15616
    s_waitcnt lgkmcnt(6)
    v_mfma_f32_16x16x32_bf16 v[52:55], v[108:111], v[208:211], v[52:55]
    ds_read_b128 v[80:83], v13 offset:15872
    s_add_u32 m0, s41, 102400
    s_nop 0
    buffer_load_dwordx4 v4, s[36:39], s40 offen sc1 lds
    s_mov_b32 exec_hi, 0xffff
    buffer_load_dwordx4 v4, s[36:39], s40 offen offset:1024 sc1 lds
    s_mov_b32 exec_hi, -1
    s_add_u32 s40, s40, 14336
    s_waitcnt vmcnt(8)
    s_barrier
    s_waitcnt lgkmcnt(6)
    v_mfma_f32_16x16x32_bf16 v[28:31], v[56:59], v[212:215], v[28:31]
    ds_read_b128 v[84:87], v12 offset:28672
    s_waitcnt lgkmcnt(6)
    v_mfma_f32_16x16x32_bf16 v[32:35], v[60:63], v[212:215], v[32:35]
    ds_read_b128 v[88:91], v12 offset:28928
    s_waitcnt lgkmcnt(6)
    v_mfma_f32_16x16x32_bf16 v[36:39], v[64:67], v[212:215], v[36:39]
    ds_read_b128 v[92:95], v12 offset:29184
    s_waitcnt lgkmcnt(6)
    v_mfma_f32_16x16x32_bf16 v[40:43], v[68:71], v[212:215], v[40:43]
    ds_read_b128 v[96:99], v13 offset:29440
    s_waitcnt lgkmcnt(6)
    v_mfma_f32_16x16x32_bf16 v[44:47], v[72:75], v[212:215], v[44:47]
    ds_read_b128 v[100:103], v13 offset:29696
    s_waitcnt lgkmcnt(6)
    v_mfma_f32_16x16x32_bf16 v[48:51], v[76:79], v[212:215], v[48:51]
    ds_read_b128 v[104:107], v13 offset:29952
    s_waitcnt lgkmcnt(6)
    v_mfma_f32_16x16x32_bf16 v[52:55], v[80:83], v[212:215], v[52:55]
    ds_read_b128 v[108:111], v13 offset:30208
    s_add_u32 m0, s41, 16384
    s_nop 0
    buffer_load_dwordx4 v4, s[36:39], s40 offen sc1 lds
    s_mov_b32 exec_hi, 0xffff
    buffer_load_dwordx4 v4, s[36:39], s40 offen offset:1024 sc1 lds
    s_mov_b32 exec_hi, -1
    s_add_u32 s40, s40, 14336
    s_waitcnt vmcnt(8)
    s_barrier
    s_waitcnt lgkmcnt(6)
    v_mfma_f32_16x16x32_bf16 v[28:31], v[84:87], v[216:219], v[28:31]
    ds_read_b128 v[56:59], v12 offset:43008
    s_waitcnt lgkmcnt(6)
    v_mfma_f32_16x16x32_bf16 v[32:35], v[88:91], v[216:219], v[32:35]
    ds_read_b128 v[60:63], v12 offset:43264
    s_waitcnt lgkmcnt(6)
    v_mfma_f32_16x16x32_bf16 v[36:39], v[92:95], v[216:219], v[36:39]
    ds_read_b128 v[64:67], v12 offset:43520
    s_waitcnt lgkmcnt(6)
    v_mfma_f32_16x16x32_bf16 v[40:43], v[96:99], v[216:219], v[40:43]
    ds_read_b128 v[68:71], v13 offset:43776
    s_waitcnt lgkmcnt(6)
    v_mfma_f32_16x16x32_bf16 v[44:47], v[100:103], v[216:219], v[44:47]
    ds_read_b128 v[72:75], v13 offset:44032
    s_waitcnt lgkmcnt(6)
    v_mfma_f32_16x16x32_bf16 v[48:51], v[104:107], v[216:219], v[48:51]
    ds_read_b128 v[76:79], v13 offset:44288
    s_waitcnt lgkmcnt(6)
    v_mfma_f32_16x16x32_bf16 v[52:55], v[108:111], v[216:219], v[52:55]
    ds_read_b128 v[80:83], v13 offset:44544
    v_add_u32 v12, 57344, v10
    v_add_u32 v13, 57344, v11
    s_add_u32 m0, s41, 30720
    s_nop 0
    buffer_load_dwordx4 v4, s[36:39], s40 offen sc1 lds
    s_mov_b32 exec_hi, 0xffff
    buffer_load_dwordx4 v4, s[36:39], s40 offen offset:1024 sc1 lds
    s_mov_b32 exec_hi, -1
    s_add_u32 s40, s40, 14336
    s_waitcnt vmcnt(8)
    s_barrier
    s_waitcnt lgkmcnt(6)
    v_mfma_f32_16x16x32_bf16 v[28:31], v[56:59], v[220:223], v[28:31]
    ds_read_b128 v[84:87], v12 offset:0
    s_waitcnt lgkmcnt(6)
    v_mfma_f32_16x16x32_bf16 v[32:35], v[60:63], v[220:223], v[32:35]
    ds_read_b128 v[88:91], v12 offset:256
    s_waitcnt lgkmcnt(6)
    v_mfma_f32_16x16x32_bf16 v[36:39], v[64:67], v[220:223], v[36:39]
    ds_read_b128 v[92:95], v12 offset:512
    s_waitcnt lgkmcnt(6)
    v_mfma_f32_16x16x32_bf16 v[40:43], v[68:71], v[220:223], v[40:43]
    ds_read_b128 v[96:99], v13 offset:768
    s_waitcnt lgkmcnt(6)
    v_mfma_f32_16x16x32_bf16 v[44:47], v[72:75], v[220:223], v[44:47]
    ds_read_b128 v[100:103], v13 offset:1024
    s_waitcnt lgkmcnt(6)
    v_mfma_f32_16x16x32_bf16 v[48:51], v[76:79], v[220:223], v[48:51]
    ds_read_b128 v[104:107], v13 offset:1280
    s_waitcnt lgkmcnt(6)
    v_mfma_f32_16x16x32_bf16 v[52:55], v[80:83], v[220:223], v[52:55]
    ds_read_b128 v[108:111], v13 offset:1536
    s_add_u32 m0, s41, 45056
    s_nop 0
    buffer_load_dwordx4 v4, s[36:39], s40 offen sc1 lds
    s_mov_b32 exec_hi, 0xffff
    buffer_load_dwordx4 v4, s[36:39], s40 offen offset:1024 sc1 lds
    s_mov_b32 exec_hi, -1
    s_add_u32 s40, s40, 14336
    s_waitcnt vmcnt(8)
    s_barrier
    s_waitcnt lgkmcnt(6)
    v_mfma_f32_16x16x32_bf16 v[28:31], v[84:87], v[224:227], v[28:31]
    ds_read_b128 v[56:59], v12 offset:14336
    s_waitcnt lgkmcnt(6)
    v_mfma_f32_16x16x32_bf16 v[32:35], v[88:91], v[224:227], v[32:35]
    ds_read_b128 v[60:63], v12 offset:14592
    s_waitcnt lgkmcnt(6)
    v_mfma_f32_16x16x32_bf16 v[36:39], v[92:95], v[224:227], v[36:39]
    ds_read_b128 v[64:67], v12 offset:14848
    s_waitcnt lgkmcnt(6)
    v_mfma_f32_16x16x32_bf16 v[40:43], v[96:99], v[224:227], v[40:43]
    ds_read_b128 v[68:71], v13 offset:15104
    s_waitcnt lgkmcnt(6)
    v_mfma_f32_16x16x32_bf16 v[44:47], v[100:103], v[224:227], v[44:47]
    ds_read_b128 v[72:75], v13 offset:15360
    s_waitcnt lgkmcnt(6)
    v_mfma_f32_16x16x32_bf16 v[48:51], v[104:107], v[224:227], v[48:51]
    ds_read_b128 v[76:79], v13 offset:15616
    s_waitcnt lgkmcnt(6)
    v_mfma_f32_16x16x32_bf16 v[52:55], v[108:111], v[224:227], v[52:55]
    ds_read_b128 v[80:83], v13 offset:15872
    s_add_u32 m0, s41, 59392
    s_nop 0
    buffer_load_dwordx4 v4, s[36:39], s40 offen sc1 lds
    s_mov_b32 exec_hi, 0xffff
    buffer_load_dwordx4 v4, s[36:39], s40 offen offset:1024 sc1 lds
    s_mov_b32 exec_hi, -1
    s_add_u32 s40, s40, 14336
    s_waitcnt vmcnt(8)
    s_barrier
    s_waitcnt lgkmcnt(6)
    v_mfma_f32_16x16x32_bf16 v[28:31], v[56:59], v[228:231], v[28:31]
    ds_read_b128 v[84:87], v12 offset:28672
    s_waitcnt lgkmcnt(6)
    v_mfma_f32_16x16x32_bf16 v[32:35], v[60:63], v[228:231], v[32:35]
    ds_read_b128 v[88:91], v12 offset:28928
    s_waitcnt lgkmcnt(6)
    v_mfma_f32_16x16x32_bf16 v[36:39], v[64:67], v[228:231], v[36:39]
    ds_read_b128 v[92:95], v12 offset:29184
    s_waitcnt lgkmcnt(6)
    v_mfma_f32_16x16x32_bf16 v[40:43], v[68:71], v[228:231], v[40:43]
    ds_read_b128 v[96:99], v13 offset:29440
    s_waitcnt lgkmcnt(6)
    v_mfma_f32_16x16x32_bf16 v[44:47], v[72:75], v[228:231], v[44:47]
    ds_read_b128 v[100:103], v13 offset:29696
    s_waitcnt lgkmcnt(6)
    v_mfma_f32_16x16x32_bf16 v[48:51], v[76:79], v[228:231], v[48:51]
    ds_read_b128 v[104:107], v13 offset:29952
    s_waitcnt lgkmcnt(6)
    v_mfma_f32_16x16x32_bf16 v[52:55], v[80:83], v[228:231], v[52:55]
    ds_read_b128 v[108:111], v13 offset:30208
    v_mov_b32 v12, v10
    v_mov_b32 v13, v11
    s_waitcnt vmcnt(6)
    s_barrier
    s_waitcnt lgkmcnt(6)
    v_mfma_f32_16x16x32_bf16 v[28:31], v[84:87], v[232:235], v[28:31]
    ds_read_b128 v[56:59], v12 offset:0
    s_waitcnt lgkmcnt(6)
    v_mfma_f32_16x16x32_bf16 v[32:35], v[88:91], v[232:235], v[32:35]
    ds_read_b128 v[60:63], v12 offset:256
    s_waitcnt lgkmcnt(6)
    v_mfma_f32_16x16x32_bf16 v[36:39], v[92:95], v[232:235], v[36:39]
    ds_read_b128 v[64:67], v12 offset:512
    s_waitcnt lgkmcnt(6)
    v_mfma_f32_16x16x32_bf16 v[40:43], v[96:99], v[232:235], v[40:43]
    ds_read_b128 v[68:71], v13 offset:768
    s_waitcnt lgkmcnt(6)
    v_mfma_f32_16x16x32_bf16 v[44:47], v[100:103], v[232:235], v[44:47]
    ds_read_b128 v[72:75], v13 offset:1024
    s_waitcnt lgkmcnt(6)
    v_mfma_f32_16x16x32_bf16 v[48:51], v[104:107], v[232:235], v[48:51]
    ds_read_b128 v[76:79], v13 offset:1280
    s_waitcnt lgkmcnt(6)
    v_mfma_f32_16x16x32_bf16 v[52:55], v[108:111], v[232:235], v[52:55]
    ds_read_b128 v[80:83], v13 offset:1536
    s_waitcnt vmcnt(4)
    s_barrier
    s_waitcnt lgkmcnt(6)
    v_mfma_f32_16x16x32_bf16 v[28:31], v[56:59], v[236:239], v[28:31]
    ds_read_b128 v[84:87], v12 offset:14336
    s_waitcnt lgkmcnt(6)
    v_mfma_f32_16x16x32_bf16 v[32:35], v[60:63], v[236:239], v[32:35]
    ds_read_b128 v[88:91], v12 offset:14592
    s_waitcnt lgkmcnt(6)
    v_mfma_f32_16x16x32_bf16 v[36:39], v[64:67], v[236:239], v[36:39]
    ds_read_b128 v[92:95], v12 offset:14848
    s_waitcnt lgkmcnt(6)
    v_mfma_f32_16x16x32_bf16 v[40:43], v[68:71], v[236:239], v[40:43]
    ds_read_b128 v[96:99], v13 offset:15104
    s_waitcnt lgkmcnt(6)
    v_mfma_f32_16x16x32_bf16 v[44:47], v[72:75], v[236:239], v[44:47]
    ds_read_b128 v[100:103], v13 offset:15360
    s_waitcnt lgkmcnt(6)
    v_mfma_f32_16x16x32_bf16 v[48:51], v[76:79], v[236:239], v[48:51]
    ds_read_b128 v[104:107], v13 offset:15616
    s_waitcnt lgkmcnt(6)
    v_mfma_f32_16x16x32_bf16 v[52:55], v[80:83], v[236:239], v[52:55]
    ds_read_b128 v[108:111], v13 offset:15872
    s_waitcnt vmcnt(2)
    s_barrier
    s_waitcnt lgkmcnt(6)
    v_mfma_f32_16x16x32_bf16 v[28:31], v[84:87], v[240:243], v[28:31]
    ds_read_b128 v[56:59], v12 offset:28672
    s_waitcnt lgkmcnt(6)
    v_mfma_f32_16x16x32_bf16 v[32:35], v[88:91], v[240:243], v[32:35]
    ds_read_b128 v[60:63], v12 offset:28928
    s_waitcnt lgkmcnt(6)
    v_mfma_f32_16x16x32_bf16 v[36:39], v[92:95], v[240:243], v[36:39]
    ds_read_b128 v[64:67], v12 offset:29184
    s_waitcnt lgkmcnt(6)
    v_mfma_f32_16x16x32_bf16 v[40:43], v[96:99], v[240:243], v[40:43]
    ds_read_b128 v[68:71], v13 offset:29440
    s_waitcnt lgkmcnt(6)
    v_mfma_f32_16x16x32_bf16 v[44:47], v[100:103], v[240:243], v[44:47]
    ds_read_b128 v[72:75], v13 offset:29696
    s_waitcnt lgkmcnt(6)
    v_mfma_f32_16x16x32_bf16 v[48:51], v[104:107], v[240:243], v[48:51]
    ds_read_b128 v[76:79], v13 offset:29952
    s_waitcnt lgkmcnt(6)
    v_mfma_f32_16x16x32_bf16 v[52:55], v[108:111], v[240:243], v[52:55]
    ds_read_b128 v[80:83], v13 offset:30208
    s_waitcnt vmcnt(0)
    s_barrier
    s_waitcnt lgkmcnt(6)
    v_mfma_f32_16x16x32_bf16 v[28:31], v[56:59], v[244:247], v[28:31]
    ds_read_b128 v[84:87], v12 offset:43008
    s_waitcnt lgkmcnt(6)
    v_mfma_f32_16x16x32_bf16 v[32:35], v[60:63], v[244:247], v[32:35]
    ds_read_b128 v[88:91], v12 offset:43264
    s_waitcnt lgkmcnt(6)
    v_mfma_f32_16x16x32_bf16 v[36:39], v[64:67], v[244:247], v[36:39]
    ds_read_b128 v[92:95], v12 offset:43520
    s_waitcnt lgkmcnt(6)
    v_mfma_f32_16x16x32_bf16 v[40:43], v[68:71], v[244:247], v[40:43]
    ds_read_b128 v[96:99], v13 offset:43776
    s_waitcnt lgkmcnt(6)
    v_mfma_f32_16x16x32_bf16 v[44:47], v[72:75], v[244:247], v[44:47]
    ds_read_b128 v[100:103], v13 offset:44032
    s_waitcnt lgkmcnt(6)
    v_mfma_f32_16x16x32_bf16 v[48:51], v[76:79], v[244:247], v[48:51]
    ds_read_b128 v[104:107], v13 offset:44288
    s_waitcnt lgkmcnt(6)
    v_mfma_f32_16x16x32_bf16 v[52:55], v[80:83], v[244:247], v[52:55]
    ds_read_b128 v[108:111], v13 offset:44544
    v_add_u32 v12, 57344, v10
    v_add_u32 v13, 57344, v11
    s_waitcnt lgkmcnt(6)
    v_mfma_f32_16x16x32_bf16 v[28:31], v[84:87], v[248:251], v[28:31]
    s_waitcnt lgkmcnt(5)
    v_mfma_f32_16x16x32_bf16 v[32:35], v[88:91], v[248:251], v[32:35]
    s_waitcnt lgkmcnt(4)
    v_mfma_f32_16x16x32_bf16 v[36:39], v[92:95], v[248:251], v[36:39]
    s_waitcnt lgkmcnt(3)
    v_mfma_f32_16x16x32_bf16 v[40:43], v[96:99], v[248:251], v[40:43]
    s_waitcnt lgkmcnt(2)
    v_mfma_f32_16x16x32_bf16 v[44:47], v[100:103], v[248:251], v[44:47]
    s_waitcnt lgkmcnt(1)
    v_mfma_f32_16x16x32_bf16 v[48:51], v[104:107], v[248:251], v[48:51]
    s_waitcnt lgkmcnt(0)
    v_mfma_f32_16x16x32_bf16 v[52:55], v[108:111], v[248:251], v[52:55]
    ds_read_b64 v[84:85], v15 offset:0
    ds_read_b64 v[86:87], v15 offset:32
    ds_read_b64 v[88:89], v15 offset:64
    ds_read_b64 v[90:91], v15 offset:96
    ds_write_b128 v16, v[40:43] offset:0
    ds_write_b128 v16, v[44:47] offset:1024
    ds_write_b128 v16, v[48:51] offset:2048
    s_nop 0
    ds_write_b128 v16, v[52:55] offset:3072
    s_waitcnt lgkmcnt(0)
    s_barrier
    ds_read_b128 v[56:59], v17 offset:0
    ds_read_b128 v[60:63], v17 offset:1024
    ds_read_b128 v[64:67], v17 offset:2048
    ds_read_b128 v[68:71], v17 offset:3072
    v_lshlrev_b32 v18, 16, v18
    s_waitcnt lgkmcnt(3)
    v_pk_add_f32 v[28:29], v[28:29], v[56:57]
    v_pk_add_f32 v[30:31], v[30:31], v[58:59]
    v_pk_add_f32 v[28:29], v[28:29], v[18:19] op_sel_hi:[1,0]
    v_pk_add_f32 v[30:31], v[30:31], v[18:19] op_sel_hi:[1,0]
    v_lshlrev_b32 v112, 16, v84
    v_lshlrev_b32 v114, 16, v85
    v_and_b32 v113, 0xffff0000, v84
    v_and_b32 v115, 0xffff0000, v85
    v_pk_mul_f32 v[28:29], v[28:29], v[112:113]
    v_pk_mul_f32 v[30:31], v[30:31], v[114:115]
    v_cvt_pk_bf16_f32 v84, v28, v29
    v_cvt_pk_bf16_f32 v85, v30, v31
    buffer_store_dwordx2 v[84:85], v14, s[60:63], 0 offen offset:0 sc0 sc1
    s_cmp_le_u32 s68, 1
    s_cbranch_scc1 L_mega_kernel_done_112
    s_waitcnt lgkmcnt(2)
    v_pk_add_f32 v[32:33], v[32:33], v[60:61]
    v_pk_add_f32 v[34:35], v[34:35], v[62:63]
    v_pk_add_f32 v[32:33], v[32:33], v[18:19] op_sel_hi:[1,0]
    v_pk_add_f32 v[34:35], v[34:35], v[18:19] op_sel_hi:[1,0]
    v_lshlrev_b32 v112, 16, v86
    v_lshlrev_b32 v114, 16, v87
    v_and_b32 v113, 0xffff0000, v86
    v_and_b32 v115, 0xffff0000, v87
    v_pk_mul_f32 v[32:33], v[32:33], v[112:113]
    v_pk_mul_f32 v[34:35], v[34:35], v[114:115]
    v_cvt_pk_bf16_f32 v86, v32, v33
    v_cvt_pk_bf16_f32 v87, v34, v35
    buffer_store_dwordx2 v[86:87], v14, s[60:63], 0 offen offset:2048 sc0 sc1
    s_cmp_le_u32 s68, 2
    s_cbranch_scc1 L_mega_kernel_done_112
    s_waitcnt lgkmcnt(1)
    v_pk_add_f32 v[36:37], v[36:37], v[64:65]
    v_pk_add_f32 v[38:39], v[38:39], v[66:67]
    v_pk_add_f32 v[36:37], v[36:37], v[18:19] op_sel_hi:[1,0]
    v_pk_add_f32 v[38:39], v[38:39], v[18:19] op_sel_hi:[1,0]
    v_lshlrev_b32 v112, 16, v88
    v_lshlrev_b32 v114, 16, v89
    v_and_b32 v113, 0xffff0000, v88
    v_and_b32 v115, 0xffff0000, v89
    v_pk_mul_f32 v[36:37], v[36:37], v[112:113]
    v_pk_mul_f32 v[38:39], v[38:39], v[114:115]
    v_cvt_pk_bf16_f32 v88, v36, v37
    v_cvt_pk_bf16_f32 v89, v38, v39
    v_add_u32 v14, 4096, v14
    buffer_store_dwordx2 v[88:89], v14, s[60:63], 0 offen offset:0 sc0 sc1
    s_cmp_le_u32 s68, 3
    s_cbranch_scc1 L_mega_kernel_done_112
    s_waitcnt lgkmcnt(0)
    v_pk_add_f32 v[40:41], v[40:41], v[68:69]
    v_pk_add_f32 v[42:43], v[42:43], v[70:71]
    v_pk_add_f32 v[40:41], v[40:41], v[18:19] op_sel_hi:[1,0]
    v_pk_add_f32 v[42:43], v[42:43], v[18:19] op_sel_hi:[1,0]
    v_lshlrev_b32 v112, 16, v90
    v_lshlrev_b32 v114, 16, v91
    v_and_b32 v113, 0xffff0000, v90
    v_and_b32 v115, 0xffff0000, v91
    v_pk_mul_f32 v[40:41], v[40:41], v[112:113]
    v_pk_mul_f32 v[42:43], v[42:43], v[114:115]
    v_cvt_pk_bf16_f32 v90, v40, v41
    v_cvt_pk_bf16_f32 v91, v42, v43
    buffer_store_dwordx2 v[90:91], v14, s[60:63], 0 offen offset:2048 sc0 sc1
L_mega_kernel_done_112:
    s_waitcnt lgkmcnt(0)
    s_lshl_b32 s92, s14, 3
    s_add_u32 s91, s92, s15
    v_and_b32 v5, 7, v1
    v_lshlrev_b32 v5, 7, v5
    s_lshl_b32 s17, s92, 7
    v_add_u32 v5, s17, v5
    v_add_u32 v5, 98304, v5
    s_waitcnt vmcnt(0)
    v_mov_b32 v2, 161836
    v_mov_b32 v3, 1
    s_mov_b64 exec, 1
    ds_add_rtn_u32 v3, v2, v3
    s_waitcnt lgkmcnt(0)
    v_cmp_eq_u32 vcc, 15, v3
    s_mov_b64 exec, -1
    s_cbranch_vccz L_mega_kernel_np_113
    s_lshl_b32 s17, s91, 7
    v_mov_b32 v2, 98304
    v_mov_b32 v112, s20
    v_mov_b32 v113, s21
    s_mov_b64 exec, 1
    buffer_store_dwordx2 v[112:113], v2, s[44:47], s17 offen sc0 sc1
    s_mov_b64 exec, -1
L_mega_kernel_np_113:
    s_mul_i32 s17, s16, 1280
    s_add_u32 m0, s17, 20480
    s_nop 0
    buffer_load_dwordx4 v4, s[72:75], s76 offen sc1 lds
    s_mov_b64 exec, 0xffff
    buffer_load_dwordx4 v4, s[72:75], s76 offen offset:1024 sc1 lds
    s_mov_b64 exec, -1
    s_add_u32 s76, s76, 10240
    s_mul_i32 s17, s16, 1280
    s_add_u32 m0, s17, 30720
    s_nop 0
    buffer_load_dwordx4 v4, s[72:75], s76 offen sc1 lds
    s_mov_b64 exec, 0xffff
    buffer_load_dwordx4 v4, s[72:75], s76 offen offset:1024 sc1 lds
    s_mov_b64 exec, -1
    s_add_u32 s76, s76, 10240
    s_mul_i32 s17, s16, 1280
    s_add_u32 m0, s17, 40960
    s_nop 0
    buffer_load_dwordx4 v4, s[72:75], s76 offen sc1 lds
    s_mov_b64 exec, 0xffff
    buffer_load_dwordx4 v4, s[72:75], s76 offen offset:1024 sc1 lds
    s_mov_b64 exec, -1
    s_add_u32 s76, s76, 10240
    s_mul_i32 s17, s16, 1280
    s_add_u32 m0, s17, 51200
    s_nop 0
    buffer_load_dwordx4 v4, s[72:75], s76 offen sc1 lds
    s_mov_b64 exec, 0xffff
    buffer_load_dwordx4 v4, s[72:75], s76 offen offset:1024 sc1 lds
    s_mov_b64 exec, -1
    s_add_u32 s76, s76, 10240
    s_mul_i32 s17, s16, 1280
    s_add_u32 m0, s17, 61440
    s_nop 0
    buffer_load_dwordx4 v4, s[72:75], s76 offen sc1 lds
    s_mov_b64 exec, 0xffff
    buffer_load_dwordx4 v4, s[72:75], s76 offen offset:1024 sc1 lds
    s_mov_b64 exec, -1
    s_add_u32 s76, s76, 10240
    s_mul_i32 s17, s16, 1280
    s_add_u32 m0, s17, 71680
    s_nop 0
    buffer_load_dwordx4 v4, s[72:75], s76 offen sc1 lds
    s_mov_b64 exec, 0xffff
    buffer_load_dwordx4 v4, s[72:75], s76 offen offset:1024 sc1 lds
    s_mov_b64 exec, -1
    s_add_u32 s76, s76, 10240
    s_and_b32 s90, s16, 1
    v_lshrrev_b32 v6, 4, v1
    v_and_b32 v7, 15, v1
    v_mul_u32_u24 v8, 1280, v6
    v_lshl_add_u32 v8, v7, 4, v8
    s_mul_i32 s17, s90, 5120
    v_add_u32 v8, s17, v8
    v_lshlrev_b32 v13, 10, v6
    v_lshl_add_u32 v13, v7, 4, v13
    s_lshl_b32 s17, s22, 8
    s_lshl_b32 s18, s90, 12
    s_add_u32 s17, s17, s18
    s_add_u32 s17, s17, 102400
    v_add_u32 v13, s17, v13
    v_xor_b32 v14, 256, v13
    s_lshl_b32 s17, s14, 6
    s_lshl_b32 s18, s22, 4
    s_add_u32 s17, s17, s18
    v_add_u32 v9, s17, v7
    v_mul_u32_u24 v9, 1280, v9
    v_lshl_add_u32 v9, v6, 3, v9
    s_mul_i32 s17, s15, 160
    v_add_u32 v9, s17, v9
    v_bfe_u32 v3, v1, 2, 2
    v_lshl_add_u32 v10, v6, 2, v3
    v_lshlrev_b32 v10, 7, v10
    v_and_b32 v2, 3, v1
    v_lshl_add_u32 v10, v2, 3, v10
    s_lshl_b32 s17, s22, 5
    s_add_u32 s17, s17, 151552
    v_add_u32 v10, s17, v10
    s_mul_i32 s17, s22, 5120
    v_add_u32 v11, s17, v4
    v_mov_b32 v28, 0
    v_mov_b32 v29, 0
    v_mov_b32 v30, 0
    v_mov_b32 v31, 0
    v_mov_b32 v32, 0
    v_mov_b32 v33, 0
    v_mov_b32 v34, 0
    v_mov_b32 v35, 0
    v_mov_b32 v36, 0
    v_mov_b32 v37, 0
    v_mov_b32 v38, 0
    v_mov_b32 v39, 0
    v_mov_b32 v40, 0
    v_mov_b32 v41, 0
    v_mov_b32 v42, 0
    v_mov_b32 v43, 0
    v_mov_b32 v44, 0
    v_mov_b32 v45, 0
    v_mov_b32 v46, 0
    v_mov_b32 v47, 0
    v_mov_b32 v48, 0
    v_mov_b32 v49, 0
    v_mov_b32 v50, 0
    v_mov_b32 v51, 0
    v_mov_b32 v52, 0
    v_mov_b32 v53, 0
    v_mov_b32 v54, 0
    v_mov_b32 v55, 0
    v_mov_b32 v56, 0
    v_mov_b32 v57, 0
    v_mov_b32 v58, 0
    v_mov_b32 v59, 0
    v_mov_b32 v60, 0
    v_mov_b32 v61, 0
    v_mov_b32 v62, 0
    v_mov_b32 v63, 0
    v_mov_b32 v64, 0
    v_mov_b32 v65, 0
    v_mov_b32 v66, 0
    v_mov_b32 v67, 0
    s_mov_b32 s80, s12
    s_mov_b32 s81, s13
    s_mov_b32 s82, 0x280000
    s_mov_b32 s83, 0x00020000
    s_mul_i32 s17, s14, 110592
    s_add_u32 s84, s6, s17
    s_addc_u32 s85, s7, 0
    s_add_u32 s84, s84, 0x1800000
    s_addc_u32 s85, s85, 0
    s_mov_b32 s86, 110592
    s_mov_b32 s87, 0x00020000
    s_lshl_b32 s89, s22, 11
    s_mov_b32 s88, s89
    v_mov_b32 v2, 161836
    s_mov_b32 s17, 0
L_mega_kernel_ls_114:
    ds_read_b32 v3, v2
    s_waitcnt lgkmcnt(0)
    v_cmp_gt_u32 vcc, 16, v3
    s_cbranch_vccz L_mega_kernel_lo_115
    s_add_u32 s17, s17, 1
    s_sleep 1
    s_cmp_lt_u32 s17, 0x400000
    s_cbranch_scc1 L_mega_kernel_ls_114
L_mega_kernel_lo_115:
    s_mul_i32 s17, s16, 1280
    s_add_u32 m0, s17, 81920
    s_nop 0
    buffer_load_dwordx4 v4, s[72:75], s76 offen sc1 lds
    s_mov_b64 exec, 0xffff
    buffer_load_dwordx4 v4, s[72:75], s76 offen offset:1024 sc1 lds
    s_mov_b64 exec, -1
    s_add_u32 s76, s76, 10240
    s_mul_i32 s17, s16, 1280
    s_add_u32 m0, s17, 92160
    s_nop 0
    buffer_load_dwordx4 v4, s[72:75], s76 offen sc1 lds
    s_mov_b64 exec, 0xffff
    buffer_load_dwordx4 v4, s[72:75], s76 offen offset:1024 sc1 lds
    s_mov_b64 exec, -1
    s_add_u32 s76, s76, 10240
    s_mul_i32 s17, s16, 1280
    s_add_u32 m0, s17, 0
    s_nop 0
    buffer_load_dwordx4 v4, s[72:75], s76 offen sc1 lds
    s_mov_b64 exec, 0xffff
    buffer_load_dwordx4 v4, s[72:75], s76 offen offset:1024 sc1 lds
    s_mov_b64 exec, -1
    s_add_u32 s76, s76, 10240
    s_mul_i32 s17, s16, 1280
    s_add_u32 m0, s17, 10240
    s_nop 0
    buffer_load_dwordx4 v4, s[72:75], s76 offen sc1 lds
    s_mov_b64 exec, 0xffff
    buffer_load_dwordx4 v4, s[72:75], s76 offen offset:1024 sc1 lds
    s_mov_b64 exec, -1
    s_add_u32 s76, s76, 10240
    s_cmp_lg_u32 s16, 0
    s_cbranch_scc1 L_mega_kernel_as_116
    s_mov_b32 s56, 0
L_mega_kernel_poll_117:
    buffer_load_dwordx2 v[112:113], v5, s[44:47], 0 offen offset:0 sc1
    s_waitcnt vmcnt(0)
    v_cmp_ne_u64 vcc, s[20:21], v[112:113]
    s_cbranch_vccz L_mega_kernel_ok_118
    s_add_u32 s56, s56, 1
    s_cmp_lt_u32 s56, 0x100000
    s_cbranch_scc1 L_mega_kernel_poll_117
L_mega_kernel_ok_118:
L_mega_kernel_as_116:
    s_waitcnt vmcnt(0)
    s_barrier
    s_cmp_ge_u32 s16, 4
    s_cbranch_scc1 L_mega_kernel_m5_119
    v_add_u32 v12, 40960, v8
    s_barrier
    ds_read_b128 v[120:123], v8 offset:20480
    ds_read_b128 v[160:163], v13 offset:0
    ds_read_b128 v[164:167], v14 offset:0
    ds_read_b128 v[124:127], v8 offset:20736
    ds_read_b128 v[128:131], v8 offset:20992
    ds_read_b128 v[132:135], v8 offset:21248
    ds_read_b128 v[136:139], v8 offset:21504
    s_barrier
    s_waitcnt lgkmcnt(5)
    v_mfma_f32_16x16x32_bf16 v[28:31], v[120:123], v[160:163], v[28:31]
    ds_read_b128 v[140:143], v8 offset:30720
    s_waitcnt lgkmcnt(5)
    v_mfma_f32_16x16x32_bf16 v[48:51], v[120:123], v[164:167], v[48:51]
    s_waitcnt lgkmcnt(4)
    v_mfma_f32_16x16x32_bf16 v[32:35], v[124:127], v[160:163], v[32:35]
    ds_read_b128 v[168:171], v13 offset:8192
    v_mfma_f32_16x16x32_bf16 v[52:55], v[124:127], v[164:167], v[52:55]
    ds_read_b128 v[172:175], v14 offset:8192
    s_waitcnt lgkmcnt(5)
    v_mfma_f32_16x16x32_bf16 v[36:39], v[128:131], v[160:163], v[36:39]
    v_mfma_f32_16x16x32_bf16 v[56:59], v[128:131], v[164:167], v[56:59]
    ds_read_b128 v[144:147], v8 offset:30976
    s_waitcnt lgkmcnt(5)
    v_mfma_f32_16x16x32_bf16 v[40:43], v[132:135], v[160:163], v[40:43]
    ds_read_b128 v[148:151], v8 offset:31232
    v_mfma_f32_16x16x32_bf16 v[60:63], v[132:135], v[164:167], v[60:63]
    s_waitcnt lgkmcnt(5)
    v_mfma_f32_16x16x32_bf16 v[44:47], v[136:139], v[160:163], v[44:47]
    ds_read_b128 v[152:155], v8 offset:31488
    v_mfma_f32_16x16x32_bf16 v[64:67], v[136:139], v[164:167], v[64:67]
    ds_read_b128 v[156:159], v8 offset:31744
    s_barrier
    s_waitcnt lgkmcnt(5)
    v_mfma_f32_16x16x32_bf16 v[28:31], v[140:143], v[168:171], v[28:31]
    ds_read_b128 v[120:123], v8 offset:40960
    s_waitcnt lgkmcnt(5)
    v_mfma_f32_16x16x32_bf16 v[48:51], v[140:143], v[172:175], v[48:51]
    s_waitcnt lgkmcnt(4)
    v_mfma_f32_16x16x32_bf16 v[32:35], v[144:147], v[168:171], v[32:35]
    ds_read_b128 v[160:163], v13 offset:16384
    v_mfma_f32_16x16x32_bf16 v[52:55], v[144:147], v[172:175], v[52:55]
    ds_read_b128 v[164:167], v14 offset:16384
    s_waitcnt lgkmcnt(5)
    v_mfma_f32_16x16x32_bf16 v[36:39], v[148:151], v[168:171], v[36:39]
    v_mfma_f32_16x16x32_bf16 v[56:59], v[148:151], v[172:175], v[56:59]
    ds_read_b128 v[124:127], v8 offset:41216
    s_waitcnt lgkmcnt(5)
    v_mfma_f32_16x16x32_bf16 v[40:43], v[152:155], v[168:171], v[40:43]
    ds_read_b128 v[128:131], v8 offset:41472
    v_mfma_f32_16x16x32_bf16 v[60:63], v[152:155], v[172:175], v[60:63]
    s_waitcnt lgkmcnt(5)
    v_mfma_f32_16x16x32_bf16 v[44:47], v[156:159], v[168:171], v[44:47]
    ds_read_b128 v[132:135], v8 offset:41728
    v_mfma_f32_16x16x32_bf16 v[64:67], v[156:159], v[172:175], v[64:67]
    ds_read_b128 v[136:139], v8 offset:41984
    s_barrier
    s_waitcnt lgkmcnt(5)
    v_mfma_f32_16x16x32_bf16 v[28:31], v[120:123], v[160:163], v[28:31]
    ds_read_b128 v[140:143], v8 offset:51200
    s_waitcnt lgkmcnt(5)
    v_mfma_f32_16x16x32_bf16 v[48:51], v[120:123], v[164:167], v[48:51]
    s_waitcnt lgkmcnt(4)
    v_mfma_f32_16x16x32_bf16 v[32:35], v[124:127], v[160:163], v[32:35]
    ds_read_b128 v[168:171], v13 offset:24576
    v_mfma_f32_16x16x32_bf16 v[52:55], v[124:127], v[164:167], v[52:55]
    ds_read_b128 v[172:175], v14 offset:24576
    s_waitcnt lgkmcnt(5)
    v_mfma_f32_16x16x32_bf16 v[36:39], v[128:131], v[160:163], v[36:39]
    v_mfma_f32_16x16x32_bf16 v[56:59], v[128:131], v[164:167], v[56:59]
    ds_read_b128 v[144:147], v8 offset:51456
    s_waitcnt lgkmcnt(5)
    v_mfma_f32_16x16x32_bf16 v[40:43], v[132:135], v[160:163], v[40:43]
    ds_read_b128 v[148:151], v8 offset:51712
    v_mfma_f32_16x16x32_bf16 v[60:63], v[132:135], v[164:167], v[60:63]
    s_waitcnt lgkmcnt(5)
    v_mfma_f32_16x16x32_bf16 v[44:47], v[136:139], v[160:163], v[44:47]
    ds_read_b128 v[152:155], v8 offset:51968
    v_mfma_f32_16x16x32_bf16 v[64:67], v[136:139], v[164:167], v[64:67]
    ds_read_b128 v[156:159], v8 offset:52224
    s_barrier
    s_waitcnt lgkmcnt(5)
    v_mfma_f32_16x16x32_bf16 v[28:31], v[140:143], v[168:171], v[28:31]
    ds_read_b128 v[120:123], v8 offset:61440
    s_waitcnt lgkmcnt(5)
    v_mfma_f32_16x16x32_bf16 v[48:51], v[140:143], v[172:175], v[48:51]
    s_waitcnt lgkmcnt(4)
    v_mfma_f32_16x16x32_bf16 v[32:35], v[144:147], v[168:171], v[32:35]
    ds_read_b128 v[160:163], v13 offset:32768
    v_mfma_f32_16x16x32_bf16 v[52:55], v[144:147], v[172:175], v[52:55]
    ds_read_b128 v[164:167], v14 offset:32768
    s_waitcnt lgkmcnt(5)
    v_mfma_f32_16x16x32_bf16 v[36:39], v[148:151], v[168:171], v[36:39]
    v_mfma_f32_16x16x32_bf16 v[56:59], v[148:151], v[172:175], v[56:59]
    ds_read_b128 v[124:127], v8 offset:61696
    s_waitcnt lgkmcnt(5)
    v_mfma_f32_16x16x32_bf16 v[40:43], v[152:155], v[168:171], v[40:43]
    ds_read_b128 v[128:131], v8 offset:61952
    v_mfma_f32_16x16x32_bf16 v[60:63], v[152:155], v[172:175], v[60:63]
    s_waitcnt lgkmcnt(5)
    v_mfma_f32_16x16x32_bf16 v[44:47], v[156:159], v[168:171], v[44:47]
    ds_read_b128 v[132:135], v8 offset:62208
    v_mfma_f32_16x16x32_bf16 v[64:67], v[156:159], v[172:175], v[64:67]
    ds_read_b128 v[136:139], v8 offset:62464
    s_barrier
    s_waitcnt lgkmcnt(5)
    v_mfma_f32_16x16x32_bf16 v[28:31], v[120:123], v[160:163], v[28:31]
    ds_read_b128 v[140:143], v12 offset:30720
    s_waitcnt lgkmcnt(5)
    v_mfma_f32_16x16x32_bf16 v[48:51], v[120:123], v[164:167], v[48:51]
    s_waitcnt lgkmcnt(4)
    v_mfma_f32_16x16x32_bf16 v[32:35], v[124:127], v[160:163], v[32:35]
    ds_read_b128 v[168:171], v13 offset:40960
    v_mfma_f32_16x16x32_bf16 v[52:55], v[124:127], v[164:167], v[52:55]
    ds_read_b128 v[172:175], v14 offset:40960
    s_waitcnt lgkmcnt(5)
    v_mfma_f32_16x16x32_bf16 v[36:39], v[128:131], v[160:163], v[36:39]
    v_mfma_f32_16x16x32_bf16 v[56:59], v[128:131], v[164:167], v[56:59]
    ds_read_b128 v[144:147], v12 offset:30976
    s_waitcnt lgkmcnt(5)
    v_mfma_f32_16x16x32_bf16 v[40:43], v[132:135], v[160:163], v[40:43]
    ds_read_b128 v[148:151], v12 offset:31232
    v_mfma_f32_16x16x32_bf16 v[60:63], v[132:135], v[164:167], v[60:63]
    s_waitcnt lgkmcnt(5)
    v_mfma_f32_16x16x32_bf16 v[44:47], v[136:139], v[160:163], v[44:47]
    ds_read_b128 v[152:155], v12 offset:31488
    v_mfma_f32_16x16x32_bf16 v[64:67], v[136:139], v[164:167], v[64:67]
    ds_read_b128 v[156:159], v12 offset:31744
    s_barrier
    s_waitcnt lgkmcnt(5)
    v_mfma_f32_16x16x32_bf16 v[28:31], v[140:143], v[168:171], v[28:31]
    ds_read_b128 v[120:123], v12 offset:40960
    s_waitcnt lgkmcnt(5)
    v_mfma_f32_16x16x32_bf16 v[48:51], v[140:143], v[172:175], v[48:51]
    s_waitcnt lgkmcnt(4)
    v_mfma_f32_16x16x32_bf16 v[32:35], v[144:147], v[168:171], v[32:35]
    ds_read_b128 v[160:163], v13 offset:0
    v_mfma_f32_16x16x32_bf16 v[52:55], v[144:147], v[172:175], v[52:55]
    ds_read_b128 v[164:167], v14 offset:0
    s_waitcnt lgkmcnt(5)
    v_mfma_f32_16x16x32_bf16 v[36:39], v[148:151], v[168:171], v[36:39]
    v_mfma_f32_16x16x32_bf16 v[56:59], v[148:151], v[172:175], v[56:59]
    ds_read_b128 v[124:127], v12 offset:41216
    s_waitcnt lgkmcnt(5)
    v_mfma_f32_16x16x32_bf16 v[40:43], v[152:155], v[168:171], v[40:43]
    ds_read_b128 v[128:131], v12 offset:41472
    v_mfma_f32_16x16x32_bf16 v[60:63], v[152:155], v[172:175], v[60:63]
    s_waitcnt lgkmcnt(5)
    v_mfma_f32_16x16x32_bf16 v[44:47], v[156:159], v[168:171], v[44:47]
    ds_read_b128 v[132:135], v12 offset:41728
    v_mfma_f32_16x16x32_bf16 v[64:67], v[156:159], v[172:175], v[64:67]
    ds_read_b128 v[136:139], v12 offset:41984
    s_barrier
    s_waitcnt lgkmcnt(5)
    v_mfma_f32_16x16x32_bf16 v[28:31], v[120:123], v[160:163], v[28:31]
    ds_read_b128 v[140:143], v12 offset:51200
    s_waitcnt lgkmcnt(5)
    v_mfma_f32_16x16x32_bf16 v[48:51], v[120:123], v[164:167], v[48:51]
    s_waitcnt lgkmcnt(4)
    v_mfma_f32_16x16x32_bf16 v[32:35], v[124:127], v[160:163], v[32:35]
    ds_read_b128 v[168:171], v13 offset:8192
    v_mfma_f32_16x16x32_bf16 v[52:55], v[124:127], v[164:167], v[52:55]
    ds_read_b128 v[172:175], v14 offset:8192
    s_waitcnt lgkmcnt(5)
    v_mfma_f32_16x16x32_bf16 v[36:39], v[128:131], v[160:163], v[36:39]
    v_mfma_f32_16x16x32_bf16 v[56:59], v[128:131], v[164:167], v[56:59]
    ds_read_b128 v[144:147], v12 offset:51456
    s_waitcnt lgkmcnt(5)
    v_mfma_f32_16x16x32_bf16 v[40:43], v[132:135], v[160:163], v[40:43]
    ds_read_b128 v[148:151], v12 offset:51712
    v_mfma_f32_16x16x32_bf16 v[60:63], v[132:135], v[164:167], v[60:63]
    s_waitcnt lgkmcnt(5)
    v_mfma_f32_16x16x32_bf16 v[44:47], v[136:139], v[160:163], v[44:47]
    ds_read_b128 v[152:155], v12 offset:51968
    v_mfma_f32_16x16x32_bf16 v[64:67], v[136:139], v[164:167], v[64:67]
    ds_read_b128 v[156:159], v12 offset:52224
    s_barrier
    s_waitcnt lgkmcnt(5)
    v_mfma_f32_16x16x32_bf16 v[28:31], v[140:143], v[168:171], v[28:31]
    ds_read_b128 v[120:123], v8 offset:0
    s_waitcnt lgkmcnt(5)
    v_mfma_f32_16x16x32_bf16 v[48:51], v[140:143], v[172:175], v[48:51]
    s_waitcnt lgkmcnt(4)
    v_mfma_f32_16x16x32_bf16 v[32:35], v[144:147], v[168:171], v[32:35]
    ds_read_b128 v[160:163], v13 offset:16384
    v_mfma_f32_16x16x32_bf16 v[52:55], v[144:147], v[172:175], v[52:55]
    ds_read_b128 v[164:167], v14 offset:16384
    s_waitcnt lgkmcnt(5)
    v_mfma_f32_16x16x32_bf16 v[36:39], v[148:151], v[168:171], v[36:39]
    v_mfma_f32_16x16x32_bf16 v[56:59], v[148:151], v[172:175], v[56:59]
    ds_read_b128 v[124:127], v8 offset:256
    s_waitcnt lgkmcnt(5)
    v_mfma_f32_16x16x32_bf16 v[40:43], v[152:155], v[168:171], v[40:43]
    ds_read_b128 v[128:131], v8 offset:512
    v_mfma_f32_16x16x32_bf16 v[60:63], v[152:155], v[172:175], v[60:63]
    s_waitcnt lgkmcnt(5)
    v_mfma_f32_16x16x32_bf16 v[44:47], v[156:159], v[168:171], v[44:47]
    ds_read_b128 v[132:135], v8 offset:768
    v_mfma_f32_16x16x32_bf16 v[64:67], v[156:159], v[172:175], v[64:67]
    ds_read_b128 v[136:139], v8 offset:1024
    s_barrier
    s_waitcnt lgkmcnt(5)
    v_mfma_f32_16x16x32_bf16 v[28:31], v[120:123], v[160:163], v[28:31]
    ds_read_b128 v[140:143], v8 offset:10240
    s_waitcnt lgkmcnt(5)
    v_mfma_f32_16x16x32_bf16 v[48:51], v[120:123], v[164:167], v[48:51]
    s_waitcnt lgkmcnt(4)
    v_mfma_f32_16x16x32_bf16 v[32:35], v[124:127], v[160:163], v[32:35]
    ds_read_b128 v[168:171], v13 offset:24576
    v_mfma_f32_16x16x32_bf16 v[52:55], v[124:127], v[164:167], v[52:55]
    ds_read_b128 v[172:175], v14 offset:24576
    s_waitcnt lgkmcnt(5)
    v_mfma_f32_16x16x32_bf16 v[36:39], v[128:131], v[160:163], v[36:39]
    v_mfma_f32_16x16x32_bf16 v[56:59], v[128:131], v[164:167], v[56:59]
    ds_read_b128 v[144:147], v8 offset:10496
    s_waitcnt lgkmcnt(5)
    v_mfma_f32_16x16x32_bf16 v[40:43], v[132:135], v[160:163], v[40:43]
    ds_read_b128 v[148:151], v8 offset:10752
    v_mfma_f32_16x16x32_bf16 v[60:63], v[132:135], v[164:167], v[60:63]
    s_waitcnt lgkmcnt(5)
    v_mfma_f32_16x16x32_bf16 v[44:47], v[136:139], v[160:163], v[44:47]
    ds_read_b128 v[152:155], v8 offset:11008
    v_mfma_f32_16x16x32_bf16 v[64:67], v[136:139], v[164:167], v[64:67]
    ds_read_b128 v[156:159], v8 offset:11264
    s_barrier
    s_waitcnt lgkmcnt(5)
    v_mfma_f32_16x16x32_bf16 v[28:31], v[140:143], v[168:171], v[28:31]
    ds_read_b128 v[120:123], v8 offset:20480
    s_waitcnt lgkmcnt(5)
    v_mfma_f32_16x16x32_bf16 v[48:51], v[140:143], v[172:175], v[48:51]
    s_waitcnt lgkmcnt(4)
    v_mfma_f32_16x16x32_bf16 v[32:35], v[144:147], v[168:171], v[32:35]
    ds_read_b128 v[160:163], v13 offset:32768
    v_mfma_f32_16x16x32_bf16 v[52:55], v[144:147], v[172:175], v[52:55]
    ds_read_b128 v[164:167], v14 offset:32768
    s_waitcnt lgkmcnt(5)
    v_mfma_f32_16x16x32_bf16 v[36:39], v[148:151], v[168:171], v[36:39]
    v_mfma_f32_16x16x32_bf16 v[56:59], v[148:151], v[172:175], v[56:59]
    ds_read_b128 v[124:127], v8 offset:20736
    s_waitcnt lgkmcnt(5)
    v_mfma_f32_16x16x32_bf16 v[40:43], v[152:155], v[168:171], v[40:43]
    ds_read_b128 v[128:131], v8 offset:20992
    v_mfma_f32_16x16x32_bf16 v[60:63], v[152:155], v[172:175], v[60:63]
    s_waitcnt lgkmcnt(5)
    v_mfma_f32_16x16x32_bf16 v[44:47], v[156:159], v[168:171], v[44:47]
    ds_read_b128 v[132:135], v8 offset:21248
    v_mfma_f32_16x16x32_bf16 v[64:67], v[156:159], v[172:175], v[64:67]
    ds_read_b128 v[136:139], v8 offset:21504
    s_barrier
    s_waitcnt lgkmcnt(5)
    v_mfma_f32_16x16x32_bf16 v[28:31], v[120:123], v[160:163], v[28:31]
    ds_read_b128 v[140:143], v8 offset:30720
    s_waitcnt lgkmcnt(5)
    v_mfma_f32_16x16x32_bf16 v[48:51], v[120:123], v[164:167], v[48:51]
    s_waitcnt lgkmcnt(4)
    v_mfma_f32_16x16x32_bf16 v[32:35], v[124:127], v[160:163], v[32:35]
    ds_read_b128 v[168:171], v13 offset:40960
    v_mfma_f32_16x16x32_bf16 v[52:55], v[124:127], v[164:167], v[52:55]
    ds_read_b128 v[172:175], v14 offset:40960
    s_waitcnt lgkmcnt(5)
    v_mfma_f32_16x16x32_bf16 v[36:39], v[128:131], v[160:163], v[36:39]
    v_mfma_f32_16x16x32_bf16 v[56:59], v[128:131], v[164:167], v[56:59]
    ds_read_b128 v[144:147], v8 offset:30976
    s_waitcnt lgkmcnt(5)
    v_mfma_f32_16x16x32_bf16 v[40:43], v[132:135], v[160:163], v[40:43]
    ds_read_b128 v[148:151], v8 offset:31232
    v_mfma_f32_16x16x32_bf16 v[60:63], v[132:135], v[164:167], v[60:63]
    s_waitcnt lgkmcnt(5)
    v_mfma_f32_16x16x32_bf16 v[44:47], v[136:139], v[160:163], v[44:47]
    ds_read_b128 v[152:155], v8 offset:31488
    v_mfma_f32_16x16x32_bf16 v[64:67], v[136:139], v[164:167], v[64:67]
    ds_read_b128 v[156:159], v8 offset:31744
    s_barrier
    s_waitcnt lgkmcnt(5)
    v_mfma_f32_16x16x32_bf16 v[28:31], v[140:143], v[168:171], v[28:31]
    ds_read_b128 v[120:123], v8 offset:40960
    s_waitcnt lgkmcnt(5)
    v_mfma_f32_16x16x32_bf16 v[48:51], v[140:143], v[172:175], v[48:51]
    s_waitcnt lgkmcnt(4)
    v_mfma_f32_16x16x32_bf16 v[32:35], v[144:147], v[168:171], v[32:35]
    ds_read_b128 v[160:163], v13 offset:0
    v_mfma_f32_16x16x32_bf16 v[52:55], v[144:147], v[172:175], v[52:55]
    ds_read_b128 v[164:167], v14 offset:0
    s_waitcnt lgkmcnt(5)
    v_mfma_f32_16x16x32_bf16 v[36:39], v[148:151], v[168:171], v[36:39]
    v_mfma_f32_16x16x32_bf16 v[56:59], v[148:151], v[172:175], v[56:59]
    ds_read_b128 v[124:127], v8 offset:41216
    s_waitcnt lgkmcnt(5)
    v_mfma_f32_16x16x32_bf16 v[40:43], v[152:155], v[168:171], v[40:43]
    ds_read_b128 v[128:131], v8 offset:41472
    v_mfma_f32_16x16x32_bf16 v[60:63], v[152:155], v[172:175], v[60:63]
    s_waitcnt lgkmcnt(5)
    v_mfma_f32_16x16x32_bf16 v[44:47], v[156:159], v[168:171], v[44:47]
    ds_read_b128 v[132:135], v8 offset:41728
    v_mfma_f32_16x16x32_bf16 v[64:67], v[156:159], v[172:175], v[64:67]
    ds_read_b128 v[136:139], v8 offset:41984
    s_barrier
    s_waitcnt lgkmcnt(5)
    v_mfma_f32_16x16x32_bf16 v[28:31], v[120:123], v[160:163], v[28:31]
    ds_read_b128 v[140:143], v8 offset:51200
    s_waitcnt lgkmcnt(5)
    v_mfma_f32_16x16x32_bf16 v[48:51], v[120:123], v[164:167], v[48:51]
    s_waitcnt lgkmcnt(4)
    v_mfma_f32_16x16x32_bf16 v[32:35], v[124:127], v[160:163], v[32:35]
    ds_read_b128 v[168:171], v13 offset:8192
    v_mfma_f32_16x16x32_bf16 v[52:55], v[124:127], v[164:167], v[52:55]
    ds_read_b128 v[172:175], v14 offset:8192
    s_waitcnt lgkmcnt(5)
    v_mfma_f32_16x16x32_bf16 v[36:39], v[128:131], v[160:163], v[36:39]
    v_mfma_f32_16x16x32_bf16 v[56:59], v[128:131], v[164:167], v[56:59]
    ds_read_b128 v[144:147], v8 offset:51456
    s_waitcnt lgkmcnt(5)
    v_mfma_f32_16x16x32_bf16 v[40:43], v[132:135], v[160:163], v[40:43]
    ds_read_b128 v[148:151], v8 offset:51712
    v_mfma_f32_16x16x32_bf16 v[60:63], v[132:135], v[164:167], v[60:63]
    s_waitcnt lgkmcnt(5)
    v_mfma_f32_16x16x32_bf16 v[44:47], v[136:139], v[160:163], v[44:47]
    ds_read_b128 v[152:155], v8 offset:51968
    v_mfma_f32_16x16x32_bf16 v[64:67], v[136:139], v[164:167], v[64:67]
    ds_read_b128 v[156:159], v8 offset:52224
    ds_read_b64_tr_b16 v[70:71], v10 offset:0
    ds_read_b64_tr_b16 v[74:75], v10 offset:2048
    ds_read_b64_tr_b16 v[78:79], v10 offset:4096
    ds_read_b64_tr_b16 v[82:83], v10 offset:6144
    ds_read_b64_tr_b16 v[86:87], v10 offset:8192
    s_waitcnt lgkmcnt(0)
    v_mfma_f32_16x16x32_bf16 v[28:31], v[140:143], v[168:171], v[28:31]
    v_mfma_f32_16x16x32_bf16 v[48:51], v[140:143], v[172:175], v[48:51]
    v_mfma_f32_16x16x32_bf16 v[32:35], v[144:147], v[168:171], v[32:35]
    v_mfma_f32_16x16x32_bf16 v[52:55], v[144:147], v[172:175], v[52:55]
    v_mfma_f32_16x16x32_bf16 v[36:39], v[148:151], v[168:171], v[36:39]
    v_mfma_f32_16x16x32_bf16 v[56:59], v[148:151], v[172:175], v[56:59]
    v_mfma_f32_16x16x32_bf16 v[40:43], v[152:155], v[168:171], v[40:43]
    v_mfma_f32_16x16x32_bf16 v[60:63], v[152:155], v[172:175], v[60:63]
    v_mfma_f32_16x16x32_bf16 v[44:47], v[156:159], v[168:171], v[44:47]
    v_mfma_f32_16x16x32_bf16 v[64:67], v[156:159], v[172:175], v[64:67]
    v_lshlrev_b32 v68, 16, v70
    v_and_b32 v69, 0xffff0000, v70
    v_lshlrev_b32 v70, 16, v71
    v_and_b32 v71, 0xffff0000, v71
    v_lshlrev_b32 v72, 16, v74
    v_and_b32 v73, 0xffff0000, v74
    v_lshlrev_b32 v74, 16, v75
    v_and_b32 v75, 0xffff0000, v75
    v_lshlrev_b32 v76, 16, v78
    v_and_b32 v77, 0xffff0000, v78
    v_lshlrev_b32 v78, 16, v79
    v_and_b32 v79, 0xffff0000, v79
    v_lshlrev_b32 v80, 16, v82
    v_and_b32 v81, 0xffff0000, v82
    v_lshlrev_b32 v82, 16, v83
    v_and_b32 v83, 0xffff0000, v83
    v_lshlrev_b32 v84, 16, v86
    v_and_b32 v85, 0xffff0000, v86
    v_lshlrev_b32 v86, 16, v87
    v_and_b32 v87, 0xffff0000, v87
    v_add_u32 v3, 71680, v11
    ds_write_b128 v3, v[48:51] offset:0
    ds_write_b128 v3, v[52:55] offset:1024
    ds_write_b128 v3, v[56:59] offset:2048
    ds_write_b128 v3, v[60:63] offset:3072
    ds_write_b128 v3, v[64:67] offset:4096
    s_mul_i32 s17, s90, 10240
    s_sub_u32 s17, 76800, s17
    v_add_u32 v3, s17, v11
    s_waitcnt lgkmcnt(0)
    s_barrier
    ds_read_b128 v[120:123], v3 offset:0
    ds_read_b128 v[124:127], v3 offset:1024
    ds_read_b128 v[128:131], v3 offset:2048
    ds_read_b128 v[132:135], v3 offset:3072
    ds_read_b128 v[136:139], v3 offset:4096
    s_waitcnt lgkmcnt(4)
    v_pk_add_f32 v[28:29], v[28:29], v[120:121]
    v_pk_add_f32 v[30:31], v[30:31], v[122:123]
    v_pk_add_f32 v[28:29], v[28:29], v[68:69]
    v_pk_add_f32 v[30:31], v[30:31], v[70:71]
    v_cvt_pk_bf16_f32 v68, v28, v29
    v_cvt_pk_bf16_f32 v69, v30, v31
    buffer_store_dwordx2 v[68:69], v9, s[80:83], 0 offen offset:0
    s_waitcnt lgkmcnt(3)
    v_pk_add_f32 v[32:33], v[32:33], v[124:125]
    v_pk_add_f32 v[34:35], v[34:35], v[126:127]
    v_pk_add_f32 v[32:33], v[32:33], v[72:73]
    v_pk_add_f32 v[34:35], v[34:35], v[74:75]
    v_cvt_pk_bf16_f32 v72, v32, v33
    v_cvt_pk_bf16_f32 v73, v34, v35
    buffer_store_dwordx2 v[72:73], v9, s[80:83], 0 offen offset:32
    s_waitcnt lgkmcnt(2)
    v_pk_add_f32 v[36:37], v[36:37], v[128:129]
    v_pk_add_f32 v[38:39], v[38:39], v[130:131]
    v_pk_add_f32 v[36:37], v[36:37], v[76:77]
    v_pk_add_f32 v[38:39], v[38:39], v[78:79]
    v_cvt_pk_bf16_f32 v76, v36, v37
    v_cvt_pk_bf16_f32 v77, v38, v39
    buffer_store_dwordx2 v[76:77], v9, s[80:83], 0 offen offset:64
    s_waitcnt lgkmcnt(1)
    v_pk_add_f32 v[40:41], v[40:41], v[132:133]
    v_pk_add_f32 v[42:43], v[42:43], v[134:135]
    v_pk_add_f32 v[40:41], v[40:41], v[80:81]
    v_pk_add_f32 v[42:43], v[42:43], v[82:83]
    v_cvt_pk_bf16_f32 v80, v40, v41
    v_cvt_pk_bf16_f32 v81, v42, v43
    buffer_store_dwordx2 v[80:81], v9, s[80:83], 0 offen offset:96
    s_waitcnt lgkmcnt(0)
    v_pk_add_f32 v[44:45], v[44:45], v[136:137]
    v_pk_add_f32 v[46:47], v[46:47], v[138:139]
    v_pk_add_f32 v[44:45], v[44:45], v[84:85]
    v_pk_add_f32 v[46:47], v[46:47], v[86:87]
    v_cvt_pk_bf16_f32 v84, v44, v45
    v_cvt_pk_bf16_f32 v85, v46, v47
    buffer_store_dwordx2 v[84:85], v9, s[80:83], 0 offen offset:128
    s_branch L_mega_kernel_e5_120
L_mega_kernel_m5_119:
    s_mul_i32 s76, s15, 138240
    s_mul_i32 s90, s22, 2560
    s_add_u32 s76, s76, s90
    s_add_u32 s76, s76, 102400
    s_add_u32 m0, s89, 102400
    s_nop 0
    buffer_load_dwordx4 v4, s[84:87], s88 offen offset:0 sc1 lds
    buffer_load_dwordx4 v4, s[84:87], s88 offen offset:1024 sc1 lds
    s_add_u32 s88, s88, 8192
    s_add_u32 m0, s89, 110592
    s_nop 0
    buffer_load_dwordx4 v4, s[84:87], s88 offen offset:0 sc1 lds
    buffer_load_dwordx4 v4, s[84:87], s88 offen offset:1024 sc1 lds
    s_add_u32 s88, s88, 8192
    s_add_u32 m0, s89, 118784
    s_nop 0
    buffer_load_dwordx4 v4, s[84:87], s88 offen offset:0 sc1 lds
    buffer_load_dwordx4 v4, s[84:87], s88 offen offset:1024 sc1 lds
    s_add_u32 s88, s88, 8192
    s_add_u32 m0, s89, 126976
    s_nop 0
    buffer_load_dwordx4 v4, s[84:87], s88 offen offset:0 sc1 lds
    buffer_load_dwordx4 v4, s[84:87], s88 offen offset:1024 sc1 lds
    s_add_u32 s88, s88, 8192
    s_waitcnt vmcnt(6)
    s_barrier
    s_add_u32 m0, s89, 135168
    s_nop 0
    buffer_load_dwordx4 v4, s[84:87], s88 offen offset:0 sc1 lds
    buffer_load_dwordx4 v4, s[84:87], s88 offen offset:1024 sc1 lds
    s_add_u32 s88, s88, 8192
    s_waitcnt vmcnt(6)
    s_barrier
    s_add_u32 m0, s89, 143360
    s_nop 0
    buffer_load_dwordx4 v4, s[84:87], s88 offen offset:0 sc1 lds
    buffer_load_dwordx4 v4, s[84:87], s88 offen offset:1024 sc1 lds
    s_add_u32 s88, s88, 8192
    s_waitcnt vmcnt(6)
    s_barrier
    s_add_u32 m0, s89, 102400
    s_nop 0
    buffer_load_dwordx4 v4, s[84:87], s88 offen offset:0 sc1 lds
    buffer_load_dwordx4 v4, s[84:87], s88 offen offset:1024 sc1 lds
    s_add_u32 s88, s88, 8192
    s_add_u32 m0, s90, 20480
    s_nop 0
    buffer_load_dwordx4 v4, s[72:75], s76 offen offset:0 sc1 lds
    buffer_load_dwordx4 v4, s[72:75], s76 offen offset:1024 sc1 lds
    s_mov_b32 exec_hi, 0
    buffer_load_dwordx4 v4, s[72:75], s76 offen offset:2048 sc1 lds
    s_mov_b32 exec_hi, -1
    s_add_u32 s76, s76, 10240
    s_waitcnt vmcnt(9)
    s_barrier
    s_add_u32 m0, s89, 110592
    s_nop 0
    buffer_load_dwordx4 v4, s[84:87], s88 offen offset:0 sc1 lds
    buffer_load_dwordx4 v4, s[84:87], s88 offen offset:1024 sc1 lds
    s_add_u32 s88, s88, 8192
    s_add_u32 m0, s90, 30720
    s_nop 0
    buffer_load_dwordx4 v4, s[72:75], s76 offen offset:0 sc1 lds
    buffer_load_dwordx4 v4, s[72:75], s76 offen offset:1024 sc1 lds
    s_mov_b32 exec_hi, 0
    buffer_load_dwordx4 v4, s[72:75], s76 offen offset:2048 sc1 lds
    s_mov_b32 exec_hi, -1
    s_add_u32 s76, s76, 10240
    s_waitcnt vmcnt(12)
    s_barrier
    s_add_u32 m0, s89, 118784
    s_nop 0
    buffer_load_dwordx4 v4, s[84:87], s88 offen offset:0 sc1 lds
    buffer_load_dwordx4 v4, s[84:87], s88 offen offset:1024 sc1 lds
    s_add_u32 s88, s88, 8192
    s_add_u32 m0, s90, 40960
    s_nop 0
    buffer_load_dwordx4 v4, s[72:75], s76 offen offset:0 sc1 lds
    buffer_load_dwordx4 v4, s[72:75], s76 offen offset:1024 sc1 lds
    s_mov_b32 exec_hi, 0
    buffer_load_dwordx4 v4, s[72:75], s76 offen offset:2048 sc1 lds
    s_mov_b32 exec_hi, -1
    s_add_u32 s76, s76, 10240
    s_waitcnt vmcnt(15)
    s_barrier
    s_add_u32 m0, s89, 126976
    s_nop 0
    buffer_load_dwordx4 v4, s[84:87], s88 offen offset:0 sc1 lds
    buffer_load_dwordx4 v4, s[84:87], s88 offen offset:1024 sc1 lds
    s_add_u32 s88, s88, 8192
    s_add_u32 m0, s90, 51200
    s_nop 0
    buffer_load_dwordx4 v4, s[72:75], s76 offen offset:0 sc1 lds
    buffer_load_dwordx4 v4, s[72:75], s76 offen offset:1024 sc1 lds
    s_mov_b32 exec_hi, 0
    buffer_load_dwordx4 v4, s[72:75], s76 offen offset:2048 sc1 lds
    s_mov_b32 exec_hi, -1
    s_add_u32 s76, s76, 10240
    s_waitcnt vmcnt(18)
    s_barrier
    s_add_u32 m0, s89, 135168
    s_nop 0
    buffer_load_dwordx4 v4, s[84:87], s88 offen offset:0 sc1 lds
    buffer_load_dwordx4 v4, s[84:87], s88 offen offset:1024 sc1 lds
    s_add_u32 s88, s88, 8192
    s_waitcnt vmcnt(15)
    s_barrier
    s_add_u32 m0, s89, 143360
    s_nop 0
    buffer_load_dwordx4 v4, s[84:87], s88 offen offset:0 sc1 lds
    buffer_load_dwordx4 v4, s[84:87], s88 offen offset:1024 sc1 lds
    s_add_u32 s88, s88, 8192
    s_waitcnt vmcnt(12)
    s_barrier
    s_add_u32 m0, s89, 102400
    s_nop 0
    buffer_load_dwordx4 v4, s[84:87], s88 offen offset:0 sc1 lds
    buffer_load_dwordx4 v4, s[84:87], s88 offen offset:1024 sc1 lds
    s_add_u32 s88, s88, 8192
    s_add_u32 s48, s6, 0xa80000
    s_addc_u32 s49, s7, 0
    s_mov_b32 s50, 0x280000
    s_mov_b32 s51, 0x00020000
    s_mul_i32 s17, s14, 81920
    s_add_u32 m0, s90, 151552
    s_mul_i32 s18, s15, 80
    s_mul_i32 s56, s22, 20
    s_add_u32 s18, s18, s56
    v_lshrrev_b32 v20, 3, v1
    v_add_u32 v20, s18, v20
    v_mul_u32_u24 v21, 52429, v20
    v_lshrrev_b32 v21, 18, v21
    v_mul_u32_u24 v22, 5, v21
    v_sub_u32 v22, v20, v22
    v_sub_u32 v20, v20, v21
    v_cmp_lt_u32 vcc, 2, v22
    v_add_u32 v23, -1, v20
    s_nop 0
    v_cndmask_b32 v20, v20, v23, vcc
    v_add_u32 v21, 512, v21
    v_cmp_eq_u32 vcc, 2, v22
    s_nop 1
    v_cndmask_b32 v20, v20, v21, vcc
    v_lshlrev_b32 v20, 7, v20
    v_and_b32 v21, 7, v1
    v_lshl_add_u32 v24, v21, 4, v20
    v_lshrrev_b32 v20, 3, v1
    v_add_u32 v20, s18, v20
    v_add_u32 v20, 8, v20
    v_mul_u32_u24 v21, 52429, v20
    v_lshrrev_b32 v21, 18, v21
    v_mul_u32_u24 v22, 5, v21
    v_sub_u32 v22, v20, v22
    v_sub_u32 v20, v20, v21
    v_cmp_lt_u32 vcc, 2, v22
    v_add_u32 v23, -1, v20
    s_nop 0
    v_cndmask_b32 v20, v20, v23, vcc
    v_add_u32 v21, 512, v21
    v_cmp_eq_u32 vcc, 2, v22
    s_nop 1
    v_cndmask_b32 v20, v20, v21, vcc
    v_lshlrev_b32 v20, 7, v20
    v_and_b32 v21, 7, v1
    v_lshl_add_u32 v25, v21, 4, v20
    v_lshrrev_b32 v20, 3, v1
    v_add_u32 v20, s18, v20
    v_add_u32 v20, 16, v20
    v_mul_u32_u24 v21, 52429, v20
    v_lshrrev_b32 v21, 18, v21
    v_mul_u32_u24 v22, 5, v21
    v_sub_u32 v22, v20, v22
    v_sub_u32 v20, v20, v21
    v_cmp_lt_u32 vcc, 2, v22
    v_add_u32 v23, -1, v20
    s_nop 0
    v_cndmask_b32 v20, v20, v23, vcc
    v_add_u32 v21, 512, v21
    v_cmp_eq_u32 vcc, 2, v22
    s_nop 1
    v_cndmask_b32 v20, v20, v21, vcc
    v_lshlrev_b32 v20, 7, v20
    v_and_b32 v21, 7, v1
    v_lshl_add_u32 v26, v21, 4, v20
    buffer_load_dwordx4 v24, s[48:51], s17 offen sc1 lds
    s_add_u32 m0, m0, 1024
    s_nop 0
    buffer_load_dwordx4 v25, s[48:51], s17 offen sc1 lds
    s_mov_b32 exec_hi, 0
    s_add_u32 m0, m0, 1024
    s_nop 0
    buffer_load_dwordx4 v26, s[48:51], s17 offen sc1 lds
    s_mov_b32 exec_hi, -1
    s_waitcnt vmcnt(12)
    s_barrier
    s_add_u32 m0, s89, 110592
    s_nop 0
    buffer_load_dwordx4 v4, s[84:87], s88 offen offset:0 sc1 lds
    buffer_load_dwordx4 v4, s[84:87], s88 offen offset:1024 sc1 lds
    s_add_u32 s88, s88, 8192
    s_waitcnt vmcnt(9)
    s_barrier
    s_waitcnt vmcnt(7)
    s_barrier
    s_waitcnt vmcnt(5)
    s_barrier
    s_waitcnt vmcnt(0)
    s_barrier
    s_barrier
L_mega_kernel_e5_120:
L_mega_kernel_end_1:
    s_endpgm
L_code_end:
.section .rodata,"a"
.p2align 6
.amdhsa_kernel mega_kernel
  .amdhsa_next_free_vgpr 252
  .amdhsa_next_free_sgpr 96
  .amdhsa_accum_offset 252
  .amdhsa_group_segment_fixed_size 0
  .amdhsa_kernarg_size 120
  .amdhsa_user_sgpr_count 2
  .amdhsa_user_sgpr_kernarg_segment_ptr 1
  .amdhsa_system_sgpr_workgroup_id_x 1
.end_amdhsa_kernel
```
